```python
import torch

def _softmax(x, axis=-1):
    return torch.softmax(x, dim=axis)
def _gelu(x):
    return torch.nn.functional.gelu(x, approximate="tanh")
def _silu(x):
    return torch.nn.functional.silu(x)
def _sigmoid(x):
    return torch.sigmoid(x)
def _layernorm(x, axis=-1, eps=1e-5):
    m = x.mean(dim=axis, keepdim=True)
    v = x.var(dim=axis, keepdim=True, unbiased=False)
    return (x - m) / torch.sqrt(v + eps)
def _scatter_add(tgt, idx, src, axis=0):
    return tgt.clone().index_add_(axis, idx, src)
def _segment_sum(src, seg, n):
    out = torch.zeros((n,) + src.shape[1:], dtype=src.dtype)
    return out.index_add_(0, seg, src)
def _pad(x, pw):
    flat = tuple(v for pair in reversed(pw) for v in pair)
    return torch.nn.functional.pad(x, flat)

kernel_name = 'recurrent_scan__mha_block_cached__dense_activation_silu__prompt'

def setup_inputs():

    _w = (lambda a: (lambda t: t.to(torch.bfloat16) if t.is_floating_point() else t)(torch.as_tensor(a)))
    def _A_setup():
        B, Sq, D = 1, 2048, 640
        H, Sk, Dh = 32, 2048, 128
        return {
            "x": _w((lambda *s: torch.randn(*s, dtype=torch.bfloat16) * 0.05)(B, Sq, D)),
            "k_cache": _w((lambda *s: torch.randn(*s, dtype=torch.bfloat16) * 3.2)(B, H, Sk, Dh)),
            "v_cache": _w((lambda *s: torch.randn(*s, dtype=torch.bfloat16) * 3.2)(B, H, Sk, Dh)),
            "wq": _w((lambda *s: torch.randn(*s, dtype=torch.bfloat16) * 3.2)(D, H * Dh) * (D ** -0.5)),
            "wo": _w((lambda *s: torch.randn(*s, dtype=torch.bfloat16) * 3.2)(H * Dh, D) * ((H * Dh) ** -0.5)),
        }
    _A_in = _A_setup()

    def _B_setup():
        B, S, D, F = 1, 2048, 640, 1728
        return {
            "x": _w((lambda *s: torch.randn(*s, dtype=torch.bfloat16) * 0.05)(B, S, D)),
            "w1": _w((lambda *s: torch.randn(*s, dtype=torch.bfloat16) * 3.2)(D, F) * (D ** -0.5)),
            "w2": _w((lambda *s: torch.randn(*s, dtype=torch.bfloat16) * 0.4)(F, D) * (F ** -0.5)),
        }
    _B_in = _B_setup()

    return {
        "A_x": _A_in["x"],
        "A_k_cache": _A_in["k_cache"],
        "A_v_cache": _A_in["v_cache"],
        "A_wq": _A_in["wq"],
        "A_wo": _A_in["wo"],
        "B_x": _B_in["x"],
        "B_w1": _B_in["w1"],
        "B_w2": _B_in["w2"],
    }

def reference(A_x, A_k_cache, A_v_cache, A_wq, A_wo, B_x, B_w1, B_w2):
    def _A_ref(x, k_cache, v_cache, wq, wo):
        B, Sq, D = x.shape
        H, Dh = 32, 128
        q = (lambda x, *d: x.permute(*d))((x @ wq).reshape(B, Sq, H, Dh), 0, 2, 1, 3)
        scores = torch.einsum("bhqd,bhkd->bhqk", q, k_cache) * (Dh ** -0.5)
        p = _softmax(scores, axis=-1)
        o = torch.einsum("bhqk,bhkd->bhqd", p, v_cache)
        return (lambda x, *d: x.permute(*d))(o, 0, 2, 1, 3).reshape(B, Sq, H * Dh) @ wo

    def _B_ref(x, w1, w2):
        h = torch.einsum("bsd,df->bsf", x, w1)
        h = _silu(h)
        out = torch.einsum("bsf,fd->bsd", h, w2)
        return out

    x = A_x
    xn = _layernorm(x, axis=-1)
    s = _A_ref(xn, A_k_cache, A_v_cache, A_wq, A_wo)
    g = _silu(_B_ref(xn, B_w1, B_w2))
    return x + s * g
```

```asm
; @launch kernel=ln_kernel grid=(128,1,1) block=(256,1,1) lds=0
; @launch kernel=attn_kernel grid=(256,1,1) block=(256,1,1) lds=163840
; @launch kernel=out_kernel grid=(256,1,1) block=(256,1,1) lds=122880
.amdgcn_target "amdgcn-amd-amdhsa--gfx950"
.text
.globl ln_kernel
.p2align 8
.type ln_kernel,@function
ln_kernel:
  s_cmp_ge_u32 s2, 128
  s_cbranch_scc1 L_k0_done
  s_load_dwordx2 s[4:5], s[0:1], 0
  s_load_dwordx2 s[6:7], s[0:1], 80
  v_lshrrev_b32 v1, 4, v0
  s_lshl_b32 s3, s2, 4
  v_add_u32 v1, s3, v1
  v_and_b32 v2, 15, v0
  v_mul_u32_u24 v3, 1280, v1
  v_lshl_add_u32 v3, v2, 4, v3
  v_lshrrev_b32 v4, 4, v1
  v_mul_u32_u24 v4, 20480, v4
  v_lshrrev_b32 v5, 2, v2
  v_lshl_add_u32 v4, v5, 10, v4
  v_and_b32 v5, 3, v2
  v_lshl_add_u32 v4, v5, 8, v4
  v_and_b32 v5, 15, v1
  v_lshl_add_u32 v4, v5, 4, v4
  s_waitcnt lgkmcnt(0)
  s_mov_b32 s8, s4
  s_and_b32 s9, s5, 0xffff
  s_mov_b32 s10, 2621440
  s_mov_b32 s11, 0x20000
  s_mov_b32 s12, s6
  s_and_b32 s13, s7, 0xffff
  s_mov_b32 s14, 2621440
  s_mov_b32 s15, 0x20000
  buffer_load_dwordx4 v[8:11], v3, s[8:11], 0 offen offset:0
  buffer_load_dwordx4 v[12:15], v3, s[8:11], 0 offen offset:256
  buffer_load_dwordx4 v[16:19], v3, s[8:11], 0 offen offset:512
  buffer_load_dwordx4 v[20:23], v3, s[8:11], 0 offen offset:768
  buffer_load_dwordx4 v[24:27], v3, s[8:11], 0 offen offset:1024
  s_mov_b32 s16, 0xffff0000
  s_waitcnt vmcnt(0)
  v_lshlrev_b32 v32, 16, v8
  v_and_b32 v33, s16, v8
  v_lshlrev_b32 v34, 16, v9
  v_and_b32 v35, s16, v9
  v_lshlrev_b32 v36, 16, v10
  v_and_b32 v37, s16, v10
  v_lshlrev_b32 v38, 16, v11
  v_and_b32 v39, s16, v11
  v_lshlrev_b32 v40, 16, v12
  v_and_b32 v41, s16, v12
  v_lshlrev_b32 v42, 16, v13
  v_and_b32 v43, s16, v13
  v_lshlrev_b32 v44, 16, v14
  v_and_b32 v45, s16, v14
  v_lshlrev_b32 v46, 16, v15
  v_and_b32 v47, s16, v15
  v_lshlrev_b32 v48, 16, v16
  v_and_b32 v49, s16, v16
  v_lshlrev_b32 v50, 16, v17
  v_and_b32 v51, s16, v17
  v_lshlrev_b32 v52, 16, v18
  v_and_b32 v53, s16, v18
  v_lshlrev_b32 v54, 16, v19
  v_and_b32 v55, s16, v19
  v_lshlrev_b32 v56, 16, v20
  v_and_b32 v57, s16, v20
  v_lshlrev_b32 v58, 16, v21
  v_and_b32 v59, s16, v21
  v_lshlrev_b32 v60, 16, v22
  v_and_b32 v61, s16, v22
  v_lshlrev_b32 v62, 16, v23
  v_and_b32 v63, s16, v23
  v_lshlrev_b32 v64, 16, v24
  v_and_b32 v65, s16, v24
  v_lshlrev_b32 v66, 16, v25
  v_and_b32 v67, s16, v25
  v_lshlrev_b32 v68, 16, v26
  v_and_b32 v69, s16, v26
  v_lshlrev_b32 v70, 16, v27
  v_and_b32 v71, s16, v27
  v_add_f32 v72, v32, v36
  v_add_f32 v73, v33, v37
  v_add_f32 v74, v34, v38
  v_add_f32 v75, v35, v39
  v_add_f32 v72, v72, v40
  v_add_f32 v73, v73, v41
  v_add_f32 v74, v74, v42
  v_add_f32 v75, v75, v43
  v_add_f32 v72, v72, v44
  v_add_f32 v73, v73, v45
  v_add_f32 v74, v74, v46
  v_add_f32 v75, v75, v47
  v_add_f32 v72, v72, v48
  v_add_f32 v73, v73, v49
  v_add_f32 v74, v74, v50
  v_add_f32 v75, v75, v51
  v_add_f32 v72, v72, v52
  v_add_f32 v73, v73, v53
  v_add_f32 v74, v74, v54
  v_add_f32 v75, v75, v55
  v_add_f32 v72, v72, v56
  v_add_f32 v73, v73, v57
  v_add_f32 v74, v74, v58
  v_add_f32 v75, v75, v59
  v_add_f32 v72, v72, v60
  v_add_f32 v73, v73, v61
  v_add_f32 v74, v74, v62
  v_add_f32 v75, v75, v63
  v_add_f32 v72, v72, v64
  v_add_f32 v73, v73, v65
  v_add_f32 v74, v74, v66
  v_add_f32 v75, v75, v67
  v_add_f32 v72, v72, v68
  v_add_f32 v73, v73, v69
  v_add_f32 v74, v74, v70
  v_add_f32 v75, v75, v71
  v_add_f32 v72, v72, v73
  v_add_f32 v74, v74, v75
  v_add_f32 v72, v72, v74
  s_nop 1
  v_add_f32_dpp v72, v72, v72 row_ror:8 row_mask:0xf bank_mask:0xf
  s_nop 1
  v_add_f32_dpp v72, v72, v72 row_ror:4 row_mask:0xf bank_mask:0xf
  s_nop 1
  v_add_f32_dpp v72, v72, v72 row_ror:2 row_mask:0xf bank_mask:0xf
  s_nop 1
  v_add_f32_dpp v72, v72, v72 row_ror:1 row_mask:0xf bank_mask:0xf
  v_mul_f32 v72, 0x3acccccd, v72
  v_mov_b32 v76, 0
  v_mov_b32 v77, 0
  v_mov_b32 v78, 0
  v_mov_b32 v79, 0
  v_sub_f32 v80, v32, v72
  v_fmac_f32 v76, v80, v80
  v_sub_f32 v80, v33, v72
  v_fmac_f32 v77, v80, v80
  v_sub_f32 v80, v34, v72
  v_fmac_f32 v78, v80, v80
  v_sub_f32 v80, v35, v72
  v_fmac_f32 v79, v80, v80
  v_sub_f32 v80, v36, v72
  v_fmac_f32 v76, v80, v80
  v_sub_f32 v80, v37, v72
  v_fmac_f32 v77, v80, v80
  v_sub_f32 v80, v38, v72
  v_fmac_f32 v78, v80, v80
  v_sub_f32 v80, v39, v72
  v_fmac_f32 v79, v80, v80
  v_sub_f32 v80, v40, v72
  v_fmac_f32 v76, v80, v80
  v_sub_f32 v80, v41, v72
  v_fmac_f32 v77, v80, v80
  v_sub_f32 v80, v42, v72
  v_fmac_f32 v78, v80, v80
  v_sub_f32 v80, v43, v72
  v_fmac_f32 v79, v80, v80
  v_sub_f32 v80, v44, v72
  v_fmac_f32 v76, v80, v80
  v_sub_f32 v80, v45, v72
  v_fmac_f32 v77, v80, v80
  v_sub_f32 v80, v46, v72
  v_fmac_f32 v78, v80, v80
  v_sub_f32 v80, v47, v72
  v_fmac_f32 v79, v80, v80
  v_sub_f32 v80, v48, v72
  v_fmac_f32 v76, v80, v80
  v_sub_f32 v80, v49, v72
  v_fmac_f32 v77, v80, v80
  v_sub_f32 v80, v50, v72
  v_fmac_f32 v78, v80, v80
  v_sub_f32 v80, v51, v72
  v_fmac_f32 v79, v80, v80
  v_sub_f32 v80, v52, v72
  v_fmac_f32 v76, v80, v80
  v_sub_f32 v80, v53, v72
  v_fmac_f32 v77, v80, v80
  v_sub_f32 v80, v54, v72
  v_fmac_f32 v78, v80, v80
  v_sub_f32 v80, v55, v72
  v_fmac_f32 v79, v80, v80
  v_sub_f32 v80, v56, v72
  v_fmac_f32 v76, v80, v80
  v_sub_f32 v80, v57, v72
  v_fmac_f32 v77, v80, v80
  v_sub_f32 v80, v58, v72
  v_fmac_f32 v78, v80, v80
  v_sub_f32 v80, v59, v72
  v_fmac_f32 v79, v80, v80
  v_sub_f32 v80, v60, v72
  v_fmac_f32 v76, v80, v80
  v_sub_f32 v80, v61, v72
  v_fmac_f32 v77, v80, v80
  v_sub_f32 v80, v62, v72
  v_fmac_f32 v78, v80, v80
  v_sub_f32 v80, v63, v72
  v_fmac_f32 v79, v80, v80
  v_sub_f32 v80, v64, v72
  v_fmac_f32 v76, v80, v80
  v_sub_f32 v80, v65, v72
  v_fmac_f32 v77, v80, v80
  v_sub_f32 v80, v66, v72
  v_fmac_f32 v78, v80, v80
  v_sub_f32 v80, v67, v72
  v_fmac_f32 v79, v80, v80
  v_sub_f32 v80, v68, v72
  v_fmac_f32 v76, v80, v80
  v_sub_f32 v80, v69, v72
  v_fmac_f32 v77, v80, v80
  v_sub_f32 v80, v70, v72
  v_fmac_f32 v78, v80, v80
  v_sub_f32 v80, v71, v72
  v_fmac_f32 v79, v80, v80
  v_add_f32 v76, v76, v77
  v_add_f32 v78, v78, v79
  v_add_f32 v76, v76, v78
  s_nop 1
  v_add_f32_dpp v76, v76, v76 row_ror:8 row_mask:0xf bank_mask:0xf
  s_nop 1
  v_add_f32_dpp v76, v76, v76 row_ror:4 row_mask:0xf bank_mask:0xf
  s_nop 1
  v_add_f32_dpp v76, v76, v76 row_ror:2 row_mask:0xf bank_mask:0xf
  s_nop 1
  v_add_f32_dpp v76, v76, v76 row_ror:1 row_mask:0xf bank_mask:0xf
  v_mul_f32 v76, 0x3acccccd, v76
  v_cvt_pk_bf16_f32 v72, v72, v76
  s_nop 0
  v_and_b32 v76, s16, v72
  v_lshlrev_b32 v72, 16, v72
  v_add_f32 v76, 0x3727c5ac, v76
  s_nop 0
  v_cvt_pk_bf16_f32 v76, v76, v76
  s_nop 0
  v_lshlrev_b32 v76, 16, v76
  v_sqrt_f32 v77, v76
  s_nop 0
  v_rcp_f32 v78, v77
  v_fma_f32 v79, -v77, v77, v76
  v_mul_f32 v78, 0.5, v78
  v_fmac_f32 v77, v79, v78
  v_cvt_pk_bf16_f32 v77, v77, v77
  s_nop 0
  v_lshlrev_b32 v77, 16, v77
  s_nop 0
  v_rcp_f32 v78, v77
  s_nop 0
  v_sub_f32 v32, v32, v72
  v_sub_f32 v33, v33, v72
  v_cvt_pk_bf16_f32 v80, v32, v33
  v_lshlrev_b32 v32, 16, v80
  v_and_b32 v33, s16, v80
  v_mul_f32 v81, v32, v78
  v_mul_f32 v82, v33, v78
  v_fma_f32 v83, -v81, v77, v32
  v_fma_f32 v84, -v82, v77, v33
  v_fmac_f32 v81, v83, v78
  v_fmac_f32 v82, v84, v78
  v_cvt_pk_bf16_f32 v8, v81, v82
  v_sub_f32 v34, v34, v72
  v_sub_f32 v35, v35, v72
  v_cvt_pk_bf16_f32 v80, v34, v35
  v_lshlrev_b32 v34, 16, v80
  v_and_b32 v35, s16, v80
  v_mul_f32 v81, v34, v78
  v_mul_f32 v82, v35, v78
  v_fma_f32 v83, -v81, v77, v34
  v_fma_f32 v84, -v82, v77, v35
  v_fmac_f32 v81, v83, v78
  v_fmac_f32 v82, v84, v78
  v_cvt_pk_bf16_f32 v9, v81, v82
  v_sub_f32 v36, v36, v72
  v_sub_f32 v37, v37, v72
  v_cvt_pk_bf16_f32 v80, v36, v37
  v_lshlrev_b32 v36, 16, v80
  v_and_b32 v37, s16, v80
  v_mul_f32 v81, v36, v78
  v_mul_f32 v82, v37, v78
  v_fma_f32 v83, -v81, v77, v36
  v_fma_f32 v84, -v82, v77, v37
  v_fmac_f32 v81, v83, v78
  v_fmac_f32 v82, v84, v78
  v_cvt_pk_bf16_f32 v10, v81, v82
  v_sub_f32 v38, v38, v72
  v_sub_f32 v39, v39, v72
  v_cvt_pk_bf16_f32 v80, v38, v39
  v_lshlrev_b32 v38, 16, v80
  v_and_b32 v39, s16, v80
  v_mul_f32 v81, v38, v78
  v_mul_f32 v82, v39, v78
  v_fma_f32 v83, -v81, v77, v38
  v_fma_f32 v84, -v82, v77, v39
  v_fmac_f32 v81, v83, v78
  v_fmac_f32 v82, v84, v78
  v_cvt_pk_bf16_f32 v11, v81, v82
  v_sub_f32 v40, v40, v72
  v_sub_f32 v41, v41, v72
  v_cvt_pk_bf16_f32 v80, v40, v41
  v_lshlrev_b32 v40, 16, v80
  v_and_b32 v41, s16, v80
  v_mul_f32 v81, v40, v78
  v_mul_f32 v82, v41, v78
  v_fma_f32 v83, -v81, v77, v40
  v_fma_f32 v84, -v82, v77, v41
  v_fmac_f32 v81, v83, v78
  v_fmac_f32 v82, v84, v78
  v_cvt_pk_bf16_f32 v12, v81, v82
  v_sub_f32 v42, v42, v72
  v_sub_f32 v43, v43, v72
  v_cvt_pk_bf16_f32 v80, v42, v43
  v_lshlrev_b32 v42, 16, v80
  v_and_b32 v43, s16, v80
  v_mul_f32 v81, v42, v78
  v_mul_f32 v82, v43, v78
  v_fma_f32 v83, -v81, v77, v42
  v_fma_f32 v84, -v82, v77, v43
  v_fmac_f32 v81, v83, v78
  v_fmac_f32 v82, v84, v78
  v_cvt_pk_bf16_f32 v13, v81, v82
  v_sub_f32 v44, v44, v72
  v_sub_f32 v45, v45, v72
  v_cvt_pk_bf16_f32 v80, v44, v45
  v_lshlrev_b32 v44, 16, v80
  v_and_b32 v45, s16, v80
  v_mul_f32 v81, v44, v78
  v_mul_f32 v82, v45, v78
  v_fma_f32 v83, -v81, v77, v44
  v_fma_f32 v84, -v82, v77, v45
  v_fmac_f32 v81, v83, v78
  v_fmac_f32 v82, v84, v78
  v_cvt_pk_bf16_f32 v14, v81, v82
  v_sub_f32 v46, v46, v72
  v_sub_f32 v47, v47, v72
  v_cvt_pk_bf16_f32 v80, v46, v47
  v_lshlrev_b32 v46, 16, v80
  v_and_b32 v47, s16, v80
  v_mul_f32 v81, v46, v78
  v_mul_f32 v82, v47, v78
  v_fma_f32 v83, -v81, v77, v46
  v_fma_f32 v84, -v82, v77, v47
  v_fmac_f32 v81, v83, v78
  v_fmac_f32 v82, v84, v78
  v_cvt_pk_bf16_f32 v15, v81, v82
  v_sub_f32 v48, v48, v72
  v_sub_f32 v49, v49, v72
  v_cvt_pk_bf16_f32 v80, v48, v49
  v_lshlrev_b32 v48, 16, v80
  v_and_b32 v49, s16, v80
  v_mul_f32 v81, v48, v78
  v_mul_f32 v82, v49, v78
  v_fma_f32 v83, -v81, v77, v48
  v_fma_f32 v84, -v82, v77, v49
  v_fmac_f32 v81, v83, v78
  v_fmac_f32 v82, v84, v78
  v_cvt_pk_bf16_f32 v16, v81, v82
  v_sub_f32 v50, v50, v72
  v_sub_f32 v51, v51, v72
  v_cvt_pk_bf16_f32 v80, v50, v51
  v_lshlrev_b32 v50, 16, v80
  v_and_b32 v51, s16, v80
  v_mul_f32 v81, v50, v78
  v_mul_f32 v82, v51, v78
  v_fma_f32 v83, -v81, v77, v50
  v_fma_f32 v84, -v82, v77, v51
  v_fmac_f32 v81, v83, v78
  v_fmac_f32 v82, v84, v78
  v_cvt_pk_bf16_f32 v17, v81, v82
  v_sub_f32 v52, v52, v72
  v_sub_f32 v53, v53, v72
  v_cvt_pk_bf16_f32 v80, v52, v53
  v_lshlrev_b32 v52, 16, v80
  v_and_b32 v53, s16, v80
  v_mul_f32 v81, v52, v78
  v_mul_f32 v82, v53, v78
  v_fma_f32 v83, -v81, v77, v52
  v_fma_f32 v84, -v82, v77, v53
  v_fmac_f32 v81, v83, v78
  v_fmac_f32 v82, v84, v78
  v_cvt_pk_bf16_f32 v18, v81, v82
  v_sub_f32 v54, v54, v72
  v_sub_f32 v55, v55, v72
  v_cvt_pk_bf16_f32 v80, v54, v55
  v_lshlrev_b32 v54, 16, v80
  v_and_b32 v55, s16, v80
  v_mul_f32 v81, v54, v78
  v_mul_f32 v82, v55, v78
  v_fma_f32 v83, -v81, v77, v54
  v_fma_f32 v84, -v82, v77, v55
  v_fmac_f32 v81, v83, v78
  v_fmac_f32 v82, v84, v78
  v_cvt_pk_bf16_f32 v19, v81, v82
  v_sub_f32 v56, v56, v72
  v_sub_f32 v57, v57, v72
  v_cvt_pk_bf16_f32 v80, v56, v57
  v_lshlrev_b32 v56, 16, v80
  v_and_b32 v57, s16, v80
  v_mul_f32 v81, v56, v78
  v_mul_f32 v82, v57, v78
  v_fma_f32 v83, -v81, v77, v56
  v_fma_f32 v84, -v82, v77, v57
  v_fmac_f32 v81, v83, v78
  v_fmac_f32 v82, v84, v78
  v_cvt_pk_bf16_f32 v20, v81, v82
  v_sub_f32 v58, v58, v72
  v_sub_f32 v59, v59, v72
  v_cvt_pk_bf16_f32 v80, v58, v59
  v_lshlrev_b32 v58, 16, v80
  v_and_b32 v59, s16, v80
  v_mul_f32 v81, v58, v78
  v_mul_f32 v82, v59, v78
  v_fma_f32 v83, -v81, v77, v58
  v_fma_f32 v84, -v82, v77, v59
  v_fmac_f32 v81, v83, v78
  v_fmac_f32 v82, v84, v78
  v_cvt_pk_bf16_f32 v21, v81, v82
  v_sub_f32 v60, v60, v72
  v_sub_f32 v61, v61, v72
  v_cvt_pk_bf16_f32 v80, v60, v61
  v_lshlrev_b32 v60, 16, v80
  v_and_b32 v61, s16, v80
  v_mul_f32 v81, v60, v78
  v_mul_f32 v82, v61, v78
  v_fma_f32 v83, -v81, v77, v60
  v_fma_f32 v84, -v82, v77, v61
  v_fmac_f32 v81, v83, v78
  v_fmac_f32 v82, v84, v78
  v_cvt_pk_bf16_f32 v22, v81, v82
  v_sub_f32 v62, v62, v72
  v_sub_f32 v63, v63, v72
  v_cvt_pk_bf16_f32 v80, v62, v63
  v_lshlrev_b32 v62, 16, v80
  v_and_b32 v63, s16, v80
  v_mul_f32 v81, v62, v78
  v_mul_f32 v82, v63, v78
  v_fma_f32 v83, -v81, v77, v62
  v_fma_f32 v84, -v82, v77, v63
  v_fmac_f32 v81, v83, v78
  v_fmac_f32 v82, v84, v78
  v_cvt_pk_bf16_f32 v23, v81, v82
  v_sub_f32 v64, v64, v72
  v_sub_f32 v65, v65, v72
  v_cvt_pk_bf16_f32 v80, v64, v65
  v_lshlrev_b32 v64, 16, v80
  v_and_b32 v65, s16, v80
  v_mul_f32 v81, v64, v78
  v_mul_f32 v82, v65, v78
  v_fma_f32 v83, -v81, v77, v64
  v_fma_f32 v84, -v82, v77, v65
  v_fmac_f32 v81, v83, v78
  v_fmac_f32 v82, v84, v78
  v_cvt_pk_bf16_f32 v24, v81, v82
  v_sub_f32 v66, v66, v72
  v_sub_f32 v67, v67, v72
  v_cvt_pk_bf16_f32 v80, v66, v67
  v_lshlrev_b32 v66, 16, v80
  v_and_b32 v67, s16, v80
  v_mul_f32 v81, v66, v78
  v_mul_f32 v82, v67, v78
  v_fma_f32 v83, -v81, v77, v66
  v_fma_f32 v84, -v82, v77, v67
  v_fmac_f32 v81, v83, v78
  v_fmac_f32 v82, v84, v78
  v_cvt_pk_bf16_f32 v25, v81, v82
  v_sub_f32 v68, v68, v72
  v_sub_f32 v69, v69, v72
  v_cvt_pk_bf16_f32 v80, v68, v69
  v_lshlrev_b32 v68, 16, v80
  v_and_b32 v69, s16, v80
  v_mul_f32 v81, v68, v78
  v_mul_f32 v82, v69, v78
  v_fma_f32 v83, -v81, v77, v68
  v_fma_f32 v84, -v82, v77, v69
  v_fmac_f32 v81, v83, v78
  v_fmac_f32 v82, v84, v78
  v_cvt_pk_bf16_f32 v26, v81, v82
  v_sub_f32 v70, v70, v72
  v_sub_f32 v71, v71, v72
  v_cvt_pk_bf16_f32 v80, v70, v71
  v_lshlrev_b32 v70, 16, v80
  v_and_b32 v71, s16, v80
  v_mul_f32 v81, v70, v78
  v_mul_f32 v82, v71, v78
  v_fma_f32 v83, -v81, v77, v70
  v_fma_f32 v84, -v82, v77, v71
  v_fmac_f32 v81, v83, v78
  v_fmac_f32 v82, v84, v78
  v_cvt_pk_bf16_f32 v27, v81, v82
  s_mov_b32 s17, 0
  buffer_store_dwordx4 v[8:11], v4, s[12:15], s17 offen
  s_mov_b32 s17, 4096
  buffer_store_dwordx4 v[12:15], v4, s[12:15], s17 offen
  s_mov_b32 s17, 8192
  buffer_store_dwordx4 v[16:19], v4, s[12:15], s17 offen
  s_mov_b32 s17, 12288
  buffer_store_dwordx4 v[20:23], v4, s[12:15], s17 offen
  s_mov_b32 s17, 16384
  buffer_store_dwordx4 v[24:27], v4, s[12:15], s17 offen
  s_endpgm
L_k0_done:
  s_endpgm
.text
.globl attn_kernel
.p2align 8
.type attn_kernel,@function
attn_kernel:
  s_cmp_ge_u32 s2, 256
  s_cbranch_scc1 L_k2_done
  s_load_dwordx4 s[48:51], s[0:1], 8
  s_load_dwordx2 s[52:53], s[0:1], 24
  s_load_dwordx2 s[54:55], s[0:1], 48
  s_load_dwordx2 s[56:57], s[0:1], 80
  s_load_dwordx2 s[58:59], s[0:1], 0
  s_load_dwordx2 s[66:67], s[0:1], 72
  v_lshrrev_b32 v1, 6, v0
  v_and_b32 v0, 63, v0
  s_nop 0
  v_readfirstlane_b32 s28, v1
  s_and_b32 s44, s2, 7
  s_lshr_b32 s45, s2, 3
  s_and_b32 s46, s45, 3
  s_lshl_b32 s44, s44, 2
  s_add_u32 s29, s44, s46
  s_lshr_b32 s30, s45, 2
  s_min_u32 s41, s29, 26
  v_and_b32 v1, 15, v0
  v_lshrrev_b32 v2, 4, v0
  v_bfe_u32 v3, v0, 2, 2
  v_and_b32 v4, 3, v0
  v_lshlrev_b32 v8, 2, v2
  v_xor_b32 v8, v8, v1
  v_lshlrev_b32 v8, 4, v8
  v_lshl_add_u32 v214, v2, 13, v8
  v_lshrrev_b32 v8, 3, v0
  v_bfe_u32 v10, v0, 4, 1
  v_lshlrev_b32 v10, 2, v10
  v_and_b32 v11, 7, v0
  v_xor_b32 v10, v10, v11
  v_lshlrev_b32 v10, 4, v10
  v_mul_u32_u24 v8, 3456, v8
  v_add_u32 v215, v8, v10
  s_lshl_b32 s44, s30, 4
  s_lshl_b32 s45, s28, 2
  s_add_u32 s44, s44, s45
  s_mul_i32 s45, s44, 20480
  v_lshl_add_u32 v200, v0, 4, s45
  s_mul_i32 s45, s44, 186368
  v_lshl_add_u32 v201, v0, 4, s45
  s_lshl_b32 s44, s28, 12
  s_add_u32 s32, s44, 0
  s_lshl_b32 s44, s28, 12
  s_add_u32 s33, s44, 16384
  s_lshl_b32 s44, s28, 12
  s_add_u32 s34, s44, 32768
  s_lshl_b32 s44, s28, 12
  s_add_u32 s35, s44, 49152
  s_waitcnt lgkmcnt(0)
  s_lshl_b32 s44, s29, 19
  s_add_u32 s48, s48, s44
  s_addc_u32 s49, s49, 0
  s_add_u32 s50, s50, s44
  s_addc_u32 s51, s51, 0
  s_mov_b32 s4, s48
  s_and_b32 s5, s49, 0xffff
  s_mov_b32 s6, 524288
  s_mov_b32 s7, 0x20000
  s_mov_b32 s8, s50
  s_and_b32 s9, s51, 0xffff
  s_mov_b32 s10, 524288
  s_mov_b32 s11, 0x20000
  s_mov_b32 s20, s52
  s_and_b32 s21, s53, 0xffff
  s_mov_b32 s22, 5242880
  s_mov_b32 s23, 0x20000
  s_mov_b32 s16, s54
  s_and_b32 s17, s55, 0xffff
  s_mov_b32 s18, 2211840
  s_mov_b32 s19, 0x20000
  s_mov_b32 s12, s56
  s_and_b32 s13, s57, 0xffff
  s_mov_b32 s14, 2621440
  s_mov_b32 s15, 0x20000
  s_add_u32 s56, s56, 3145728
  s_addc_u32 s57, s57, 0
  s_mov_b32 s24, s56
  s_and_b32 s25, s57, 0xffff
  s_mov_b32 s26, 23855104
  s_mov_b32 s27, 0x20000
  s_mov_b32 s36, 0
  s_mov_b32 s37, 0
  s_mov_b32 s40, 0
  s_mov_b32 s31, 0x42cc0000
  v_mov_b32 v232, 0xff800000
  v_mov_b32 v164, 0x3f803f80
  v_mov_b32 v233, 0xff800000
  v_mov_b32 v165, 0x3f803f80
  v_mov_b32 v234, 0xff800000
  v_mov_b32 v166, 0x3f803f80
  v_mov_b32 v235, 0xff800000
  v_mov_b32 v167, 0x3f803f80
  s_lshl_b32 s44, s28, 11
  s_add_u32 s60, s44, 114688
  s_mul_i32 s61, s28, 55296
  s_lshl_b32 s44, s41, 7
  s_add_u32 s61, s61, s44
  s_lshl_b32 s62, s28, 17
  s_lshl_b32 s44, s29, 8
  s_add_u32 s62, s62, s44
  s_cmp_lt_u32 s29, 27
  s_cselect_b32 s61, s61, 0x40000000
  s_mov_b32 s45, 0
  buffer_load_dwordx4 a[64:67], v200, s[12:15], s45 offen offset:0
  s_mov_b32 s45, 20480
  buffer_load_dwordx4 a[68:71], v200, s[12:15], s45 offen offset:0
  s_mov_b32 s45, 40960
  buffer_load_dwordx4 a[72:75], v200, s[12:15], s45 offen offset:0
  s_mov_b32 s45, 61440
  buffer_load_dwordx4 a[76:79], v200, s[12:15], s45 offen offset:0
  s_mov_b32 s45, 0
  buffer_load_dwordx4 a[80:83], v200, s[12:15], s45 offen offset:1024
  s_mov_b32 s45, 20480
  buffer_load_dwordx4 a[84:87], v200, s[12:15], s45 offen offset:1024
  s_mov_b32 s45, 40960
  buffer_load_dwordx4 a[88:91], v200, s[12:15], s45 offen offset:1024
  s_mov_b32 s45, 61440
  buffer_load_dwordx4 a[92:95], v200, s[12:15], s45 offen offset:1024
  s_add_u32 m0, s32, 0
  s_add_u32 s46, s62, 0
  buffer_load_dwordx4 v214, s[20:23], s46 offen lds
  s_add_u32 m0, s32, 1024
  s_add_u32 s46, s62, 32768
  buffer_load_dwordx4 v214, s[20:23], s46 offen lds
  s_add_u32 m0, s32, 2048
  s_add_u32 s46, s62, 65536
  buffer_load_dwordx4 v214, s[20:23], s46 offen lds
  s_add_u32 m0, s32, 3072
  s_add_u32 s46, s62, 98304
  buffer_load_dwordx4 v214, s[20:23], s46 offen lds
  s_add_u32 m0, s60, 16384
  s_add_u32 s46, s61, 0
  buffer_load_dwordx4 v215, s[16:19], s46 offen lds
  s_add_u32 m0, s60, 17408
  s_add_u32 s46, s61, 27648
  buffer_load_dwordx4 v215, s[16:19], s46 offen lds
  s_mov_b32 s45, 2048
  buffer_load_dwordx4 a[96:99], v200, s[12:15], s45 offen offset:0
  s_mov_b32 s45, 22528
  buffer_load_dwordx4 a[100:103], v200, s[12:15], s45 offen offset:0
  s_mov_b32 s45, 43008
  buffer_load_dwordx4 a[104:107], v200, s[12:15], s45 offen offset:0
  s_mov_b32 s45, 63488
  buffer_load_dwordx4 a[108:111], v200, s[12:15], s45 offen offset:0
  s_mov_b32 s45, 2048
  buffer_load_dwordx4 a[112:115], v200, s[12:15], s45 offen offset:1024
  s_mov_b32 s45, 22528
  buffer_load_dwordx4 a[116:119], v200, s[12:15], s45 offen offset:1024
  s_mov_b32 s45, 43008
  buffer_load_dwordx4 a[120:123], v200, s[12:15], s45 offen offset:1024
  s_mov_b32 s45, 63488
  buffer_load_dwordx4 a[124:127], v200, s[12:15], s45 offen offset:1024
  s_add_u32 m0, s32, 16384
  s_add_u32 s46, s62, 524288
  buffer_load_dwordx4 v214, s[20:23], s46 offen lds
  s_add_u32 m0, s32, 17408
  s_add_u32 s46, s62, 557056
  buffer_load_dwordx4 v214, s[20:23], s46 offen lds
  s_add_u32 m0, s32, 18432
  s_add_u32 s46, s62, 589824
  buffer_load_dwordx4 v214, s[20:23], s46 offen lds
  s_add_u32 m0, s32, 19456
  s_add_u32 s46, s62, 622592
  buffer_load_dwordx4 v214, s[20:23], s46 offen lds
  s_add_u32 m0, s60, 24576
  s_add_u32 s46, s61, 221184
  buffer_load_dwordx4 v215, s[16:19], s46 offen lds
  s_add_u32 m0, s60, 25600
  s_add_u32 s46, s61, 248832
  buffer_load_dwordx4 v215, s[16:19], s46 offen lds
  v_or_b32 v8, 0, v2
  v_xor_b32 v8, v8, v1
  v_lshlrev_b32 v8, 4, v8
  v_lshl_add_u32 v160, v1, 8, v8
  v_or_b32 v8, 4, v2
  v_xor_b32 v8, v8, v1
  v_lshlrev_b32 v8, 4, v8
  v_lshl_add_u32 v161, v1, 8, v8
  v_or_b32 v8, 8, v2
  v_xor_b32 v8, v8, v1
  v_lshlrev_b32 v8, 4, v8
  v_lshl_add_u32 v162, v1, 8, v8
  v_or_b32 v8, 12, v2
  v_xor_b32 v8, v8, v1
  v_lshlrev_b32 v8, 4, v8
  v_lshl_add_u32 v163, v1, 8, v8
  v_lshl_add_u32 v5, v2, 2, v3
  v_and_b32 v6, 7, v5
  v_lshlrev_b32 v6, 1, v6
  v_lshrrev_b32 v7, 1, v4
  v_and_b32 v9, 1, v4
  v_lshlrev_b32 v9, 3, v9
  v_lshl_add_u32 v9, v7, 4, v9
  v_lshl_add_u32 v9, v5, 8, v9
  v_add_u32 v9, 0x10000, v9
  v_xor_b32 v8, 0, v6
  v_lshl_add_u32 v168, v8, 4, v9
  v_xor_b32 v8, 2, v6
  v_lshl_add_u32 v169, v8, 4, v9
  v_xor_b32 v8, 4, v6
  v_lshl_add_u32 v170, v8, 4, v9
  v_xor_b32 v8, 6, v6
  v_lshl_add_u32 v171, v8, 4, v9
  v_xor_b32 v8, 8, v6
  v_lshl_add_u32 v172, v8, 4, v9
  v_xor_b32 v8, 10, v6
  v_lshl_add_u32 v173, v8, 4, v9
  v_xor_b32 v8, 12, v6
  v_lshl_add_u32 v174, v8, 4, v9
  v_xor_b32 v8, 14, v6
  v_lshl_add_u32 v175, v8, 4, v9
  v_lshl_add_u32 v5, v2, 3, v3
  v_lshlrev_b32 v9, 4, v4
  v_lshl_add_u32 v9, v5, 8, v9
  v_xor_b32 v8, 0, v3
  v_lshl_add_u32 v8, v8, 6, v9
  v_add_u32 v202, 0, v8
  v_add_u32 v240, 0x10000, v202
  v_xor_b32 v8, 0, v3
  v_lshl_add_u32 v8, v8, 6, v9
  v_add_u32 v203, 8, v8
  v_add_u32 v241, 0x10000, v203
  v_xor_b32 v8, 1, v3
  v_lshl_add_u32 v8, v8, 6, v9
  v_add_u32 v204, 0, v8
  v_add_u32 v242, 0x10000, v204
  v_xor_b32 v8, 1, v3
  v_lshl_add_u32 v8, v8, 6, v9
  v_add_u32 v205, 8, v8
  v_add_u32 v243, 0x10000, v205
  v_xor_b32 v8, 2, v3
  v_lshl_add_u32 v8, v8, 6, v9
  v_add_u32 v206, 0, v8
  v_add_u32 v244, 0x10000, v206
  v_xor_b32 v8, 2, v3
  v_lshl_add_u32 v8, v8, 6, v9
  v_add_u32 v207, 8, v8
  v_add_u32 v245, 0x10000, v207
  v_xor_b32 v8, 3, v3
  v_lshl_add_u32 v8, v8, 6, v9
  v_add_u32 v208, 0, v8
  v_add_u32 v246, 0x10000, v208
  v_xor_b32 v8, 3, v3
  v_lshl_add_u32 v8, v8, 6, v9
  v_add_u32 v209, 8, v8
  v_add_u32 v247, 0x10000, v209
  v_lshlrev_b32 v9, 3, v4
  v_lshl_add_u32 v9, v5, 7, v9
  v_add_u32 v9, 0x1c000, v9
  v_lshrrev_b32 v7, 1, v3
  v_xor_b32 v8, 0, v7
  v_lshl_add_u32 v8, v8, 6, v9
  v_add_u32 v210, 0, v8
  v_xor_b32 v8, 0, v7
  v_lshl_add_u32 v8, v8, 6, v9
  v_add_u32 v211, 32, v8
  v_xor_b32 v8, 1, v7
  v_lshl_add_u32 v8, v8, 6, v9
  v_add_u32 v212, 0, v8
  v_xor_b32 v8, 1, v7
  v_lshl_add_u32 v8, v8, 6, v9
  v_add_u32 v213, 32, v8
  s_lshl_b32 s44, s28, 12
  v_add_u32 v8, 0, v2
  v_xor_b32 v8, v8, v1
  v_lshlrev_b32 v8, 4, v8
  v_lshl_add_u32 v8, v2, 8, v8
  v_add_u32 v176, s44, v8
  v_add_u32 v8, 4, v2
  v_xor_b32 v8, v8, v1
  v_lshlrev_b32 v8, 4, v8
  v_lshl_add_u32 v8, v2, 8, v8
  v_add_u32 v177, s44, v8
  v_add_u32 v8, 8, v2
  v_xor_b32 v8, v8, v1
  v_lshlrev_b32 v8, 4, v8
  v_lshl_add_u32 v8, v2, 8, v8
  v_add_u32 v178, s44, v8
  v_add_u32 v8, 12, v2
  v_xor_b32 v8, v8, v1
  v_lshlrev_b32 v8, 4, v8
  v_lshl_add_u32 v8, v2, 8, v8
  v_add_u32 v179, s44, v8
  v_add_u32 v8, 0, v2
  v_lshlrev_b32 v8, 1, v8
  v_xor_b32 v8, v8, v1
  v_lshlrev_b32 v8, 4, v8
  v_lshl_add_u32 v8, v2, 8, v8
  v_add_u32 v180, s44, v8
  v_add_u32 v8, 4, v2
  v_lshlrev_b32 v8, 1, v8
  v_xor_b32 v8, v8, v1
  v_lshlrev_b32 v8, 4, v8
  v_lshl_add_u32 v8, v2, 8, v8
  v_add_u32 v181, s44, v8
  s_load_dwordx2 s[48:49], s[0:1], 32
  s_load_dwordx2 s[50:51], s[0:1], 56
  s_load_dwordx2 s[52:53], s[0:1], 80
  v_lshrrev_b32 v8, 3, v0
  v_mul_u32_u24 v8, 1280, v8
  v_and_b32 v10, 7, v0
  v_lshl_add_u32 v236, v10, 4, v8
  s_lshl_b32 s63, s28, 12
  s_add_u32 s63, s63, 0x18000
  v_lshrrev_b32 v8, 4, v0
  v_lshlrev_b32 v8, 2, v8
  v_bfe_u32 v10, v0, 2, 2
  v_add_u32 v8, v8, v10
  v_lshlrev_b32 v8, 7, v8
  v_and_b32 v10, 3, v0
  v_lshl_add_u32 v8, v10, 3, v8
  v_add_u32 v237, s63, v8
  v_lshlrev_b32 v238, 4, v0
  s_waitcnt lgkmcnt(0)
  s_add_u32 s52, s52, 33554432
  s_addc_u32 s53, s53, 0
  s_mov_b32 s88, s52
  s_and_b32 s89, s53, 0xffff
  s_mov_b32 s90, 7454720
  s_mov_b32 s91, 0x20000
  s_lshl_b32 s44, s2, 2
  s_add_u32 s44, s44, s28
  s_lshl_b32 s44, s44, 1
  s_add_u32 s44, s44, 0
  s_mul_i32 s45, s44, 52429
  s_lshr_b32 s45, s45, 19
  s_mul_i32 s46, s45, 10
  s_sub_u32 s46, s44, s46
  s_cmp_lt_u32 s45, 128
  s_cselect_b32 s80, s48, s50
  s_cselect_b32 s81, s49, s51
  s_mov_b32 s82, 2211840
  s_cselect_b32 s82, 5242880, s82
  s_cselect_b32 s47, 0, 128
  s_and_b32 s81, s81, 0xffff
  s_mov_b32 s83, 0x20000
  s_sub_u32 s47, s45, s47
  s_mul_i32 s47, s47, 40960
  s_lshl_b32 s54, s46, 7
  s_add_u32 s92, s47, s54
  s_mul_i32 s46, s46, 745472
  s_lshl_b32 s45, s45, 10
  s_add_u32 s94, s46, s45
  s_cmp_lt_u32 s44, 1820
  s_cselect_b32 s92, s92, 0x40000000
  s_cselect_b32 s94, s94, 0x40000000
  s_lshl_b32 s44, s2, 2
  s_add_u32 s44, s44, s28
  s_lshl_b32 s44, s44, 1
  s_add_u32 s44, s44, 1
  s_mul_i32 s45, s44, 52429
  s_lshr_b32 s45, s45, 19
  s_mul_i32 s46, s45, 10
  s_sub_u32 s46, s44, s46
  s_cmp_lt_u32 s45, 128
  s_cselect_b32 s84, s48, s50
  s_cselect_b32 s85, s49, s51
  s_mov_b32 s86, 2211840
  s_cselect_b32 s86, 5242880, s86
  s_cselect_b32 s47, 0, 128
  s_and_b32 s85, s85, 0xffff
  s_mov_b32 s87, 0x20000
  s_sub_u32 s47, s45, s47
  s_mul_i32 s47, s47, 40960
  s_lshl_b32 s54, s46, 7
  s_add_u32 s93, s47, s54
  s_mul_i32 s46, s46, 745472
  s_lshl_b32 s45, s45, 10
  s_add_u32 s95, s46, s45
  s_cmp_lt_u32 s44, 1820
  s_cselect_b32 s93, s93, 0x40000000
  s_cselect_b32 s95, s95, 0x40000000
  s_waitcnt vmcnt(14)
  s_barrier
  ds_read_b64_tr_b16 a[224:225], v202 offset:0
  ds_read_b64_tr_b16 a[226:227], v202 offset:1024
  ds_read_b64_tr_b16 a[228:229], v203 offset:0
  ds_read_b64_tr_b16 a[230:231], v203 offset:1024
  ds_read_b64_tr_b16 a[232:233], v204 offset:0
  ds_read_b64_tr_b16 a[234:235], v204 offset:1024
  ds_read_b64_tr_b16 a[236:237], v205 offset:0
  ds_read_b64_tr_b16 a[238:239], v205 offset:1024
  s_waitcnt lgkmcnt(4)
  v_mfma_f32_16x16x32_bf16 v[0:3], a[224:227], a[64:67], 0
  ds_read_b64_tr_b16 a[240:241], v206 offset:0
  v_mfma_f32_16x16x32_bf16 v[32:35], a[224:227], a[68:71], 0
  s_add_u32 m0, s32, 32768
  s_add_u32 s46, s62, 1048576
  buffer_load_dwordx4 v214, s[20:23], s46 offen lds
  v_mfma_f32_16x16x32_bf16 v[64:67], a[224:227], a[72:75], 0
  ds_read_b64_tr_b16 a[242:243], v206 offset:1024
  v_mfma_f32_16x16x32_bf16 v[96:99], a[224:227], a[76:79], 0
  v_mfma_f32_16x16x32_bf16 v[4:7], a[228:231], a[64:67], 0
  ds_read_b64_tr_b16 a[244:245], v207 offset:0
  s_add_u32 m0, s32, 33792
  s_add_u32 s46, s62, 1081344
  buffer_load_dwordx4 v214, s[20:23], s46 offen lds
  v_mfma_f32_16x16x32_bf16 v[36:39], a[228:231], a[68:71], 0
  v_mfma_f32_16x16x32_bf16 v[68:71], a[228:231], a[72:75], 0
  ds_read_b64_tr_b16 a[246:247], v207 offset:1024
  v_mfma_f32_16x16x32_bf16 v[100:103], a[228:231], a[76:79], 0
  s_add_u32 m0, s32, 34816
  s_add_u32 s46, s62, 1114112
  buffer_load_dwordx4 v214, s[20:23], s46 offen lds
  s_waitcnt lgkmcnt(4)
  v_mfma_f32_16x16x32_bf16 v[8:11], a[232:235], a[64:67], 0
  ds_read_b64_tr_b16 a[248:249], v208 offset:0
  v_mfma_f32_16x16x32_bf16 v[40:43], a[232:235], a[68:71], 0
  v_mfma_f32_16x16x32_bf16 v[72:75], a[232:235], a[72:75], 0
  ds_read_b64_tr_b16 a[250:251], v208 offset:1024
  s_add_u32 m0, s32, 35840
  s_add_u32 s46, s62, 1146880
  buffer_load_dwordx4 v214, s[20:23], s46 offen lds
  v_mfma_f32_16x16x32_bf16 v[104:107], a[232:235], a[76:79], 0
  v_mfma_f32_16x16x32_bf16 v[12:15], a[236:239], a[64:67], 0
  ds_read_b64_tr_b16 a[252:253], v209 offset:0
  v_mfma_f32_16x16x32_bf16 v[44:47], a[236:239], a[68:71], 0
  s_add_u32 m0, s60, 32768
  s_add_u32 s46, s61, 442368
  buffer_load_dwordx4 v215, s[16:19], s46 offen lds
  v_mfma_f32_16x16x32_bf16 v[76:79], a[236:239], a[72:75], 0
  ds_read_b64_tr_b16 a[254:255], v209 offset:1024
  v_mfma_f32_16x16x32_bf16 v[108:111], a[236:239], a[76:79], 0
  s_waitcnt lgkmcnt(4)
  v_mfma_f32_16x16x32_bf16 v[16:19], a[240:243], a[64:67], 0
  ds_read_b64_tr_b16 a[224:225], v210 offset:16384
  s_add_u32 m0, s60, 33792
  s_add_u32 s46, s61, 470016
  buffer_load_dwordx4 v215, s[16:19], s46 offen lds
  v_mfma_f32_16x16x32_bf16 v[48:51], a[240:243], a[68:71], 0
  v_mfma_f32_16x16x32_bf16 v[80:83], a[240:243], a[72:75], 0
  ds_read_b64_tr_b16 a[226:227], v210 offset:16896
  v_mfma_f32_16x16x32_bf16 v[112:115], a[240:243], a[76:79], 0
  s_mov_b32 s45, 4096
  buffer_load_dwordx4 a[128:131], v200, s[12:15], s45 offen offset:0
  v_mfma_f32_16x16x32_bf16 v[20:23], a[244:247], a[64:67], 0
  ds_read_b64_tr_b16 a[228:229], v211 offset:16384
  v_mfma_f32_16x16x32_bf16 v[52:55], a[244:247], a[68:71], 0
  v_mfma_f32_16x16x32_bf16 v[84:87], a[244:247], a[72:75], 0
  ds_read_b64_tr_b16 a[230:231], v211 offset:16896
  s_mov_b32 s45, 24576
  buffer_load_dwordx4 a[132:135], v200, s[12:15], s45 offen offset:0
  v_mfma_f32_16x16x32_bf16 v[116:119], a[244:247], a[76:79], 0
  s_waitcnt lgkmcnt(4)
  v_mfma_f32_16x16x32_bf16 v[24:27], a[248:251], a[64:67], 0
  ds_read_b64_tr_b16 a[232:233], v212 offset:16384
  v_mfma_f32_16x16x32_bf16 v[56:59], a[248:251], a[68:71], 0
  s_mov_b32 s45, 45056
  buffer_load_dwordx4 a[136:139], v200, s[12:15], s45 offen offset:0
  v_mfma_f32_16x16x32_bf16 v[88:91], a[248:251], a[72:75], 0
  ds_read_b64_tr_b16 a[234:235], v212 offset:16896
  v_mfma_f32_16x16x32_bf16 v[120:123], a[248:251], a[76:79], 0
  v_mfma_f32_16x16x32_bf16 v[28:31], a[252:255], a[64:67], 0
  ds_read_b64_tr_b16 a[236:237], v213 offset:16384
  s_mov_b32 s45, 65536
  buffer_load_dwordx4 a[140:143], v200, s[12:15], s45 offen offset:0
  v_mfma_f32_16x16x32_bf16 v[60:63], a[252:255], a[68:71], 0
  v_mfma_f32_16x16x32_bf16 v[92:95], a[252:255], a[72:75], 0
  ds_read_b64_tr_b16 a[238:239], v213 offset:16896
  v_mfma_f32_16x16x32_bf16 v[124:127], a[252:255], a[76:79], 0
  s_mov_b32 s45, 4096
  buffer_load_dwordx4 a[144:147], v200, s[12:15], s45 offen offset:1024
  s_waitcnt lgkmcnt(4)
  v_mfma_f32_16x16x32_bf16 a[0:3], a[224:227], a[64:67], 0
  ds_read_b64_tr_b16 a[240:241], v202 offset:8192
  v_mfma_f32_16x16x32_bf16 a[16:19], a[224:227], a[68:71], 0
  v_mfma_f32_16x16x32_bf16 a[32:35], a[224:227], a[72:75], 0
  ds_read_b64_tr_b16 a[242:243], v202 offset:9216
  s_mov_b32 s45, 24576
  buffer_load_dwordx4 a[148:151], v200, s[12:15], s45 offen offset:1024
  v_mfma_f32_16x16x32_bf16 a[48:51], a[224:227], a[76:79], 0
  v_mfma_f32_16x16x32_bf16 a[4:7], a[228:231], a[64:67], 0
  ds_read_b64_tr_b16 a[244:245], v203 offset:8192
  v_mfma_f32_16x16x32_bf16 a[20:23], a[228:231], a[68:71], 0
  s_mov_b32 s45, 45056
  buffer_load_dwordx4 a[152:155], v200, s[12:15], s45 offen offset:1024
  v_mfma_f32_16x16x32_bf16 a[36:39], a[228:231], a[72:75], 0
  ds_read_b64_tr_b16 a[246:247], v203 offset:9216
  v_mfma_f32_16x16x32_bf16 a[52:55], a[228:231], a[76:79], 0
  s_waitcnt lgkmcnt(4)
  v_mfma_f32_16x16x32_bf16 a[8:11], a[232:235], a[64:67], 0
  ds_read_b64_tr_b16 a[248:249], v204 offset:8192
  s_mov_b32 s45, 65536
  buffer_load_dwordx4 a[156:159], v200, s[12:15], s45 offen offset:1024
  v_mfma_f32_16x16x32_bf16 a[24:27], a[232:235], a[68:71], 0
  v_mfma_f32_16x16x32_bf16 a[40:43], a[232:235], a[72:75], 0
  ds_read_b64_tr_b16 a[250:251], v204 offset:9216
  v_mfma_f32_16x16x32_bf16 a[56:59], a[232:235], a[76:79], 0
  s_add_u32 m0, s32, 49152
  s_add_u32 s46, s62, 1572864
  buffer_load_dwordx4 v214, s[20:23], s46 offen lds
  v_mfma_f32_16x16x32_bf16 a[12:15], a[236:239], a[64:67], 0
  ds_read_b64_tr_b16 a[252:253], v205 offset:8192
  v_mfma_f32_16x16x32_bf16 a[28:31], a[236:239], a[68:71], 0
  v_mfma_f32_16x16x32_bf16 a[44:47], a[236:239], a[72:75], 0
  ds_read_b64_tr_b16 a[254:255], v205 offset:9216
  s_add_u32 m0, s32, 50176
  s_add_u32 s46, s62, 1605632
  buffer_load_dwordx4 v214, s[20:23], s46 offen lds
  v_mfma_f32_16x16x32_bf16 a[60:63], a[236:239], a[76:79], 0
  s_mov_b32 s45, 8192
  buffer_load_dwordx4 a[64:67], v200, s[12:15], s45 offen offset:0
  s_waitcnt lgkmcnt(4)
  v_mfma_f32_16x16x32_bf16 v[0:3], a[240:243], a[80:83], v[0:3]
  ds_read_b64_tr_b16 a[224:225], v206 offset:8192
  v_mfma_f32_16x16x32_bf16 v[32:35], a[240:243], a[84:87], v[32:35]
  s_add_u32 m0, s32, 51200
  s_add_u32 s46, s62, 1638400
  buffer_load_dwordx4 v214, s[20:23], s46 offen lds
  v_mfma_f32_16x16x32_bf16 v[64:67], a[240:243], a[88:91], v[64:67]
  ds_read_b64_tr_b16 a[226:227], v206 offset:9216
  v_mfma_f32_16x16x32_bf16 v[96:99], a[240:243], a[92:95], v[96:99]
  v_mfma_f32_16x16x32_bf16 v[4:7], a[244:247], a[80:83], v[4:7]
  s_mov_b32 s45, 28672
  buffer_load_dwordx4 a[68:71], v200, s[12:15], s45 offen offset:0
  ds_read_b64_tr_b16 a[228:229], v207 offset:8192
  s_add_u32 m0, s32, 52224
  s_add_u32 s46, s62, 1671168
  buffer_load_dwordx4 v214, s[20:23], s46 offen lds
  v_mfma_f32_16x16x32_bf16 v[36:39], a[244:247], a[84:87], v[36:39]
  v_mfma_f32_16x16x32_bf16 v[68:71], a[244:247], a[88:91], v[68:71]
  ds_read_b64_tr_b16 a[230:231], v207 offset:9216
  v_mfma_f32_16x16x32_bf16 v[100:103], a[244:247], a[92:95], v[100:103]
  s_add_u32 m0, s60, 40960
  s_add_u32 s46, s61, 663552
  buffer_load_dwordx4 v215, s[16:19], s46 offen lds
  s_waitcnt lgkmcnt(4)
  v_mfma_f32_16x16x32_bf16 v[8:11], a[248:251], a[80:83], v[8:11]
  ds_read_b64_tr_b16 a[232:233], v208 offset:8192
  v_mfma_f32_16x16x32_bf16 v[40:43], a[248:251], a[84:87], v[40:43]
  s_mov_b32 s45, 49152
  buffer_load_dwordx4 a[72:75], v200, s[12:15], s45 offen offset:0
  v_mfma_f32_16x16x32_bf16 v[72:75], a[248:251], a[88:91], v[72:75]
  ds_read_b64_tr_b16 a[234:235], v208 offset:9216
  s_add_u32 m0, s60, 41984
  s_add_u32 s46, s61, 691200
  buffer_load_dwordx4 v215, s[16:19], s46 offen lds
  v_mfma_f32_16x16x32_bf16 v[104:107], a[248:251], a[92:95], v[104:107]
  v_mfma_f32_16x16x32_bf16 v[12:15], a[252:255], a[80:83], v[12:15]
  ds_read_b64_tr_b16 a[236:237], v209 offset:8192
  v_mfma_f32_16x16x32_bf16 v[44:47], a[252:255], a[84:87], v[44:47]
  s_mov_b32 s45, 6144
  buffer_load_dwordx4 a[160:163], v200, s[12:15], s45 offen offset:0
  v_mfma_f32_16x16x32_bf16 v[76:79], a[252:255], a[88:91], v[76:79]
  s_mov_b32 s45, 69632
  buffer_load_dwordx4 a[76:79], v200, s[12:15], s45 offen offset:0
  ds_read_b64_tr_b16 a[238:239], v209 offset:9216
  v_mfma_f32_16x16x32_bf16 v[108:111], a[252:255], a[92:95], v[108:111]
  s_waitcnt lgkmcnt(4)
  v_mfma_f32_16x16x32_bf16 v[16:19], a[224:227], a[80:83], v[16:19]
  ds_read_b64_tr_b16 a[240:241], v210 offset:20480
  s_mov_b32 s45, 26624
  buffer_load_dwordx4 a[164:167], v200, s[12:15], s45 offen offset:0
  v_mfma_f32_16x16x32_bf16 v[48:51], a[224:227], a[84:87], v[48:51]
  v_mfma_f32_16x16x32_bf16 v[80:83], a[224:227], a[88:91], v[80:83]
  ds_read_b64_tr_b16 a[242:243], v210 offset:20992
  v_mfma_f32_16x16x32_bf16 v[112:115], a[224:227], a[92:95], v[112:115]
  s_mov_b32 s45, 47104
  buffer_load_dwordx4 a[168:171], v200, s[12:15], s45 offen offset:0
  v_mfma_f32_16x16x32_bf16 v[20:23], a[228:231], a[80:83], v[20:23]
  ds_read_b64_tr_b16 a[244:245], v211 offset:20480
  v_mfma_f32_16x16x32_bf16 v[52:55], a[228:231], a[84:87], v[52:55]
  v_mfma_f32_16x16x32_bf16 v[84:87], a[228:231], a[88:91], v[84:87]
  ds_read_b64_tr_b16 a[246:247], v211 offset:20992
  s_mov_b32 s45, 67584
  buffer_load_dwordx4 a[172:175], v200, s[12:15], s45 offen offset:0
  v_mfma_f32_16x16x32_bf16 v[116:119], a[228:231], a[92:95], v[116:119]
  s_waitcnt lgkmcnt(4)
  v_mfma_f32_16x16x32_bf16 v[24:27], a[232:235], a[80:83], v[24:27]
  ds_read_b64_tr_b16 a[248:249], v212 offset:20480
  v_mfma_f32_16x16x32_bf16 v[56:59], a[232:235], a[84:87], v[56:59]
  s_mov_b32 s45, 6144
  buffer_load_dwordx4 a[176:179], v200, s[12:15], s45 offen offset:1024
  v_mfma_f32_16x16x32_bf16 v[88:91], a[232:235], a[88:91], v[88:91]
  ds_read_b64_tr_b16 a[250:251], v212 offset:20992
  v_mfma_f32_16x16x32_bf16 v[120:123], a[232:235], a[92:95], v[120:123]
  v_mfma_f32_16x16x32_bf16 v[28:31], a[236:239], a[80:83], v[28:31]
  ds_read_b64_tr_b16 a[252:253], v213 offset:20480
  s_mov_b32 s45, 26624
  buffer_load_dwordx4 a[180:183], v200, s[12:15], s45 offen offset:1024
  v_mfma_f32_16x16x32_bf16 v[60:63], a[236:239], a[84:87], v[60:63]
  v_mfma_f32_16x16x32_bf16 v[92:95], a[236:239], a[88:91], v[92:95]
  ds_read_b64_tr_b16 a[254:255], v213 offset:20992
  v_mfma_f32_16x16x32_bf16 v[124:127], a[236:239], a[92:95], v[124:127]
  s_waitcnt vmcnt(30)
  s_barrier
  s_mov_b32 s45, 47104
  buffer_load_dwordx4 a[184:187], v200, s[12:15], s45 offen offset:1024
  s_waitcnt lgkmcnt(4)
  v_mfma_f32_16x16x32_bf16 a[0:3], a[240:243], a[80:83], a[0:3]
  ds_read_b64_tr_b16 a[224:225], v202 offset:16384
  v_mfma_f32_16x16x32_bf16 a[16:19], a[240:243], a[84:87], a[16:19]
  v_mfma_f32_16x16x32_bf16 a[32:35], a[240:243], a[88:91], a[32:35]
  ds_read_b64_tr_b16 a[226:227], v202 offset:17408
  s_mov_b32 s45, 67584
  buffer_load_dwordx4 a[188:191], v200, s[12:15], s45 offen offset:1024
  v_mfma_f32_16x16x32_bf16 a[48:51], a[240:243], a[92:95], a[48:51]
  v_mfma_f32_16x16x32_bf16 a[4:7], a[244:247], a[80:83], a[4:7]
  ds_read_b64_tr_b16 a[228:229], v203 offset:16384
  v_mfma_f32_16x16x32_bf16 a[20:23], a[244:247], a[84:87], a[20:23]
  v_mfma_f32_16x16x32_bf16 a[36:39], a[244:247], a[88:91], a[36:39]
  ds_read_b64_tr_b16 a[230:231], v203 offset:17408
  v_mfma_f32_16x16x32_bf16 a[52:55], a[244:247], a[92:95], a[52:55]
  s_waitcnt lgkmcnt(4)
  v_mfma_f32_16x16x32_bf16 a[8:11], a[248:251], a[80:83], a[8:11]
  ds_read_b64_tr_b16 a[232:233], v204 offset:16384
  s_add_u32 m0, s32, 65536
  s_add_u32 s46, s62, 2097152
  buffer_load_dwordx4 v214, s[20:23], s46 offen lds
  v_mfma_f32_16x16x32_bf16 a[24:27], a[248:251], a[84:87], a[24:27]
  v_mfma_f32_16x16x32_bf16 a[40:43], a[248:251], a[88:91], a[40:43]
  ds_read_b64_tr_b16 a[234:235], v204 offset:17408
  v_mfma_f32_16x16x32_bf16 a[56:59], a[248:251], a[92:95], a[56:59]
  v_mfma_f32_16x16x32_bf16 a[12:15], a[252:255], a[80:83], a[12:15]
  ds_read_b64_tr_b16 a[236:237], v205 offset:16384
  s_add_u32 m0, s32, 66560
  s_add_u32 s46, s62, 2129920
  buffer_load_dwordx4 v214, s[20:23], s46 offen lds
  v_mfma_f32_16x16x32_bf16 a[28:31], a[252:255], a[84:87], a[28:31]
  v_mfma_f32_16x16x32_bf16 a[44:47], a[252:255], a[88:91], a[44:47]
  ds_read_b64_tr_b16 a[238:239], v205 offset:17408
  v_mfma_f32_16x16x32_bf16 a[60:63], a[252:255], a[92:95], a[60:63]
  s_mov_b32 s45, 8192
  buffer_load_dwordx4 a[80:83], v200, s[12:15], s45 offen offset:1024
  s_waitcnt lgkmcnt(4)
  v_mfma_f32_16x16x32_bf16 v[0:3], a[224:227], a[96:99], v[0:3]
  ds_read_b64_tr_b16 a[240:241], v206 offset:16384
  s_add_u32 m0, s32, 67584
  s_add_u32 s46, s62, 2162688
  buffer_load_dwordx4 v214, s[20:23], s46 offen lds
  v_mfma_f32_16x16x32_bf16 v[32:35], a[224:227], a[100:103], v[32:35]
  v_mfma_f32_16x16x32_bf16 v[64:67], a[224:227], a[104:107], v[64:67]
  ds_read_b64_tr_b16 a[242:243], v206 offset:17408
  v_mfma_f32_16x16x32_bf16 v[96:99], a[224:227], a[108:111], v[96:99]
  v_mfma_f32_16x16x32_bf16 v[4:7], a[228:231], a[96:99], v[4:7]
  s_mov_b32 s45, 28672
  buffer_load_dwordx4 a[84:87], v200, s[12:15], s45 offen offset:1024
  ds_read_b64_tr_b16 a[244:245], v207 offset:16384
  s_add_u32 m0, s32, 68608
  s_add_u32 s46, s62, 2195456
  buffer_load_dwordx4 v214, s[20:23], s46 offen lds
  v_mfma_f32_16x16x32_bf16 v[36:39], a[228:231], a[100:103], v[36:39]
  v_mfma_f32_16x16x32_bf16 v[68:71], a[228:231], a[104:107], v[68:71]
  ds_read_b64_tr_b16 a[246:247], v207 offset:17408
  v_mfma_f32_16x16x32_bf16 v[100:103], a[228:231], a[108:111], v[100:103]
  s_waitcnt lgkmcnt(4)
  v_mfma_f32_16x16x32_bf16 v[8:11], a[232:235], a[96:99], v[8:11]
  ds_read_b64_tr_b16 a[248:249], v208 offset:16384
  s_add_u32 m0, s60, 0
  s_add_u32 s46, s61, 884736
  buffer_load_dwordx4 v215, s[16:19], s46 offen lds
  v_mfma_f32_16x16x32_bf16 v[40:43], a[232:235], a[100:103], v[40:43]
  s_mov_b32 s45, 49152
  buffer_load_dwordx4 a[88:91], v200, s[12:15], s45 offen offset:1024
  v_mfma_f32_16x16x32_bf16 v[72:75], a[232:235], a[104:107], v[72:75]
  ds_read_b64_tr_b16 a[250:251], v208 offset:17408
  v_mfma_f32_16x16x32_bf16 v[104:107], a[232:235], a[108:111], v[104:107]
  v_mfma_f32_16x16x32_bf16 v[12:15], a[236:239], a[96:99], v[12:15]
  ds_read_b64_tr_b16 a[252:253], v209 offset:16384
  s_add_u32 m0, s60, 1024
  s_add_u32 s46, s61, 912384
  buffer_load_dwordx4 v215, s[16:19], s46 offen lds
  v_mfma_f32_16x16x32_bf16 v[44:47], a[236:239], a[100:103], v[44:47]
  v_mfma_f32_16x16x32_bf16 v[76:79], a[236:239], a[104:107], v[76:79]
  s_mov_b32 s45, 69632
  buffer_load_dwordx4 a[92:95], v200, s[12:15], s45 offen offset:1024
  ds_read_b64_tr_b16 a[254:255], v209 offset:17408
  v_mfma_f32_16x16x32_bf16 v[108:111], a[236:239], a[108:111], v[108:111]
  s_waitcnt lgkmcnt(4)
  v_mfma_f32_16x16x32_bf16 v[16:19], a[240:243], a[96:99], v[16:19]
  ds_read_b64_tr_b16 a[224:225], v210 offset:24576
  s_add_u32 m0, s32, 81920
  s_add_u32 s46, s62, 2621440
  buffer_load_dwordx4 v214, s[20:23], s46 offen lds
  v_mfma_f32_16x16x32_bf16 v[48:51], a[240:243], a[100:103], v[48:51]
  v_mfma_f32_16x16x32_bf16 v[80:83], a[240:243], a[104:107], v[80:83]
  ds_read_b64_tr_b16 a[226:227], v210 offset:25088
  v_mfma_f32_16x16x32_bf16 v[112:115], a[240:243], a[108:111], v[112:115]
  v_mfma_f32_16x16x32_bf16 v[20:23], a[244:247], a[96:99], v[20:23]
  ds_read_b64_tr_b16 a[228:229], v211 offset:24576
  s_add_u32 m0, s32, 82944
  s_add_u32 s46, s62, 2654208
  buffer_load_dwordx4 v214, s[20:23], s46 offen lds
  v_mfma_f32_16x16x32_bf16 v[52:55], a[244:247], a[100:103], v[52:55]
  v_mfma_f32_16x16x32_bf16 v[84:87], a[244:247], a[104:107], v[84:87]
  ds_read_b64_tr_b16 a[230:231], v211 offset:25088
  v_mfma_f32_16x16x32_bf16 v[116:119], a[244:247], a[108:111], v[116:119]
  s_waitcnt lgkmcnt(4)
  v_mfma_f32_16x16x32_bf16 v[24:27], a[248:251], a[96:99], v[24:27]
  ds_read_b64_tr_b16 a[232:233], v212 offset:24576
  s_add_u32 m0, s32, 83968
  s_add_u32 s46, s62, 2686976
  buffer_load_dwordx4 v214, s[20:23], s46 offen lds
  v_mfma_f32_16x16x32_bf16 v[56:59], a[248:251], a[100:103], v[56:59]
  v_mfma_f32_16x16x32_bf16 v[88:91], a[248:251], a[104:107], v[88:91]
  ds_read_b64_tr_b16 a[234:235], v212 offset:25088
  v_mfma_f32_16x16x32_bf16 v[120:123], a[248:251], a[108:111], v[120:123]
  v_mfma_f32_16x16x32_bf16 v[28:31], a[252:255], a[96:99], v[28:31]
  ds_read_b64_tr_b16 a[236:237], v213 offset:24576
  s_add_u32 m0, s32, 84992
  s_add_u32 s46, s62, 2719744
  buffer_load_dwordx4 v214, s[20:23], s46 offen lds
  v_mfma_f32_16x16x32_bf16 v[60:63], a[252:255], a[100:103], v[60:63]
  v_mfma_f32_16x16x32_bf16 v[92:95], a[252:255], a[104:107], v[92:95]
  ds_read_b64_tr_b16 a[238:239], v213 offset:25088
  v_mfma_f32_16x16x32_bf16 v[124:127], a[252:255], a[108:111], v[124:127]
  s_waitcnt lgkmcnt(4)
  v_mfma_f32_16x16x32_bf16 a[0:3], a[224:227], a[96:99], a[0:3]
  ds_read_b64_tr_b16 a[240:241], v202 offset:24576
  s_add_u32 m0, s60, 8192
  s_add_u32 s46, s61, 1105920
  buffer_load_dwordx4 v215, s[16:19], s46 offen lds
  v_mfma_f32_16x16x32_bf16 a[16:19], a[224:227], a[100:103], a[16:19]
  v_mfma_f32_16x16x32_bf16 a[32:35], a[224:227], a[104:107], a[32:35]
  ds_read_b64_tr_b16 a[242:243], v202 offset:25600
  v_mfma_f32_16x16x32_bf16 a[48:51], a[224:227], a[108:111], a[48:51]
  v_mfma_f32_16x16x32_bf16 a[4:7], a[228:231], a[96:99], a[4:7]
  ds_read_b64_tr_b16 a[244:245], v203 offset:24576
  s_add_u32 m0, s60, 9216
  s_add_u32 s46, s61, 1133568
  buffer_load_dwordx4 v215, s[16:19], s46 offen lds
  v_mfma_f32_16x16x32_bf16 a[20:23], a[228:231], a[100:103], a[20:23]
  v_mfma_f32_16x16x32_bf16 a[36:39], a[228:231], a[104:107], a[36:39]
  ds_read_b64_tr_b16 a[246:247], v203 offset:25600
  v_mfma_f32_16x16x32_bf16 a[52:55], a[228:231], a[108:111], a[52:55]
  s_waitcnt lgkmcnt(4)
  v_mfma_f32_16x16x32_bf16 a[8:11], a[232:235], a[96:99], a[8:11]
  ds_read_b64_tr_b16 a[248:249], v204 offset:24576
  v_mfma_f32_16x16x32_bf16 a[24:27], a[232:235], a[100:103], a[24:27]
  v_mfma_f32_16x16x32_bf16 a[40:43], a[232:235], a[104:107], a[40:43]
  ds_read_b64_tr_b16 a[250:251], v204 offset:25600
  v_mfma_f32_16x16x32_bf16 a[56:59], a[232:235], a[108:111], a[56:59]
  v_mfma_f32_16x16x32_bf16 a[12:15], a[236:239], a[96:99], a[12:15]
  ds_read_b64_tr_b16 a[252:253], v205 offset:24576
  v_mfma_f32_16x16x32_bf16 a[28:31], a[236:239], a[100:103], a[28:31]
  v_mfma_f32_16x16x32_bf16 a[44:47], a[236:239], a[104:107], a[44:47]
  ds_read_b64_tr_b16 a[254:255], v205 offset:25600
  v_mfma_f32_16x16x32_bf16 a[60:63], a[236:239], a[108:111], a[60:63]
  s_mov_b32 s45, 10240
  buffer_load_dwordx4 a[96:99], v200, s[12:15], s45 offen offset:0
  s_waitcnt lgkmcnt(4)
  v_mfma_f32_16x16x32_bf16 v[0:3], a[240:243], a[112:115], v[0:3]
  ds_read_b64_tr_b16 a[224:225], v206 offset:24576
  v_mfma_f32_16x16x32_bf16 v[32:35], a[240:243], a[116:119], v[32:35]
  v_mfma_f32_16x16x32_bf16 v[64:67], a[240:243], a[120:123], v[64:67]
  ds_read_b64_tr_b16 a[226:227], v206 offset:25600
  v_mfma_f32_16x16x32_bf16 v[96:99], a[240:243], a[124:127], v[96:99]
  v_mfma_f32_16x16x32_bf16 v[4:7], a[244:247], a[112:115], v[4:7]
  s_mov_b32 s45, 30720
  buffer_load_dwordx4 a[100:103], v200, s[12:15], s45 offen offset:0
  ds_read_b64_tr_b16 a[228:229], v207 offset:24576
  v_mfma_f32_16x16x32_bf16 v[36:39], a[244:247], a[116:119], v[36:39]
  v_mfma_f32_16x16x32_bf16 v[68:71], a[244:247], a[120:123], v[68:71]
  ds_read_b64_tr_b16 a[230:231], v207 offset:25600
  v_mfma_f32_16x16x32_bf16 v[100:103], a[244:247], a[124:127], v[100:103]
  s_waitcnt lgkmcnt(4)
  v_mfma_f32_16x16x32_bf16 v[8:11], a[248:251], a[112:115], v[8:11]
  ds_read_b64_tr_b16 a[232:233], v208 offset:24576
  v_mfma_f32_16x16x32_bf16 v[40:43], a[248:251], a[116:119], v[40:43]
  s_mov_b32 s45, 51200
  buffer_load_dwordx4 a[104:107], v200, s[12:15], s45 offen offset:0
  v_mfma_f32_16x16x32_bf16 v[72:75], a[248:251], a[120:123], v[72:75]
  ds_read_b64_tr_b16 a[234:235], v208 offset:25600
  v_mfma_f32_16x16x32_bf16 v[104:107], a[248:251], a[124:127], v[104:107]
  v_mfma_f32_16x16x32_bf16 v[12:15], a[252:255], a[112:115], v[12:15]
  ds_read_b64_tr_b16 a[236:237], v209 offset:24576
  v_mfma_f32_16x16x32_bf16 v[44:47], a[252:255], a[116:119], v[44:47]
  v_mfma_f32_16x16x32_bf16 v[76:79], a[252:255], a[120:123], v[76:79]
  s_mov_b32 s45, 71680
  buffer_load_dwordx4 a[108:111], v200, s[12:15], s45 offen offset:0
  ds_read_b64_tr_b16 a[238:239], v209 offset:25600
  v_mfma_f32_16x16x32_bf16 v[108:111], a[252:255], a[124:127], v[108:111]
  s_waitcnt lgkmcnt(4)
  v_mfma_f32_16x16x32_bf16 v[16:19], a[224:227], a[112:115], v[16:19]
  ds_read_b64_tr_b16 a[240:241], v210 offset:28672
  v_mfma_f32_16x16x32_bf16 v[48:51], a[224:227], a[116:119], v[48:51]
  v_mfma_f32_16x16x32_bf16 v[80:83], a[224:227], a[120:123], v[80:83]
  ds_read_b64_tr_b16 a[242:243], v210 offset:29184
  v_mfma_f32_16x16x32_bf16 v[112:115], a[224:227], a[124:127], v[112:115]
  v_mfma_f32_16x16x32_bf16 v[20:23], a[228:231], a[112:115], v[20:23]
  ds_read_b64_tr_b16 a[244:245], v211 offset:28672
  v_mfma_f32_16x16x32_bf16 v[52:55], a[228:231], a[116:119], v[52:55]
  v_mfma_f32_16x16x32_bf16 v[84:87], a[228:231], a[120:123], v[84:87]
  ds_read_b64_tr_b16 a[246:247], v211 offset:29184
  v_mfma_f32_16x16x32_bf16 v[116:119], a[228:231], a[124:127], v[116:119]
  s_waitcnt lgkmcnt(4)
  v_mfma_f32_16x16x32_bf16 v[24:27], a[232:235], a[112:115], v[24:27]
  ds_read_b64_tr_b16 a[248:249], v212 offset:28672
  v_mfma_f32_16x16x32_bf16 v[56:59], a[232:235], a[116:119], v[56:59]
  v_mfma_f32_16x16x32_bf16 v[88:91], a[232:235], a[120:123], v[88:91]
  ds_read_b64_tr_b16 a[250:251], v212 offset:29184
  v_mfma_f32_16x16x32_bf16 v[120:123], a[232:235], a[124:127], v[120:123]
  v_mfma_f32_16x16x32_bf16 v[28:31], a[236:239], a[112:115], v[28:31]
  ds_read_b64_tr_b16 a[252:253], v213 offset:28672
  v_mfma_f32_16x16x32_bf16 v[60:63], a[236:239], a[116:119], v[60:63]
  v_mfma_f32_16x16x32_bf16 v[92:95], a[236:239], a[120:123], v[92:95]
  ds_read_b64_tr_b16 a[254:255], v213 offset:29184
  v_mfma_f32_16x16x32_bf16 v[124:127], a[236:239], a[124:127], v[124:127]
  s_waitcnt vmcnt(46)
  s_barrier
  s_waitcnt lgkmcnt(4)
  v_mfma_f32_16x16x32_bf16 a[0:3], a[240:243], a[112:115], a[0:3]
  ds_read_b64_tr_b16 a[224:225], v202 offset:32768
  v_mfma_f32_16x16x32_bf16 a[16:19], a[240:243], a[116:119], a[16:19]
  s_add_u32 m0, s32, 0
  s_add_u32 s46, s62, 4194304
  buffer_load_dwordx4 v214, s[20:23], s46 offen lds
  v_mfma_f32_16x16x32_bf16 a[32:35], a[240:243], a[120:123], a[32:35]
  ds_read_b64_tr_b16 a[226:227], v202 offset:33792
  v_mfma_f32_16x16x32_bf16 a[48:51], a[240:243], a[124:127], a[48:51]
  v_mfma_f32_16x16x32_bf16 a[4:7], a[244:247], a[112:115], a[4:7]
  ds_read_b64_tr_b16 a[228:229], v203 offset:32768
  v_mfma_f32_16x16x32_bf16 a[20:23], a[244:247], a[116:119], a[20:23]
  v_mfma_f32_16x16x32_bf16 a[36:39], a[244:247], a[120:123], a[36:39]
  ds_read_b64_tr_b16 a[230:231], v203 offset:33792
  v_mfma_f32_16x16x32_bf16 a[52:55], a[244:247], a[124:127], a[52:55]
  s_waitcnt lgkmcnt(4)
  v_mfma_f32_16x16x32_bf16 a[8:11], a[248:251], a[112:115], a[8:11]
  ds_read_b64_tr_b16 a[232:233], v204 offset:32768
  v_mfma_f32_16x16x32_bf16 a[24:27], a[248:251], a[116:119], a[24:27]
  v_mfma_f32_16x16x32_bf16 a[40:43], a[248:251], a[120:123], a[40:43]
  ds_read_b64_tr_b16 a[234:235], v204 offset:33792
  v_mfma_f32_16x16x32_bf16 a[56:59], a[248:251], a[124:127], a[56:59]
  s_add_u32 m0, s32, 1024
  s_add_u32 s46, s62, 4227072
  buffer_load_dwordx4 v214, s[20:23], s46 offen lds
  v_mfma_f32_16x16x32_bf16 a[12:15], a[252:255], a[112:115], a[12:15]
  ds_read_b64_tr_b16 a[236:237], v205 offset:32768
  v_mfma_f32_16x16x32_bf16 a[28:31], a[252:255], a[116:119], a[28:31]
  v_mfma_f32_16x16x32_bf16 a[44:47], a[252:255], a[120:123], a[44:47]
  ds_read_b64_tr_b16 a[238:239], v205 offset:33792
  v_mfma_f32_16x16x32_bf16 a[60:63], a[252:255], a[124:127], a[60:63]
  s_mov_b32 s45, 10240
  buffer_load_dwordx4 a[112:115], v200, s[12:15], s45 offen offset:1024
  s_waitcnt vmcnt(45) lgkmcnt(4)
  v_mfma_f32_16x16x32_bf16 v[0:3], a[224:227], a[128:131], v[0:3]
  ds_read_b64_tr_b16 a[240:241], v206 offset:32768
  v_mfma_f32_16x16x32_bf16 v[32:35], a[224:227], a[132:135], v[32:35]
  v_mfma_f32_16x16x32_bf16 v[64:67], a[224:227], a[136:139], v[64:67]
  ds_read_b64_tr_b16 a[242:243], v206 offset:33792
  v_mfma_f32_16x16x32_bf16 v[96:99], a[224:227], a[140:143], v[96:99]
  v_mfma_f32_16x16x32_bf16 v[4:7], a[228:231], a[128:131], v[4:7]
  s_mov_b32 s45, 30720
  buffer_load_dwordx4 a[116:119], v200, s[12:15], s45 offen offset:1024
  ds_read_b64_tr_b16 a[244:245], v207 offset:32768
  v_mfma_f32_16x16x32_bf16 v[36:39], a[228:231], a[132:135], v[36:39]
  s_add_u32 m0, s32, 2048
  s_add_u32 s46, s62, 4259840
  buffer_load_dwordx4 v214, s[20:23], s46 offen lds
  v_mfma_f32_16x16x32_bf16 v[68:71], a[228:231], a[136:139], v[68:71]
  ds_read_b64_tr_b16 a[246:247], v207 offset:33792
  v_mfma_f32_16x16x32_bf16 v[100:103], a[228:231], a[140:143], v[100:103]
  s_waitcnt lgkmcnt(4)
  v_mfma_f32_16x16x32_bf16 v[8:11], a[232:235], a[128:131], v[8:11]
  ds_read_b64_tr_b16 a[248:249], v208 offset:32768
  v_mfma_f32_16x16x32_bf16 v[40:43], a[232:235], a[132:135], v[40:43]
  s_mov_b32 s45, 51200
  buffer_load_dwordx4 a[120:123], v200, s[12:15], s45 offen offset:1024
  v_mfma_f32_16x16x32_bf16 v[72:75], a[232:235], a[136:139], v[72:75]
  ds_read_b64_tr_b16 a[250:251], v208 offset:33792
  v_mfma_f32_16x16x32_bf16 v[104:107], a[232:235], a[140:143], v[104:107]
  v_mfma_f32_16x16x32_bf16 v[12:15], a[236:239], a[128:131], v[12:15]
  ds_read_b64_tr_b16 a[252:253], v209 offset:32768
  v_mfma_f32_16x16x32_bf16 v[44:47], a[236:239], a[132:135], v[44:47]
  v_mfma_f32_16x16x32_bf16 v[76:79], a[236:239], a[136:139], v[76:79]
  s_mov_b32 s45, 71680
  buffer_load_dwordx4 a[124:127], v200, s[12:15], s45 offen offset:1024
  ds_read_b64_tr_b16 a[254:255], v209 offset:33792
  v_mfma_f32_16x16x32_bf16 v[108:111], a[236:239], a[140:143], v[108:111]
  s_add_u32 m0, s32, 3072
  s_add_u32 s46, s62, 4292608
  buffer_load_dwordx4 v214, s[20:23], s46 offen lds
  s_waitcnt lgkmcnt(4)
  v_mfma_f32_16x16x32_bf16 v[16:19], a[240:243], a[128:131], v[16:19]
  ds_read_b64_tr_b16 a[224:225], v210 offset:32768
  v_mfma_f32_16x16x32_bf16 v[48:51], a[240:243], a[132:135], v[48:51]
  v_mfma_f32_16x16x32_bf16 v[80:83], a[240:243], a[136:139], v[80:83]
  ds_read_b64_tr_b16 a[226:227], v210 offset:33280
  v_mfma_f32_16x16x32_bf16 v[112:115], a[240:243], a[140:143], v[112:115]
  v_mfma_f32_16x16x32_bf16 v[20:23], a[244:247], a[128:131], v[20:23]
  ds_read_b64_tr_b16 a[228:229], v211 offset:32768
  v_mfma_f32_16x16x32_bf16 v[52:55], a[244:247], a[132:135], v[52:55]
  v_mfma_f32_16x16x32_bf16 v[84:87], a[244:247], a[136:139], v[84:87]
  ds_read_b64_tr_b16 a[230:231], v211 offset:33280
  v_mfma_f32_16x16x32_bf16 v[116:119], a[244:247], a[140:143], v[116:119]
  s_waitcnt lgkmcnt(4)
  v_mfma_f32_16x16x32_bf16 v[24:27], a[248:251], a[128:131], v[24:27]
  ds_read_b64_tr_b16 a[232:233], v212 offset:32768
  v_mfma_f32_16x16x32_bf16 v[56:59], a[248:251], a[132:135], v[56:59]
  s_add_u32 m0, s60, 16384
  s_add_u32 s46, s61, 1769472
  buffer_load_dwordx4 v215, s[16:19], s46 offen lds
  v_mfma_f32_16x16x32_bf16 v[88:91], a[248:251], a[136:139], v[88:91]
  ds_read_b64_tr_b16 a[234:235], v212 offset:33280
  v_mfma_f32_16x16x32_bf16 v[120:123], a[248:251], a[140:143], v[120:123]
  v_mfma_f32_16x16x32_bf16 v[28:31], a[252:255], a[128:131], v[28:31]
  ds_read_b64_tr_b16 a[236:237], v213 offset:32768
  v_mfma_f32_16x16x32_bf16 v[60:63], a[252:255], a[132:135], v[60:63]
  v_mfma_f32_16x16x32_bf16 v[92:95], a[252:255], a[136:139], v[92:95]
  ds_read_b64_tr_b16 a[238:239], v213 offset:33280
  v_mfma_f32_16x16x32_bf16 v[124:127], a[252:255], a[140:143], v[124:127]
  s_waitcnt lgkmcnt(4)
  v_mfma_f32_16x16x32_bf16 a[0:3], a[224:227], a[128:131], a[0:3]
  ds_read_b64_tr_b16 a[240:241], v202 offset:40960
  v_mfma_f32_16x16x32_bf16 a[16:19], a[224:227], a[132:135], a[16:19]
  v_mfma_f32_16x16x32_bf16 a[32:35], a[224:227], a[136:139], a[32:35]
  ds_read_b64_tr_b16 a[242:243], v202 offset:41984
  v_mfma_f32_16x16x32_bf16 a[48:51], a[224:227], a[140:143], a[48:51]
  s_add_u32 m0, s60, 17408
  s_add_u32 s46, s61, 1797120
  buffer_load_dwordx4 v215, s[16:19], s46 offen lds
  v_mfma_f32_16x16x32_bf16 a[4:7], a[228:231], a[128:131], a[4:7]
  ds_read_b64_tr_b16 a[244:245], v203 offset:40960
  v_mfma_f32_16x16x32_bf16 a[20:23], a[228:231], a[132:135], a[20:23]
  v_mfma_f32_16x16x32_bf16 a[36:39], a[228:231], a[136:139], a[36:39]
  ds_read_b64_tr_b16 a[246:247], v203 offset:41984
  v_mfma_f32_16x16x32_bf16 a[52:55], a[228:231], a[140:143], a[52:55]
  s_waitcnt lgkmcnt(4)
  v_mfma_f32_16x16x32_bf16 a[8:11], a[232:235], a[128:131], a[8:11]
  ds_read_b64_tr_b16 a[248:249], v204 offset:40960
  v_mfma_f32_16x16x32_bf16 a[24:27], a[232:235], a[132:135], a[24:27]
  v_mfma_f32_16x16x32_bf16 a[40:43], a[232:235], a[136:139], a[40:43]
  ds_read_b64_tr_b16 a[250:251], v204 offset:41984
  v_mfma_f32_16x16x32_bf16 a[56:59], a[232:235], a[140:143], a[56:59]
  v_mfma_f32_16x16x32_bf16 a[12:15], a[236:239], a[128:131], a[12:15]
  ds_read_b64_tr_b16 a[252:253], v205 offset:40960
  v_mfma_f32_16x16x32_bf16 a[28:31], a[236:239], a[132:135], a[28:31]
  v_mfma_f32_16x16x32_bf16 a[44:47], a[236:239], a[136:139], a[44:47]
  ds_read_b64_tr_b16 a[254:255], v205 offset:41984
  v_mfma_f32_16x16x32_bf16 a[60:63], a[236:239], a[140:143], a[60:63]
  s_mov_b32 s45, 12288
  buffer_load_dwordx4 a[128:131], v200, s[12:15], s45 offen offset:0
  s_waitcnt vmcnt(49) lgkmcnt(4)
  v_mfma_f32_16x16x32_bf16 v[0:3], a[240:243], a[144:147], v[0:3]
  ds_read_b64_tr_b16 a[224:225], v206 offset:40960
  v_mfma_f32_16x16x32_bf16 v[32:35], a[240:243], a[148:151], v[32:35]
  v_mfma_f32_16x16x32_bf16 v[64:67], a[240:243], a[152:155], v[64:67]
  ds_read_b64_tr_b16 a[226:227], v206 offset:41984
  v_mfma_f32_16x16x32_bf16 v[96:99], a[240:243], a[156:159], v[96:99]
  v_mfma_f32_16x16x32_bf16 v[4:7], a[244:247], a[144:147], v[4:7]
  s_mov_b32 s45, 32768
  buffer_load_dwordx4 a[132:135], v200, s[12:15], s45 offen offset:0
  ds_read_b64_tr_b16 a[228:229], v207 offset:40960
  v_mfma_f32_16x16x32_bf16 v[36:39], a[244:247], a[148:151], v[36:39]
  v_mfma_f32_16x16x32_bf16 v[68:71], a[244:247], a[152:155], v[68:71]
  ds_read_b64_tr_b16 a[230:231], v207 offset:41984
  v_mfma_f32_16x16x32_bf16 v[100:103], a[244:247], a[156:159], v[100:103]
  s_waitcnt lgkmcnt(4)
  v_mfma_f32_16x16x32_bf16 v[8:11], a[248:251], a[144:147], v[8:11]
  ds_read_b64_tr_b16 a[232:233], v208 offset:40960
  v_mfma_f32_16x16x32_bf16 v[40:43], a[248:251], a[148:151], v[40:43]
  s_mov_b32 s45, 53248
  buffer_load_dwordx4 a[136:139], v200, s[12:15], s45 offen offset:0
  v_mfma_f32_16x16x32_bf16 v[72:75], a[248:251], a[152:155], v[72:75]
  ds_read_b64_tr_b16 a[234:235], v208 offset:41984
  v_mfma_f32_16x16x32_bf16 v[104:107], a[248:251], a[156:159], v[104:107]
  v_mfma_f32_16x16x32_bf16 v[12:15], a[252:255], a[144:147], v[12:15]
  ds_read_b64_tr_b16 a[236:237], v209 offset:40960
  s_add_u32 m0, s63, 0
  s_add_u32 s46, s92, 0
  buffer_load_dwordx4 v236, s[80:83], s46 offen lds
  v_mfma_f32_16x16x32_bf16 v[44:47], a[252:255], a[148:151], v[44:47]
  v_mfma_f32_16x16x32_bf16 v[76:79], a[252:255], a[152:155], v[76:79]
  s_mov_b32 s45, 73728
  buffer_load_dwordx4 a[140:143], v200, s[12:15], s45 offen offset:0
  ds_read_b64_tr_b16 a[238:239], v209 offset:41984
  v_mfma_f32_16x16x32_bf16 v[108:111], a[252:255], a[156:159], v[108:111]
  s_waitcnt lgkmcnt(4)
  v_mfma_f32_16x16x32_bf16 v[16:19], a[224:227], a[144:147], v[16:19]
  ds_read_b64_tr_b16 a[240:241], v210 offset:36864
  v_mfma_f32_16x16x32_bf16 v[48:51], a[224:227], a[148:151], v[48:51]
  v_mfma_f32_16x16x32_bf16 v[80:83], a[224:227], a[152:155], v[80:83]
  ds_read_b64_tr_b16 a[242:243], v210 offset:37376
  v_mfma_f32_16x16x32_bf16 v[112:115], a[224:227], a[156:159], v[112:115]
  v_mfma_f32_16x16x32_bf16 v[20:23], a[228:231], a[144:147], v[20:23]
  ds_read_b64_tr_b16 a[244:245], v211 offset:36864
  s_add_u32 m0, s63, 1024
  s_add_u32 s46, s92, 10240
  buffer_load_dwordx4 v236, s[80:83], s46 offen lds
  v_mfma_f32_16x16x32_bf16 v[52:55], a[228:231], a[148:151], v[52:55]
  v_mfma_f32_16x16x32_bf16 v[84:87], a[228:231], a[152:155], v[84:87]
  ds_read_b64_tr_b16 a[246:247], v211 offset:37376
  v_mfma_f32_16x16x32_bf16 v[116:119], a[228:231], a[156:159], v[116:119]
  s_waitcnt lgkmcnt(4)
  v_mfma_f32_16x16x32_bf16 v[24:27], a[232:235], a[144:147], v[24:27]
  ds_read_b64_tr_b16 a[248:249], v212 offset:36864
  v_mfma_f32_16x16x32_bf16 v[56:59], a[232:235], a[148:151], v[56:59]
  v_mfma_f32_16x16x32_bf16 v[88:91], a[232:235], a[152:155], v[88:91]
  ds_read_b64_tr_b16 a[250:251], v212 offset:37376
  v_mfma_f32_16x16x32_bf16 v[120:123], a[232:235], a[156:159], v[120:123]
  v_mfma_f32_16x16x32_bf16 v[28:31], a[236:239], a[144:147], v[28:31]
  ds_read_b64_tr_b16 a[252:253], v213 offset:36864
  s_add_u32 m0, s63, 2048
  s_add_u32 s46, s92, 20480
  buffer_load_dwordx4 v236, s[80:83], s46 offen lds
  v_mfma_f32_16x16x32_bf16 v[60:63], a[236:239], a[148:151], v[60:63]
  v_mfma_f32_16x16x32_bf16 v[92:95], a[236:239], a[152:155], v[92:95]
  ds_read_b64_tr_b16 a[254:255], v213 offset:37376
  v_mfma_f32_16x16x32_bf16 v[124:127], a[236:239], a[156:159], v[124:127]
  s_waitcnt vmcnt(46)
  s_barrier
  s_waitcnt lgkmcnt(4)
  v_mfma_f32_16x16x32_bf16 a[0:3], a[240:243], a[144:147], a[0:3]
  ds_read_b64_tr_b16 a[224:225], v202 offset:49152
  v_mfma_f32_16x16x32_bf16 a[16:19], a[240:243], a[148:151], a[16:19]
  s_add_u32 m0, s32, 16384
  s_add_u32 s46, s62, 4718592
  buffer_load_dwordx4 v214, s[20:23], s46 offen lds
  v_mfma_f32_16x16x32_bf16 a[32:35], a[240:243], a[152:155], a[32:35]
  ds_read_b64_tr_b16 a[226:227], v202 offset:50176
  v_mfma_f32_16x16x32_bf16 a[48:51], a[240:243], a[156:159], a[48:51]
  v_mfma_f32_16x16x32_bf16 a[4:7], a[244:247], a[144:147], a[4:7]
  ds_read_b64_tr_b16 a[228:229], v203 offset:49152
  s_add_u32 m0, s63, 3072
  s_add_u32 s46, s92, 30720
  buffer_load_dwordx4 v236, s[80:83], s46 offen lds
  v_mfma_f32_16x16x32_bf16 a[20:23], a[244:247], a[148:151], a[20:23]
  v_mfma_f32_16x16x32_bf16 a[36:39], a[244:247], a[152:155], a[36:39]
  ds_read_b64_tr_b16 a[230:231], v203 offset:50176
  v_mfma_f32_16x16x32_bf16 a[52:55], a[244:247], a[156:159], a[52:55]
  s_waitcnt lgkmcnt(4)
  v_mfma_f32_16x16x32_bf16 a[8:11], a[248:251], a[144:147], a[8:11]
  ds_read_b64_tr_b16 a[232:233], v204 offset:49152
  v_mfma_f32_16x16x32_bf16 a[24:27], a[248:251], a[148:151], a[24:27]
  v_mfma_f32_16x16x32_bf16 a[40:43], a[248:251], a[152:155], a[40:43]
  ds_read_b64_tr_b16 a[234:235], v204 offset:50176
  v_mfma_f32_16x16x32_bf16 a[56:59], a[248:251], a[156:159], a[56:59]
  s_add_u32 m0, s32, 17408
  s_add_u32 s46, s62, 4751360
  buffer_load_dwordx4 v214, s[20:23], s46 offen lds
  v_mfma_f32_16x16x32_bf16 a[12:15], a[252:255], a[144:147], a[12:15]
  ds_read_b64_tr_b16 a[236:237], v205 offset:49152
  v_mfma_f32_16x16x32_bf16 a[28:31], a[252:255], a[148:151], a[28:31]
  v_mfma_f32_16x16x32_bf16 a[44:47], a[252:255], a[152:155], a[44:47]
  ds_read_b64_tr_b16 a[238:239], v205 offset:50176
  v_mfma_f32_16x16x32_bf16 a[60:63], a[252:255], a[156:159], a[60:63]
  s_mov_b32 s45, 12288
  buffer_load_dwordx4 a[144:147], v200, s[12:15], s45 offen offset:1024
  s_waitcnt vmcnt(45) lgkmcnt(4)
  v_mfma_f32_16x16x32_bf16 v[0:3], a[224:227], a[160:163], v[0:3]
  ds_read_b64_tr_b16 a[240:241], v206 offset:49152
  v_mfma_f32_16x16x32_bf16 v[32:35], a[224:227], a[164:167], v[32:35]
  v_mfma_f32_16x16x32_bf16 v[64:67], a[224:227], a[168:171], v[64:67]
  ds_read_b64_tr_b16 a[242:243], v206 offset:50176
  v_mfma_f32_16x16x32_bf16 v[96:99], a[224:227], a[172:175], v[96:99]
  v_mfma_f32_16x16x32_bf16 v[4:7], a[228:231], a[160:163], v[4:7]
  s_mov_b32 s45, 32768
  buffer_load_dwordx4 a[148:151], v200, s[12:15], s45 offen offset:1024
  ds_read_b64_tr_b16 a[244:245], v207 offset:49152
  v_mfma_f32_16x16x32_bf16 v[36:39], a[228:231], a[164:167], v[36:39]
  s_add_u32 m0, s32, 18432
  s_add_u32 s46, s62, 4784128
  buffer_load_dwordx4 v214, s[20:23], s46 offen lds
  v_mfma_f32_16x16x32_bf16 v[68:71], a[228:231], a[168:171], v[68:71]
  ds_read_b64_tr_b16 a[246:247], v207 offset:50176
  v_mfma_f32_16x16x32_bf16 v[100:103], a[228:231], a[172:175], v[100:103]
  s_waitcnt lgkmcnt(4)
  v_mfma_f32_16x16x32_bf16 v[8:11], a[232:235], a[160:163], v[8:11]
  ds_read_b64_tr_b16 a[248:249], v208 offset:49152
  v_mfma_f32_16x16x32_bf16 v[40:43], a[232:235], a[164:167], v[40:43]
  s_mov_b32 s45, 53248
  buffer_load_dwordx4 a[152:155], v200, s[12:15], s45 offen offset:1024
  v_mfma_f32_16x16x32_bf16 v[72:75], a[232:235], a[168:171], v[72:75]
  ds_read_b64_tr_b16 a[250:251], v208 offset:50176
  v_mfma_f32_16x16x32_bf16 v[104:107], a[232:235], a[172:175], v[104:107]
  v_mfma_f32_16x16x32_bf16 v[12:15], a[236:239], a[160:163], v[12:15]
  ds_read_b64_tr_b16 a[252:253], v209 offset:49152
  v_mfma_f32_16x16x32_bf16 v[44:47], a[236:239], a[164:167], v[44:47]
  v_mfma_f32_16x16x32_bf16 v[76:79], a[236:239], a[168:171], v[76:79]
  s_mov_b32 s45, 73728
  buffer_load_dwordx4 a[156:159], v200, s[12:15], s45 offen offset:1024
  ds_read_b64_tr_b16 a[254:255], v209 offset:50176
  v_mfma_f32_16x16x32_bf16 v[108:111], a[236:239], a[172:175], v[108:111]
  s_add_u32 m0, s32, 19456
  s_add_u32 s46, s62, 4816896
  buffer_load_dwordx4 v214, s[20:23], s46 offen lds
  s_waitcnt lgkmcnt(4)
  v_mfma_f32_16x16x32_bf16 v[16:19], a[240:243], a[160:163], v[16:19]
  ds_read_b64_tr_b16 a[224:225], v210 offset:40960
  v_mfma_f32_16x16x32_bf16 v[48:51], a[240:243], a[164:167], v[48:51]
  v_mfma_f32_16x16x32_bf16 v[80:83], a[240:243], a[168:171], v[80:83]
  ds_read_b64_tr_b16 a[226:227], v210 offset:41472
  v_mfma_f32_16x16x32_bf16 v[112:115], a[240:243], a[172:175], v[112:115]
  v_mfma_f32_16x16x32_bf16 v[20:23], a[244:247], a[160:163], v[20:23]
  ds_read_b64_tr_b16 a[228:229], v211 offset:40960
  v_mfma_f32_16x16x32_bf16 v[52:55], a[244:247], a[164:167], v[52:55]
  v_mfma_f32_16x16x32_bf16 v[84:87], a[244:247], a[168:171], v[84:87]
  ds_read_b64_tr_b16 a[230:231], v211 offset:41472
  v_mfma_f32_16x16x32_bf16 v[116:119], a[244:247], a[172:175], v[116:119]
  s_waitcnt lgkmcnt(4)
  v_mfma_f32_16x16x32_bf16 v[24:27], a[248:251], a[160:163], v[24:27]
  ds_read_b64_tr_b16 a[232:233], v212 offset:40960
  v_mfma_f32_16x16x32_bf16 v[56:59], a[248:251], a[164:167], v[56:59]
  s_add_u32 m0, s60, 24576
  s_add_u32 s46, s61, 1990656
  buffer_load_dwordx4 v215, s[16:19], s46 offen lds
  v_mfma_f32_16x16x32_bf16 v[88:91], a[248:251], a[168:171], v[88:91]
  ds_read_b64_tr_b16 a[234:235], v212 offset:41472
  v_mfma_f32_16x16x32_bf16 v[120:123], a[248:251], a[172:175], v[120:123]
  v_mfma_f32_16x16x32_bf16 v[28:31], a[252:255], a[160:163], v[28:31]
  ds_read_b64_tr_b16 a[236:237], v213 offset:40960
  v_mfma_f32_16x16x32_bf16 v[60:63], a[252:255], a[164:167], v[60:63]
  v_mfma_f32_16x16x32_bf16 v[92:95], a[252:255], a[168:171], v[92:95]
  ds_read_b64_tr_b16 a[238:239], v213 offset:41472
  v_mfma_f32_16x16x32_bf16 v[124:127], a[252:255], a[172:175], v[124:127]
  s_waitcnt lgkmcnt(4)
  v_mfma_f32_16x16x32_bf16 a[0:3], a[224:227], a[160:163], a[0:3]
  ds_read_b64_tr_b16 a[240:241], v202 offset:57344
  v_mfma_f32_16x16x32_bf16 a[16:19], a[224:227], a[164:167], a[16:19]
  v_mfma_f32_16x16x32_bf16 a[32:35], a[224:227], a[168:171], a[32:35]
  ds_read_b64_tr_b16 a[242:243], v202 offset:58368
  v_mfma_f32_16x16x32_bf16 a[48:51], a[224:227], a[172:175], a[48:51]
  s_add_u32 m0, s60, 25600
  s_add_u32 s46, s61, 2018304
  buffer_load_dwordx4 v215, s[16:19], s46 offen lds
  v_mfma_f32_16x16x32_bf16 a[4:7], a[228:231], a[160:163], a[4:7]
  ds_read_b64_tr_b16 a[244:245], v203 offset:57344
  v_mfma_f32_16x16x32_bf16 a[20:23], a[228:231], a[164:167], a[20:23]
  v_mfma_f32_16x16x32_bf16 a[36:39], a[228:231], a[168:171], a[36:39]
  ds_read_b64_tr_b16 a[246:247], v203 offset:58368
  v_mfma_f32_16x16x32_bf16 a[52:55], a[228:231], a[172:175], a[52:55]
  s_waitcnt lgkmcnt(4)
  v_mfma_f32_16x16x32_bf16 a[8:11], a[232:235], a[160:163], a[8:11]
  ds_read_b64_tr_b16 a[248:249], v204 offset:57344
  v_mfma_f32_16x16x32_bf16 a[24:27], a[232:235], a[164:167], a[24:27]
  v_mfma_f32_16x16x32_bf16 a[40:43], a[232:235], a[168:171], a[40:43]
  ds_read_b64_tr_b16 a[250:251], v204 offset:58368
  v_mfma_f32_16x16x32_bf16 a[56:59], a[232:235], a[172:175], a[56:59]
  v_mfma_f32_16x16x32_bf16 a[12:15], a[236:239], a[160:163], a[12:15]
  ds_read_b64_tr_b16 a[252:253], v205 offset:57344
  v_mfma_f32_16x16x32_bf16 a[28:31], a[236:239], a[164:167], a[28:31]
  v_mfma_f32_16x16x32_bf16 a[44:47], a[236:239], a[168:171], a[44:47]
  ds_read_b64_tr_b16 a[254:255], v205 offset:58368
  v_mfma_f32_16x16x32_bf16 a[60:63], a[236:239], a[172:175], a[60:63]
  s_mov_b32 s45, 14336
  buffer_load_dwordx4 a[160:163], v200, s[12:15], s45 offen offset:0
  s_waitcnt vmcnt(49) lgkmcnt(4)
  v_mfma_f32_16x16x32_bf16 v[0:3], a[240:243], a[176:179], v[0:3]
  ds_read_b64_tr_b16 a[224:225], v206 offset:57344
  v_mfma_f32_16x16x32_bf16 v[32:35], a[240:243], a[180:183], v[32:35]
  v_mfma_f32_16x16x32_bf16 v[64:67], a[240:243], a[184:187], v[64:67]
  ds_read_b64_tr_b16 a[226:227], v206 offset:58368
  v_mfma_f32_16x16x32_bf16 v[96:99], a[240:243], a[188:191], v[96:99]
  v_mfma_f32_16x16x32_bf16 v[4:7], a[244:247], a[176:179], v[4:7]
  s_mov_b32 s45, 34816
  buffer_load_dwordx4 a[164:167], v200, s[12:15], s45 offen offset:0
  ds_read_b64_tr_b16 a[228:229], v207 offset:57344
  v_mfma_f32_16x16x32_bf16 v[36:39], a[244:247], a[180:183], v[36:39]
  v_mfma_f32_16x16x32_bf16 v[68:71], a[244:247], a[184:187], v[68:71]
  ds_read_b64_tr_b16 a[230:231], v207 offset:58368
  v_mfma_f32_16x16x32_bf16 v[100:103], a[244:247], a[188:191], v[100:103]
  s_waitcnt lgkmcnt(4)
  v_mfma_f32_16x16x32_bf16 v[8:11], a[248:251], a[176:179], v[8:11]
  ds_read_b64_tr_b16 a[232:233], v208 offset:57344
  v_mfma_f32_16x16x32_bf16 v[40:43], a[248:251], a[180:183], v[40:43]
  s_mov_b32 s45, 55296
  buffer_load_dwordx4 a[168:171], v200, s[12:15], s45 offen offset:0
  v_mfma_f32_16x16x32_bf16 v[72:75], a[248:251], a[184:187], v[72:75]
  ds_read_b64_tr_b16 a[234:235], v208 offset:58368
  v_mfma_f32_16x16x32_bf16 v[104:107], a[248:251], a[188:191], v[104:107]
  v_mfma_f32_16x16x32_bf16 v[12:15], a[252:255], a[176:179], v[12:15]
  ds_read_b64_tr_b16 a[236:237], v209 offset:57344
  v_mfma_f32_16x16x32_bf16 v[44:47], a[252:255], a[180:183], v[44:47]
  v_mfma_f32_16x16x32_bf16 v[76:79], a[252:255], a[184:187], v[76:79]
  s_mov_b32 s45, 75776
  buffer_load_dwordx4 a[172:175], v200, s[12:15], s45 offen offset:0
  ds_read_b64_tr_b16 a[238:239], v209 offset:58368
  v_mfma_f32_16x16x32_bf16 v[108:111], a[252:255], a[188:191], v[108:111]
  s_waitcnt lgkmcnt(4)
  v_mfma_f32_16x16x32_bf16 v[16:19], a[224:227], a[176:179], v[16:19]
  ds_read_b64_tr_b16 a[240:241], v210 offset:45056
  v_mfma_f32_16x16x32_bf16 v[48:51], a[224:227], a[180:183], v[48:51]
  v_mfma_f32_16x16x32_bf16 v[80:83], a[224:227], a[184:187], v[80:83]
  ds_read_b64_tr_b16 a[242:243], v210 offset:45568
  v_mfma_f32_16x16x32_bf16 v[112:115], a[224:227], a[188:191], v[112:115]
  v_mfma_f32_16x16x32_bf16 v[20:23], a[228:231], a[176:179], v[20:23]
  ds_read_b64_tr_b16 a[244:245], v211 offset:45056
  v_mfma_f32_16x16x32_bf16 v[52:55], a[228:231], a[180:183], v[52:55]
  v_mfma_f32_16x16x32_bf16 v[84:87], a[228:231], a[184:187], v[84:87]
  ds_read_b64_tr_b16 a[246:247], v211 offset:45568
  v_mfma_f32_16x16x32_bf16 v[116:119], a[228:231], a[188:191], v[116:119]
  s_waitcnt lgkmcnt(4)
  v_mfma_f32_16x16x32_bf16 v[24:27], a[232:235], a[176:179], v[24:27]
  ds_read_b64_tr_b16 a[248:249], v212 offset:45056
  v_mfma_f32_16x16x32_bf16 v[56:59], a[232:235], a[180:183], v[56:59]
  v_mfma_f32_16x16x32_bf16 v[88:91], a[232:235], a[184:187], v[88:91]
  ds_read_b64_tr_b16 a[250:251], v212 offset:45568
  v_mfma_f32_16x16x32_bf16 v[120:123], a[232:235], a[188:191], v[120:123]
  v_mfma_f32_16x16x32_bf16 v[28:31], a[236:239], a[176:179], v[28:31]
  ds_read_b64_tr_b16 a[252:253], v213 offset:45056
  v_mfma_f32_16x16x32_bf16 v[60:63], a[236:239], a[180:183], v[60:63]
  v_mfma_f32_16x16x32_bf16 v[92:95], a[236:239], a[184:187], v[92:95]
  ds_read_b64_tr_b16 a[254:255], v213 offset:45568
  v_mfma_f32_16x16x32_bf16 v[124:127], a[236:239], a[188:191], v[124:127]
  s_waitcnt vmcnt(43)
  s_barrier
  s_waitcnt lgkmcnt(4)
  v_mfma_f32_16x16x32_bf16 a[0:3], a[240:243], a[176:179], a[0:3]
  ds_read_b64_tr_b16 a[224:225], v240 offset:0
  v_mfma_f32_16x16x32_bf16 a[16:19], a[240:243], a[180:183], a[16:19]
  s_add_u32 m0, s32, 32768
  s_add_u32 s46, s62, 3145728
  buffer_load_dwordx4 v214, s[20:23], s46 offen lds
  v_mfma_f32_16x16x32_bf16 a[32:35], a[240:243], a[184:187], a[32:35]
  ds_read_b64_tr_b16 a[226:227], v240 offset:1024
  v_mfma_f32_16x16x32_bf16 a[48:51], a[240:243], a[188:191], a[48:51]
  v_mfma_f32_16x16x32_bf16 a[4:7], a[244:247], a[176:179], a[4:7]
  ds_read_b64_tr_b16 a[228:229], v241 offset:0
  v_mfma_f32_16x16x32_bf16 a[20:23], a[244:247], a[180:183], a[20:23]
  v_mfma_f32_16x16x32_bf16 a[36:39], a[244:247], a[184:187], a[36:39]
  ds_read_b64_tr_b16 a[230:231], v241 offset:1024
  v_mfma_f32_16x16x32_bf16 a[52:55], a[244:247], a[188:191], a[52:55]
  s_waitcnt lgkmcnt(4)
  v_mfma_f32_16x16x32_bf16 a[8:11], a[248:251], a[176:179], a[8:11]
  ds_read_b64_tr_b16 a[232:233], v242 offset:0
  v_mfma_f32_16x16x32_bf16 a[24:27], a[248:251], a[180:183], a[24:27]
  v_mfma_f32_16x16x32_bf16 a[40:43], a[248:251], a[184:187], a[40:43]
  ds_read_b64_tr_b16 a[234:235], v242 offset:1024
  v_mfma_f32_16x16x32_bf16 a[56:59], a[248:251], a[188:191], a[56:59]
  s_add_u32 m0, s32, 33792
  s_add_u32 s46, s62, 3178496
  buffer_load_dwordx4 v214, s[20:23], s46 offen lds
  v_mfma_f32_16x16x32_bf16 a[12:15], a[252:255], a[176:179], a[12:15]
  ds_read_b64_tr_b16 a[236:237], v243 offset:0
  v_mfma_f32_16x16x32_bf16 a[28:31], a[252:255], a[180:183], a[28:31]
  v_mfma_f32_16x16x32_bf16 a[44:47], a[252:255], a[184:187], a[44:47]
  ds_read_b64_tr_b16 a[238:239], v243 offset:1024
  v_mfma_f32_16x16x32_bf16 a[60:63], a[252:255], a[188:191], a[60:63]
  s_mov_b32 s45, 14336
  buffer_load_dwordx4 a[176:179], v200, s[12:15], s45 offen offset:1024
  s_waitcnt lgkmcnt(4)
  v_mfma_f32_16x16x32_bf16 v[0:3], a[224:227], a[64:67], v[0:3]
  ds_read_b64_tr_b16 a[240:241], v244 offset:0
  v_mfma_f32_16x16x32_bf16 v[32:35], a[224:227], a[68:71], v[32:35]
  v_mfma_f32_16x16x32_bf16 v[64:67], a[224:227], a[72:75], v[64:67]
  ds_read_b64_tr_b16 a[242:243], v244 offset:1024
  v_mfma_f32_16x16x32_bf16 v[96:99], a[224:227], a[76:79], v[96:99]
  v_mfma_f32_16x16x32_bf16 v[4:7], a[228:231], a[64:67], v[4:7]
  s_mov_b32 s45, 34816
  buffer_load_dwordx4 a[180:183], v200, s[12:15], s45 offen offset:1024
  ds_read_b64_tr_b16 a[244:245], v245 offset:0
  v_mfma_f32_16x16x32_bf16 v[36:39], a[228:231], a[68:71], v[36:39]
  s_add_u32 m0, s32, 34816
  s_add_u32 s46, s62, 3211264
  buffer_load_dwordx4 v214, s[20:23], s46 offen lds
  v_mfma_f32_16x16x32_bf16 v[68:71], a[228:231], a[72:75], v[68:71]
  ds_read_b64_tr_b16 a[246:247], v245 offset:1024
  v_mfma_f32_16x16x32_bf16 v[100:103], a[228:231], a[76:79], v[100:103]
  s_waitcnt lgkmcnt(4)
  v_mfma_f32_16x16x32_bf16 v[8:11], a[232:235], a[64:67], v[8:11]
  ds_read_b64_tr_b16 a[248:249], v246 offset:0
  v_mfma_f32_16x16x32_bf16 v[40:43], a[232:235], a[68:71], v[40:43]
  s_mov_b32 s45, 55296
  buffer_load_dwordx4 a[184:187], v200, s[12:15], s45 offen offset:1024
  s_waitcnt vmcnt(19)
  v_mfma_f32_16x16x32_bf16 v[72:75], a[232:235], a[72:75], v[72:75]
  ds_read_b64_tr_b16 a[250:251], v246 offset:1024
  v_mfma_f32_16x16x32_bf16 v[104:107], a[232:235], a[76:79], v[104:107]
  v_mfma_f32_16x16x32_bf16 v[12:15], a[236:239], a[64:67], v[12:15]
  ds_read_b64_tr_b16 a[252:253], v247 offset:0
  v_mfma_f32_16x16x32_bf16 v[44:47], a[236:239], a[68:71], v[44:47]
  ds_read_b64_tr_b16 v[216:217], v237 offset:0
  v_mfma_f32_16x16x32_bf16 v[76:79], a[236:239], a[72:75], v[76:79]
  s_mov_b32 s45, 75776
  buffer_load_dwordx4 a[188:191], v200, s[12:15], s45 offen offset:1024
  ds_read_b64_tr_b16 a[254:255], v247 offset:1024
  v_mfma_f32_16x16x32_bf16 v[108:111], a[236:239], a[76:79], v[108:111]
  s_add_u32 m0, s32, 35840
  s_add_u32 s46, s62, 3244032
  buffer_load_dwordx4 v214, s[20:23], s46 offen lds
  s_waitcnt lgkmcnt(5)
  v_mfma_f32_16x16x32_bf16 v[16:19], a[240:243], a[64:67], v[16:19]
  ds_read_b64_tr_b16 a[224:225], v210 offset:0
  v_mfma_f32_16x16x32_bf16 v[48:51], a[240:243], a[68:71], v[48:51]
  ds_read_b64_tr_b16 v[218:219], v237 offset:2048
  v_mfma_f32_16x16x32_bf16 v[80:83], a[240:243], a[72:75], v[80:83]
  ds_read_b64_tr_b16 a[226:227], v210 offset:512
  v_mfma_f32_16x16x32_bf16 v[112:115], a[240:243], a[76:79], v[112:115]
  v_mfma_f32_16x16x32_bf16 v[20:23], a[244:247], a[64:67], v[20:23]
  ds_read_b64_tr_b16 a[228:229], v211 offset:0
  v_mfma_f32_16x16x32_bf16 v[52:55], a[244:247], a[68:71], v[52:55]
  ds_read_b64_tr_b16 v[220:221], v237 offset:32
  v_mfma_f32_16x16x32_bf16 v[84:87], a[244:247], a[72:75], v[84:87]
  ds_read_b64_tr_b16 a[230:231], v211 offset:512
  v_mfma_f32_16x16x32_bf16 v[116:119], a[244:247], a[76:79], v[116:119]
  s_waitcnt lgkmcnt(6)
  v_mfma_f32_16x16x32_bf16 v[24:27], a[248:251], a[64:67], v[24:27]
  ds_read_b64_tr_b16 a[232:233], v212 offset:0
  v_mfma_f32_16x16x32_bf16 v[56:59], a[248:251], a[68:71], v[56:59]
  s_add_u32 m0, s60, 32768
  s_add_u32 s46, s61, 1327104
  buffer_load_dwordx4 v215, s[16:19], s46 offen lds
  ds_read_b64_tr_b16 v[222:223], v237 offset:2080
  v_mfma_f32_16x16x32_bf16 v[88:91], a[248:251], a[72:75], v[88:91]
  ds_read_b64_tr_b16 a[234:235], v212 offset:512
  v_mfma_f32_16x16x32_bf16 v[120:123], a[248:251], a[76:79], v[120:123]
  v_mfma_f32_16x16x32_bf16 v[28:31], a[252:255], a[64:67], v[28:31]
  ds_read_b64_tr_b16 a[236:237], v213 offset:0
  v_mfma_f32_16x16x32_bf16 v[60:63], a[252:255], a[68:71], v[60:63]
  ds_read_b64_tr_b16 v[224:225], v237 offset:64
  v_mfma_f32_16x16x32_bf16 v[92:95], a[252:255], a[72:75], v[92:95]
  ds_read_b64_tr_b16 a[238:239], v213 offset:512
  v_mfma_f32_16x16x32_bf16 v[124:127], a[252:255], a[76:79], v[124:127]
  s_waitcnt lgkmcnt(6)
  v_mfma_f32_16x16x32_bf16 a[0:3], a[224:227], a[64:67], a[0:3]
  ds_read_b64_tr_b16 a[240:241], v240 offset:8192
  v_mfma_f32_16x16x32_bf16 a[16:19], a[224:227], a[68:71], a[16:19]
  ds_read_b64_tr_b16 v[226:227], v237 offset:2112
  v_mfma_f32_16x16x32_bf16 a[32:35], a[224:227], a[72:75], a[32:35]
  ds_read_b64_tr_b16 a[242:243], v240 offset:9216
  v_mfma_f32_16x16x32_bf16 a[48:51], a[224:227], a[76:79], a[48:51]
  s_add_u32 m0, s60, 33792
  s_add_u32 s46, s61, 1354752
  buffer_load_dwordx4 v215, s[16:19], s46 offen lds
  v_mfma_f32_16x16x32_bf16 a[4:7], a[228:231], a[64:67], a[4:7]
  ds_read_b64_tr_b16 a[244:245], v241 offset:8192
  v_mfma_f32_16x16x32_bf16 a[20:23], a[228:231], a[68:71], a[20:23]
  ds_read_b64_tr_b16 v[228:229], v237 offset:96
  v_mfma_f32_16x16x32_bf16 a[36:39], a[228:231], a[72:75], a[36:39]
  ds_read_b64_tr_b16 a[246:247], v241 offset:9216
  v_mfma_f32_16x16x32_bf16 a[52:55], a[228:231], a[76:79], a[52:55]
  s_waitcnt lgkmcnt(6)
  v_mfma_f32_16x16x32_bf16 a[8:11], a[232:235], a[64:67], a[8:11]
  ds_read_b64_tr_b16 a[248:249], v242 offset:8192
  v_mfma_f32_16x16x32_bf16 a[24:27], a[232:235], a[68:71], a[24:27]
  ds_read_b64_tr_b16 v[230:231], v237 offset:2144
  v_mfma_f32_16x16x32_bf16 a[40:43], a[232:235], a[72:75], a[40:43]
  ds_read_b64_tr_b16 a[250:251], v242 offset:9216
  v_mfma_f32_16x16x32_bf16 a[56:59], a[232:235], a[76:79], a[56:59]
  v_mfma_f32_16x16x32_bf16 a[12:15], a[236:239], a[64:67], a[12:15]
  ds_read_b64_tr_b16 a[252:253], v243 offset:8192
  v_mfma_f32_16x16x32_bf16 a[28:31], a[236:239], a[68:71], a[28:31]
  v_mfma_f32_16x16x32_bf16 a[44:47], a[236:239], a[72:75], a[44:47]
  ds_read_b64_tr_b16 a[254:255], v243 offset:9216
  v_mfma_f32_16x16x32_bf16 a[60:63], a[236:239], a[76:79], a[60:63]
  s_mov_b32 s45, 16384
  buffer_load_dwordx4 a[64:67], v200, s[12:15], s45 offen offset:0
  s_waitcnt lgkmcnt(5)
  v_mfma_f32_16x16x32_bf16 v[0:3], a[240:243], a[80:83], v[0:3]
  ds_read_b64_tr_b16 a[224:225], v244 offset:8192
  v_mfma_f32_16x16x32_bf16 v[32:35], a[240:243], a[84:87], v[32:35]
  v_mfma_f32_16x16x32_bf16 v[64:67], a[240:243], a[88:91], v[64:67]
  ds_read_b64_tr_b16 a[226:227], v244 offset:9216
  v_mfma_f32_16x16x32_bf16 v[96:99], a[240:243], a[92:95], v[96:99]
  v_mfma_f32_16x16x32_bf16 v[4:7], a[244:247], a[80:83], v[4:7]
  s_mov_b32 s45, 36864
  buffer_load_dwordx4 a[68:71], v200, s[12:15], s45 offen offset:0
  ds_read_b64_tr_b16 a[228:229], v245 offset:8192
  v_mfma_f32_16x16x32_bf16 v[36:39], a[244:247], a[84:87], v[36:39]
  s_add_u32 s47, s94, 0
  buffer_store_dwordx4 v[216:219], v238, s[88:91], s47 offen
  v_mfma_f32_16x16x32_bf16 v[68:71], a[244:247], a[88:91], v[68:71]
  ds_read_b64_tr_b16 a[230:231], v245 offset:9216
  v_mfma_f32_16x16x32_bf16 v[100:103], a[244:247], a[92:95], v[100:103]
  s_waitcnt lgkmcnt(4)
  v_mfma_f32_16x16x32_bf16 v[8:11], a[248:251], a[80:83], v[8:11]
  ds_read_b64_tr_b16 a[232:233], v246 offset:8192
  v_mfma_f32_16x16x32_bf16 v[40:43], a[248:251], a[84:87], v[40:43]
  s_mov_b32 s45, 57344
  buffer_load_dwordx4 a[72:75], v200, s[12:15], s45 offen offset:0
  v_mfma_f32_16x16x32_bf16 v[72:75], a[248:251], a[88:91], v[72:75]
  ds_read_b64_tr_b16 a[234:235], v246 offset:9216
  v_mfma_f32_16x16x32_bf16 v[104:107], a[248:251], a[92:95], v[104:107]
  v_mfma_f32_16x16x32_bf16 v[12:15], a[252:255], a[80:83], v[12:15]
  ds_read_b64_tr_b16 a[236:237], v247 offset:8192
  v_mfma_f32_16x16x32_bf16 v[44:47], a[252:255], a[84:87], v[44:47]
  s_add_u32 s47, s94, 186368
  buffer_store_dwordx4 v[220:223], v238, s[88:91], s47 offen
  v_mfma_f32_16x16x32_bf16 v[76:79], a[252:255], a[88:91], v[76:79]
  s_mov_b32 s45, 77824
  buffer_load_dwordx4 a[76:79], v200, s[12:15], s45 offen offset:0
  ds_read_b64_tr_b16 a[238:239], v247 offset:9216
  v_mfma_f32_16x16x32_bf16 v[108:111], a[252:255], a[92:95], v[108:111]
  s_waitcnt lgkmcnt(4)
  v_mfma_f32_16x16x32_bf16 v[16:19], a[224:227], a[80:83], v[16:19]
  ds_read_b64_tr_b16 a[240:241], v210 offset:4096
  v_mfma_f32_16x16x32_bf16 v[48:51], a[224:227], a[84:87], v[48:51]
  v_mfma_f32_16x16x32_bf16 v[80:83], a[224:227], a[88:91], v[80:83]
  ds_read_b64_tr_b16 a[242:243], v210 offset:4608
  v_mfma_f32_16x16x32_bf16 v[112:115], a[224:227], a[92:95], v[112:115]
  v_mfma_f32_16x16x32_bf16 v[20:23], a[228:231], a[80:83], v[20:23]
  ds_read_b64_tr_b16 a[244:245], v211 offset:4096
  v_mfma_f32_16x16x32_bf16 v[52:55], a[228:231], a[84:87], v[52:55]
  s_add_u32 s47, s94, 372736
  buffer_store_dwordx4 v[224:227], v238, s[88:91], s47 offen
  v_mfma_f32_16x16x32_bf16 v[84:87], a[228:231], a[88:91], v[84:87]
  ds_read_b64_tr_b16 a[246:247], v211 offset:4608
  v_mfma_f32_16x16x32_bf16 v[116:119], a[228:231], a[92:95], v[116:119]
  s_waitcnt lgkmcnt(4)
  v_mfma_f32_16x16x32_bf16 v[24:27], a[232:235], a[80:83], v[24:27]
  ds_read_b64_tr_b16 a[248:249], v212 offset:4096
  v_mfma_f32_16x16x32_bf16 v[56:59], a[232:235], a[84:87], v[56:59]
  v_mfma_f32_16x16x32_bf16 v[88:91], a[232:235], a[88:91], v[88:91]
  ds_read_b64_tr_b16 a[250:251], v212 offset:4608
  v_mfma_f32_16x16x32_bf16 v[120:123], a[232:235], a[92:95], v[120:123]
  v_mfma_f32_16x16x32_bf16 v[28:31], a[236:239], a[80:83], v[28:31]
  ds_read_b64_tr_b16 a[252:253], v213 offset:4096
  v_mfma_f32_16x16x32_bf16 v[60:63], a[236:239], a[84:87], v[60:63]
  s_add_u32 s47, s94, 559104
  buffer_store_dwordx4 v[228:231], v238, s[88:91], s47 offen
  v_mfma_f32_16x16x32_bf16 v[92:95], a[236:239], a[88:91], v[92:95]
  ds_read_b64_tr_b16 a[254:255], v213 offset:4608
  v_mfma_f32_16x16x32_bf16 v[124:127], a[236:239], a[92:95], v[124:127]
  s_barrier
  s_waitcnt lgkmcnt(4)
  v_mfma_f32_16x16x32_bf16 a[0:3], a[240:243], a[80:83], a[0:3]
  ds_read_b64_tr_b16 a[224:225], v240 offset:16384
  v_mfma_f32_16x16x32_bf16 a[16:19], a[240:243], a[84:87], a[16:19]
  s_add_u32 m0, s32, 49152
  s_add_u32 s46, s62, 3670016
  buffer_load_dwordx4 v214, s[20:23], s46 offen lds
  v_mfma_f32_16x16x32_bf16 a[32:35], a[240:243], a[88:91], a[32:35]
  ds_read_b64_tr_b16 a[226:227], v240 offset:17408
  v_mfma_f32_16x16x32_bf16 a[48:51], a[240:243], a[92:95], a[48:51]
  v_mfma_f32_16x16x32_bf16 a[4:7], a[244:247], a[80:83], a[4:7]
  ds_read_b64_tr_b16 a[228:229], v241 offset:16384
  v_mfma_f32_16x16x32_bf16 a[20:23], a[244:247], a[84:87], a[20:23]
  v_mfma_f32_16x16x32_bf16 a[36:39], a[244:247], a[88:91], a[36:39]
  ds_read_b64_tr_b16 a[230:231], v241 offset:17408
  v_mfma_f32_16x16x32_bf16 a[52:55], a[244:247], a[92:95], a[52:55]
  s_waitcnt lgkmcnt(4)
  v_mfma_f32_16x16x32_bf16 a[8:11], a[248:251], a[80:83], a[8:11]
  ds_read_b64_tr_b16 a[232:233], v242 offset:16384
  v_mfma_f32_16x16x32_bf16 a[24:27], a[248:251], a[84:87], a[24:27]
  v_mfma_f32_16x16x32_bf16 a[40:43], a[248:251], a[88:91], a[40:43]
  ds_read_b64_tr_b16 a[234:235], v242 offset:17408
  v_mfma_f32_16x16x32_bf16 a[56:59], a[248:251], a[92:95], a[56:59]
  s_add_u32 m0, s32, 50176
  s_add_u32 s46, s62, 3702784
  buffer_load_dwordx4 v214, s[20:23], s46 offen lds
  v_mfma_f32_16x16x32_bf16 a[12:15], a[252:255], a[80:83], a[12:15]
  ds_read_b64_tr_b16 a[236:237], v243 offset:16384
  v_mfma_f32_16x16x32_bf16 a[28:31], a[252:255], a[84:87], a[28:31]
  v_mfma_f32_16x16x32_bf16 a[44:47], a[252:255], a[88:91], a[44:47]
  ds_read_b64_tr_b16 a[238:239], v243 offset:17408
  v_mfma_f32_16x16x32_bf16 a[60:63], a[252:255], a[92:95], a[60:63]
  s_mov_b32 s45, 16384
  buffer_load_dwordx4 a[80:83], v200, s[12:15], s45 offen offset:1024
  s_waitcnt lgkmcnt(4)
  v_mfma_f32_16x16x32_bf16 v[0:3], a[224:227], a[96:99], v[0:3]
  ds_read_b64_tr_b16 a[240:241], v244 offset:16384
  v_mfma_f32_16x16x32_bf16 v[32:35], a[224:227], a[100:103], v[32:35]
  v_mfma_f32_16x16x32_bf16 v[64:67], a[224:227], a[104:107], v[64:67]
  ds_read_b64_tr_b16 a[242:243], v244 offset:17408
  v_mfma_f32_16x16x32_bf16 v[96:99], a[224:227], a[108:111], v[96:99]
  v_mfma_f32_16x16x32_bf16 v[4:7], a[228:231], a[96:99], v[4:7]
  s_mov_b32 s45, 36864
  buffer_load_dwordx4 a[84:87], v200, s[12:15], s45 offen offset:1024
  ds_read_b64_tr_b16 a[244:245], v245 offset:16384
  v_mfma_f32_16x16x32_bf16 v[36:39], a[228:231], a[100:103], v[36:39]
  s_add_u32 m0, s32, 51200
  s_add_u32 s46, s62, 3735552
  buffer_load_dwordx4 v214, s[20:23], s46 offen lds
  v_mfma_f32_16x16x32_bf16 v[68:71], a[228:231], a[104:107], v[68:71]
  ds_read_b64_tr_b16 a[246:247], v245 offset:17408
  v_mfma_f32_16x16x32_bf16 v[100:103], a[228:231], a[108:111], v[100:103]
  s_waitcnt lgkmcnt(4)
  v_mfma_f32_16x16x32_bf16 v[8:11], a[232:235], a[96:99], v[8:11]
  ds_read_b64_tr_b16 a[248:249], v246 offset:16384
  v_mfma_f32_16x16x32_bf16 v[40:43], a[232:235], a[100:103], v[40:43]
  s_mov_b32 s45, 57344
  buffer_load_dwordx4 a[88:91], v200, s[12:15], s45 offen offset:1024
  v_mfma_f32_16x16x32_bf16 v[72:75], a[232:235], a[104:107], v[72:75]
  ds_read_b64_tr_b16 a[250:251], v246 offset:17408
  v_mfma_f32_16x16x32_bf16 v[104:107], a[232:235], a[108:111], v[104:107]
  v_mfma_f32_16x16x32_bf16 v[12:15], a[236:239], a[96:99], v[12:15]
  ds_read_b64_tr_b16 a[252:253], v247 offset:16384
  v_mfma_f32_16x16x32_bf16 v[44:47], a[236:239], a[100:103], v[44:47]
  v_mfma_f32_16x16x32_bf16 v[76:79], a[236:239], a[104:107], v[76:79]
  s_mov_b32 s45, 77824
  buffer_load_dwordx4 a[92:95], v200, s[12:15], s45 offen offset:1024
  ds_read_b64_tr_b16 a[254:255], v247 offset:17408
  v_mfma_f32_16x16x32_bf16 v[108:111], a[236:239], a[108:111], v[108:111]
  s_add_u32 m0, s32, 52224
  s_add_u32 s46, s62, 3768320
  buffer_load_dwordx4 v214, s[20:23], s46 offen lds
  s_waitcnt lgkmcnt(4)
  v_mfma_f32_16x16x32_bf16 v[16:19], a[240:243], a[96:99], v[16:19]
  ds_read_b64_tr_b16 a[224:225], v210 offset:8192
  v_mfma_f32_16x16x32_bf16 v[48:51], a[240:243], a[100:103], v[48:51]
  v_mfma_f32_16x16x32_bf16 v[80:83], a[240:243], a[104:107], v[80:83]
  ds_read_b64_tr_b16 a[226:227], v210 offset:8704
  v_mfma_f32_16x16x32_bf16 v[112:115], a[240:243], a[108:111], v[112:115]
  v_mfma_f32_16x16x32_bf16 v[20:23], a[244:247], a[96:99], v[20:23]
  ds_read_b64_tr_b16 a[228:229], v211 offset:8192
  v_mfma_f32_16x16x32_bf16 v[52:55], a[244:247], a[100:103], v[52:55]
  v_mfma_f32_16x16x32_bf16 v[84:87], a[244:247], a[104:107], v[84:87]
  ds_read_b64_tr_b16 a[230:231], v211 offset:8704
  v_mfma_f32_16x16x32_bf16 v[116:119], a[244:247], a[108:111], v[116:119]
  s_waitcnt lgkmcnt(4)
  v_mfma_f32_16x16x32_bf16 v[24:27], a[248:251], a[96:99], v[24:27]
  ds_read_b64_tr_b16 a[232:233], v212 offset:8192
  v_mfma_f32_16x16x32_bf16 v[56:59], a[248:251], a[100:103], v[56:59]
  s_add_u32 m0, s60, 40960
  s_add_u32 s46, s61, 1548288
  buffer_load_dwordx4 v215, s[16:19], s46 offen lds
  v_mfma_f32_16x16x32_bf16 v[88:91], a[248:251], a[104:107], v[88:91]
  ds_read_b64_tr_b16 a[234:235], v212 offset:8704
  v_mfma_f32_16x16x32_bf16 v[120:123], a[248:251], a[108:111], v[120:123]
  v_mfma_f32_16x16x32_bf16 v[28:31], a[252:255], a[96:99], v[28:31]
  ds_read_b64_tr_b16 a[236:237], v213 offset:8192
  v_mfma_f32_16x16x32_bf16 v[60:63], a[252:255], a[100:103], v[60:63]
  v_mfma_f32_16x16x32_bf16 v[92:95], a[252:255], a[104:107], v[92:95]
  ds_read_b64_tr_b16 a[238:239], v213 offset:8704
  v_mfma_f32_16x16x32_bf16 v[124:127], a[252:255], a[108:111], v[124:127]
  s_waitcnt lgkmcnt(4)
  v_mfma_f32_16x16x32_bf16 a[0:3], a[224:227], a[96:99], a[0:3]
  ds_read_b64_tr_b16 a[240:241], v240 offset:24576
  v_mfma_f32_16x16x32_bf16 a[16:19], a[224:227], a[100:103], a[16:19]
  v_mfma_f32_16x16x32_bf16 a[32:35], a[224:227], a[104:107], a[32:35]
  ds_read_b64_tr_b16 a[242:243], v240 offset:25600
  v_mfma_f32_16x16x32_bf16 a[48:51], a[224:227], a[108:111], a[48:51]
  s_add_u32 m0, s60, 41984
  s_add_u32 s46, s61, 1575936
  buffer_load_dwordx4 v215, s[16:19], s46 offen lds
  v_mfma_f32_16x16x32_bf16 a[4:7], a[228:231], a[96:99], a[4:7]
  ds_read_b64_tr_b16 a[244:245], v241 offset:24576
  v_mfma_f32_16x16x32_bf16 a[20:23], a[228:231], a[100:103], a[20:23]
  v_mfma_f32_16x16x32_bf16 a[36:39], a[228:231], a[104:107], a[36:39]
  ds_read_b64_tr_b16 a[246:247], v241 offset:25600
  v_mfma_f32_16x16x32_bf16 a[52:55], a[228:231], a[108:111], a[52:55]
  s_waitcnt lgkmcnt(4)
  v_mfma_f32_16x16x32_bf16 a[8:11], a[232:235], a[96:99], a[8:11]
  ds_read_b64_tr_b16 a[248:249], v242 offset:24576
  v_mfma_f32_16x16x32_bf16 a[24:27], a[232:235], a[100:103], a[24:27]
  v_mfma_f32_16x16x32_bf16 a[40:43], a[232:235], a[104:107], a[40:43]
  ds_read_b64_tr_b16 a[250:251], v242 offset:25600
  v_mfma_f32_16x16x32_bf16 a[56:59], a[232:235], a[108:111], a[56:59]
  v_mfma_f32_16x16x32_bf16 a[12:15], a[236:239], a[96:99], a[12:15]
  ds_read_b64_tr_b16 a[252:253], v243 offset:24576
  v_mfma_f32_16x16x32_bf16 a[28:31], a[236:239], a[100:103], a[28:31]
  v_mfma_f32_16x16x32_bf16 a[44:47], a[236:239], a[104:107], a[44:47]
  ds_read_b64_tr_b16 a[254:255], v243 offset:25600
  v_mfma_f32_16x16x32_bf16 a[60:63], a[236:239], a[108:111], a[60:63]
  s_mov_b32 s45, 18432
  buffer_load_dwordx4 a[96:99], v200, s[12:15], s45 offen offset:0
  s_waitcnt lgkmcnt(4)
  v_mfma_f32_16x16x32_bf16 v[0:3], a[240:243], a[112:115], v[0:3]
  ds_read_b64_tr_b16 a[224:225], v244 offset:24576
  v_mfma_f32_16x16x32_bf16 v[32:35], a[240:243], a[116:119], v[32:35]
  v_mfma_f32_16x16x32_bf16 v[64:67], a[240:243], a[120:123], v[64:67]
  ds_read_b64_tr_b16 a[226:227], v244 offset:25600
  v_mfma_f32_16x16x32_bf16 v[96:99], a[240:243], a[124:127], v[96:99]
  v_mfma_f32_16x16x32_bf16 v[4:7], a[244:247], a[112:115], v[4:7]
  s_mov_b32 s45, 38912
  buffer_load_dwordx4 a[100:103], v200, s[12:15], s45 offen offset:0
  ds_read_b64_tr_b16 a[228:229], v245 offset:24576
  v_mfma_f32_16x16x32_bf16 v[36:39], a[244:247], a[116:119], v[36:39]
  v_mfma_f32_16x16x32_bf16 v[68:71], a[244:247], a[120:123], v[68:71]
  ds_read_b64_tr_b16 a[230:231], v245 offset:25600
  v_mfma_f32_16x16x32_bf16 v[100:103], a[244:247], a[124:127], v[100:103]
  s_waitcnt lgkmcnt(4)
  v_mfma_f32_16x16x32_bf16 v[8:11], a[248:251], a[112:115], v[8:11]
  ds_read_b64_tr_b16 a[232:233], v246 offset:24576
  v_mfma_f32_16x16x32_bf16 v[40:43], a[248:251], a[116:119], v[40:43]
  s_mov_b32 s45, 59392
  buffer_load_dwordx4 a[104:107], v200, s[12:15], s45 offen offset:0
  v_mfma_f32_16x16x32_bf16 v[72:75], a[248:251], a[120:123], v[72:75]
  ds_read_b64_tr_b16 a[234:235], v246 offset:25600
  v_mfma_f32_16x16x32_bf16 v[104:107], a[248:251], a[124:127], v[104:107]
  v_mfma_f32_16x16x32_bf16 v[12:15], a[252:255], a[112:115], v[12:15]
  ds_read_b64_tr_b16 a[236:237], v247 offset:24576
  s_add_u32 m0, s63, 0
  s_add_u32 s46, s93, 0
  buffer_load_dwordx4 v236, s[84:87], s46 offen lds
  v_mfma_f32_16x16x32_bf16 v[44:47], a[252:255], a[116:119], v[44:47]
  v_mfma_f32_16x16x32_bf16 v[76:79], a[252:255], a[120:123], v[76:79]
  s_mov_b32 s45, 79872
  buffer_load_dwordx4 a[108:111], v200, s[12:15], s45 offen offset:0
  ds_read_b64_tr_b16 a[238:239], v247 offset:25600
  v_mfma_f32_16x16x32_bf16 v[108:111], a[252:255], a[124:127], v[108:111]
  s_waitcnt lgkmcnt(4)
  v_mfma_f32_16x16x32_bf16 v[16:19], a[224:227], a[112:115], v[16:19]
  ds_read_b64_tr_b16 a[240:241], v210 offset:12288
  v_mfma_f32_16x16x32_bf16 v[48:51], a[224:227], a[116:119], v[48:51]
  v_mfma_f32_16x16x32_bf16 v[80:83], a[224:227], a[120:123], v[80:83]
  ds_read_b64_tr_b16 a[242:243], v210 offset:12800
  v_mfma_f32_16x16x32_bf16 v[112:115], a[224:227], a[124:127], v[112:115]
  v_mfma_f32_16x16x32_bf16 v[20:23], a[228:231], a[112:115], v[20:23]
  ds_read_b64_tr_b16 a[244:245], v211 offset:12288
  s_add_u32 m0, s63, 1024
  s_add_u32 s46, s93, 10240
  buffer_load_dwordx4 v236, s[84:87], s46 offen lds
  v_mfma_f32_16x16x32_bf16 v[52:55], a[228:231], a[116:119], v[52:55]
  v_mfma_f32_16x16x32_bf16 v[84:87], a[228:231], a[120:123], v[84:87]
  ds_read_b64_tr_b16 a[246:247], v211 offset:12800
  v_mfma_f32_16x16x32_bf16 v[116:119], a[228:231], a[124:127], v[116:119]
  s_waitcnt lgkmcnt(4)
  v_mfma_f32_16x16x32_bf16 v[24:27], a[232:235], a[112:115], v[24:27]
  ds_read_b64_tr_b16 a[248:249], v212 offset:12288
  v_mfma_f32_16x16x32_bf16 v[56:59], a[232:235], a[116:119], v[56:59]
  v_mfma_f32_16x16x32_bf16 v[88:91], a[232:235], a[120:123], v[88:91]
  ds_read_b64_tr_b16 a[250:251], v212 offset:12800
  v_mfma_f32_16x16x32_bf16 v[120:123], a[232:235], a[124:127], v[120:123]
  v_mfma_f32_16x16x32_bf16 v[28:31], a[236:239], a[112:115], v[28:31]
  ds_read_b64_tr_b16 a[252:253], v213 offset:12288
  s_add_u32 m0, s63, 2048
  s_add_u32 s46, s93, 20480
  buffer_load_dwordx4 v236, s[84:87], s46 offen lds
  v_mfma_f32_16x16x32_bf16 v[60:63], a[236:239], a[116:119], v[60:63]
  v_mfma_f32_16x16x32_bf16 v[92:95], a[236:239], a[120:123], v[92:95]
  ds_read_b64_tr_b16 a[254:255], v213 offset:12800
  v_mfma_f32_16x16x32_bf16 v[124:127], a[236:239], a[124:127], v[124:127]
  s_waitcnt vmcnt(25)
  s_barrier
  s_waitcnt lgkmcnt(4)
  v_mfma_f32_16x16x32_bf16 a[0:3], a[240:243], a[112:115], a[0:3]
  ds_read_b64_tr_b16 a[224:225], v202 offset:32768
  v_mfma_f32_16x16x32_bf16 a[16:19], a[240:243], a[116:119], a[16:19]
  v_mfma_f32_16x16x32_bf16 a[32:35], a[240:243], a[120:123], a[32:35]
  ds_read_b64_tr_b16 a[226:227], v202 offset:33792
  v_mfma_f32_16x16x32_bf16 a[48:51], a[240:243], a[124:127], a[48:51]
  v_mfma_f32_16x16x32_bf16 a[4:7], a[244:247], a[112:115], a[4:7]
  ds_read_b64_tr_b16 a[228:229], v203 offset:32768
  s_add_u32 m0, s63, 3072
  s_add_u32 s46, s93, 30720
  buffer_load_dwordx4 v236, s[84:87], s46 offen lds
  v_mfma_f32_16x16x32_bf16 a[20:23], a[244:247], a[116:119], a[20:23]
  v_mfma_f32_16x16x32_bf16 a[36:39], a[244:247], a[120:123], a[36:39]
  ds_read_b64_tr_b16 a[230:231], v203 offset:33792
  v_mfma_f32_16x16x32_bf16 a[52:55], a[244:247], a[124:127], a[52:55]
  s_waitcnt lgkmcnt(4)
  v_mfma_f32_16x16x32_bf16 a[8:11], a[248:251], a[112:115], a[8:11]
  ds_read_b64_tr_b16 a[232:233], v204 offset:32768
  v_mfma_f32_16x16x32_bf16 a[24:27], a[248:251], a[116:119], a[24:27]
  v_mfma_f32_16x16x32_bf16 a[40:43], a[248:251], a[120:123], a[40:43]
  ds_read_b64_tr_b16 a[234:235], v204 offset:33792
  v_mfma_f32_16x16x32_bf16 a[56:59], a[248:251], a[124:127], a[56:59]
  v_mfma_f32_16x16x32_bf16 a[12:15], a[252:255], a[112:115], a[12:15]
  ds_read_b64_tr_b16 a[236:237], v205 offset:32768
  v_mfma_f32_16x16x32_bf16 a[28:31], a[252:255], a[116:119], a[28:31]
  v_mfma_f32_16x16x32_bf16 a[44:47], a[252:255], a[120:123], a[44:47]
  ds_read_b64_tr_b16 a[238:239], v205 offset:33792
  v_mfma_f32_16x16x32_bf16 a[60:63], a[252:255], a[124:127], a[60:63]
  s_mov_b32 s45, 18432
  buffer_load_dwordx4 a[112:115], v200, s[12:15], s45 offen offset:1024
  s_waitcnt lgkmcnt(4)
  v_mfma_f32_16x16x32_bf16 v[0:3], a[224:227], a[128:131], v[0:3]
  ds_read_b64_tr_b16 a[240:241], v206 offset:32768
  v_mfma_f32_16x16x32_bf16 v[32:35], a[224:227], a[132:135], v[32:35]
  v_mfma_f32_16x16x32_bf16 v[64:67], a[224:227], a[136:139], v[64:67]
  ds_read_b64_tr_b16 a[242:243], v206 offset:33792
  v_mfma_f32_16x16x32_bf16 v[96:99], a[224:227], a[140:143], v[96:99]
  v_mfma_f32_16x16x32_bf16 v[4:7], a[228:231], a[128:131], v[4:7]
  s_mov_b32 s45, 38912
  buffer_load_dwordx4 a[116:119], v200, s[12:15], s45 offen offset:1024
  ds_read_b64_tr_b16 a[244:245], v207 offset:32768
  v_mfma_f32_16x16x32_bf16 v[36:39], a[228:231], a[132:135], v[36:39]
  v_mfma_f32_16x16x32_bf16 v[68:71], a[228:231], a[136:139], v[68:71]
  ds_read_b64_tr_b16 a[246:247], v207 offset:33792
  v_mfma_f32_16x16x32_bf16 v[100:103], a[228:231], a[140:143], v[100:103]
  s_waitcnt lgkmcnt(4)
  v_mfma_f32_16x16x32_bf16 v[8:11], a[232:235], a[128:131], v[8:11]
  ds_read_b64_tr_b16 a[248:249], v208 offset:32768
  v_mfma_f32_16x16x32_bf16 v[40:43], a[232:235], a[132:135], v[40:43]
  s_mov_b32 s45, 59392
  buffer_load_dwordx4 a[120:123], v200, s[12:15], s45 offen offset:1024
  v_mfma_f32_16x16x32_bf16 v[72:75], a[232:235], a[136:139], v[72:75]
  ds_read_b64_tr_b16 a[250:251], v208 offset:33792
  v_mfma_f32_16x16x32_bf16 v[104:107], a[232:235], a[140:143], v[104:107]
  v_mfma_f32_16x16x32_bf16 v[12:15], a[236:239], a[128:131], v[12:15]
  ds_read_b64_tr_b16 a[252:253], v209 offset:32768
  v_mfma_f32_16x16x32_bf16 v[44:47], a[236:239], a[132:135], v[44:47]
  v_mfma_f32_16x16x32_bf16 v[76:79], a[236:239], a[136:139], v[76:79]
  s_mov_b32 s45, 79872
  buffer_load_dwordx4 a[124:127], v200, s[12:15], s45 offen offset:1024
  ds_read_b64_tr_b16 a[254:255], v209 offset:33792
  v_mfma_f32_16x16x32_bf16 v[108:111], a[236:239], a[140:143], v[108:111]
  s_waitcnt lgkmcnt(4)
  v_mfma_f32_16x16x32_bf16 v[16:19], a[240:243], a[128:131], v[16:19]
  ds_read_b64_tr_b16 a[224:225], v210 offset:32768
  v_mfma_f32_16x16x32_bf16 v[48:51], a[240:243], a[132:135], v[48:51]
  v_mfma_f32_16x16x32_bf16 v[80:83], a[240:243], a[136:139], v[80:83]
  ds_read_b64_tr_b16 a[226:227], v210 offset:33280
  v_mfma_f32_16x16x32_bf16 v[112:115], a[240:243], a[140:143], v[112:115]
  v_mfma_f32_16x16x32_bf16 v[20:23], a[244:247], a[128:131], v[20:23]
  ds_read_b64_tr_b16 a[228:229], v211 offset:32768
  v_mfma_f32_16x16x32_bf16 v[52:55], a[244:247], a[132:135], v[52:55]
  v_mfma_f32_16x16x32_bf16 v[84:87], a[244:247], a[136:139], v[84:87]
  ds_read_b64_tr_b16 a[230:231], v211 offset:33280
  v_mfma_f32_16x16x32_bf16 v[116:119], a[244:247], a[140:143], v[116:119]
  s_waitcnt lgkmcnt(4)
  v_mfma_f32_16x16x32_bf16 v[24:27], a[248:251], a[128:131], v[24:27]
  ds_read_b64_tr_b16 a[232:233], v212 offset:32768
  v_mfma_f32_16x16x32_bf16 v[56:59], a[248:251], a[132:135], v[56:59]
  v_mfma_f32_16x16x32_bf16 v[88:91], a[248:251], a[136:139], v[88:91]
  ds_read_b64_tr_b16 a[234:235], v212 offset:33280
  v_mfma_f32_16x16x32_bf16 v[120:123], a[248:251], a[140:143], v[120:123]
  v_mfma_f32_16x16x32_bf16 v[28:31], a[252:255], a[128:131], v[28:31]
  ds_read_b64_tr_b16 a[236:237], v213 offset:32768
  v_mfma_f32_16x16x32_bf16 v[60:63], a[252:255], a[132:135], v[60:63]
  v_mfma_f32_16x16x32_bf16 v[92:95], a[252:255], a[136:139], v[92:95]
  ds_read_b64_tr_b16 a[238:239], v213 offset:33280
  v_mfma_f32_16x16x32_bf16 v[124:127], a[252:255], a[140:143], v[124:127]
  s_waitcnt lgkmcnt(4)
  v_mfma_f32_16x16x32_bf16 a[0:3], a[224:227], a[128:131], a[0:3]
  ds_read_b64_tr_b16 a[240:241], v202 offset:40960
  v_mfma_f32_16x16x32_bf16 a[16:19], a[224:227], a[132:135], a[16:19]
  v_mfma_f32_16x16x32_bf16 a[32:35], a[224:227], a[136:139], a[32:35]
  ds_read_b64_tr_b16 a[242:243], v202 offset:41984
  v_mfma_f32_16x16x32_bf16 a[48:51], a[224:227], a[140:143], a[48:51]
  v_mfma_f32_16x16x32_bf16 a[4:7], a[228:231], a[128:131], a[4:7]
  ds_read_b64_tr_b16 a[244:245], v203 offset:40960
  v_mfma_f32_16x16x32_bf16 a[20:23], a[228:231], a[132:135], a[20:23]
  v_mfma_f32_16x16x32_bf16 a[36:39], a[228:231], a[136:139], a[36:39]
  ds_read_b64_tr_b16 a[246:247], v203 offset:41984
  v_mfma_f32_16x16x32_bf16 a[52:55], a[228:231], a[140:143], a[52:55]
  s_waitcnt lgkmcnt(4)
  v_mfma_f32_16x16x32_bf16 a[8:11], a[232:235], a[128:131], a[8:11]
  ds_read_b64_tr_b16 a[248:249], v204 offset:40960
  v_mfma_f32_16x16x32_bf16 a[24:27], a[232:235], a[132:135], a[24:27]
  v_mfma_f32_16x16x32_bf16 a[40:43], a[232:235], a[136:139], a[40:43]
  ds_read_b64_tr_b16 a[250:251], v204 offset:41984
  v_mfma_f32_16x16x32_bf16 a[56:59], a[232:235], a[140:143], a[56:59]
  v_mfma_f32_16x16x32_bf16 a[12:15], a[236:239], a[128:131], a[12:15]
  ds_read_b64_tr_b16 a[252:253], v205 offset:40960
  v_mfma_f32_16x16x32_bf16 a[28:31], a[236:239], a[132:135], a[28:31]
  v_mfma_f32_16x16x32_bf16 a[44:47], a[236:239], a[136:139], a[44:47]
  ds_read_b64_tr_b16 a[254:255], v205 offset:41984
  v_mfma_f32_16x16x32_bf16 a[60:63], a[236:239], a[140:143], a[60:63]
  s_waitcnt lgkmcnt(4)
  v_mfma_f32_16x16x32_bf16 v[0:3], a[240:243], a[144:147], v[0:3]
  ds_read_b64_tr_b16 a[224:225], v206 offset:40960
  s_add_u32 m0, s32, 65536
  s_nop 0
  buffer_load_dwordx4 v180, s[8:11], s37 offen offset:0 lds
  v_mfma_f32_16x16x32_bf16 v[32:35], a[240:243], a[148:151], v[32:35]
  v_mfma_f32_16x16x32_bf16 v[64:67], a[240:243], a[152:155], v[64:67]
  ds_read_b64_tr_b16 a[226:227], v206 offset:41984
  v_mfma_f32_16x16x32_bf16 v[96:99], a[240:243], a[156:159], v[96:99]
  v_mfma_f32_16x16x32_bf16 v[4:7], a[244:247], a[144:147], v[4:7]
  ds_read_b64_tr_b16 a[228:229], v207 offset:40960
  v_mfma_f32_16x16x32_bf16 v[36:39], a[244:247], a[148:151], v[36:39]
  v_mfma_f32_16x16x32_bf16 v[68:71], a[244:247], a[152:155], v[68:71]
  ds_read_b64_tr_b16 a[230:231], v207 offset:41984
  v_mfma_f32_16x16x32_bf16 v[100:103], a[244:247], a[156:159], v[100:103]
  s_waitcnt lgkmcnt(4)
  v_mfma_f32_16x16x32_bf16 v[8:11], a[248:251], a[144:147], v[8:11]
  ds_read_b64_tr_b16 a[232:233], v208 offset:40960
  v_mfma_f32_16x16x32_bf16 v[40:43], a[248:251], a[148:151], v[40:43]
  v_mfma_f32_16x16x32_bf16 v[72:75], a[248:251], a[152:155], v[72:75]
  ds_read_b64_tr_b16 a[234:235], v208 offset:41984
  buffer_load_dwordx4 v181, s[8:11], s37 offen offset:1024 lds
  v_mfma_f32_16x16x32_bf16 v[104:107], a[248:251], a[156:159], v[104:107]
  v_mfma_f32_16x16x32_bf16 v[12:15], a[252:255], a[144:147], v[12:15]
  ds_read_b64_tr_b16 a[236:237], v209 offset:40960
  v_mfma_f32_16x16x32_bf16 v[44:47], a[252:255], a[148:151], v[44:47]
  v_mfma_f32_16x16x32_bf16 v[76:79], a[252:255], a[152:155], v[76:79]
  ds_read_b64_tr_b16 a[238:239], v209 offset:41984
  v_mfma_f32_16x16x32_bf16 v[108:111], a[252:255], a[156:159], v[108:111]
  s_waitcnt lgkmcnt(4)
  v_mfma_f32_16x16x32_bf16 v[16:19], a[224:227], a[144:147], v[16:19]
  ds_read_b64_tr_b16 a[240:241], v210 offset:36864
  v_mfma_f32_16x16x32_bf16 v[48:51], a[224:227], a[148:151], v[48:51]
  v_mfma_f32_16x16x32_bf16 v[80:83], a[224:227], a[152:155], v[80:83]
  ds_read_b64_tr_b16 a[242:243], v210 offset:37376
  v_mfma_f32_16x16x32_bf16 v[112:115], a[224:227], a[156:159], v[112:115]
  v_mfma_f32_16x16x32_bf16 v[20:23], a[228:231], a[144:147], v[20:23]
  ds_read_b64_tr_b16 a[244:245], v211 offset:36864
  buffer_load_dwordx4 v180, s[8:11], s37 offen offset:2048 lds
  v_mfma_f32_16x16x32_bf16 v[52:55], a[228:231], a[148:151], v[52:55]
  v_mfma_f32_16x16x32_bf16 v[84:87], a[228:231], a[152:155], v[84:87]
  ds_read_b64_tr_b16 a[246:247], v211 offset:37376
  v_mfma_f32_16x16x32_bf16 v[116:119], a[228:231], a[156:159], v[116:119]
  s_waitcnt lgkmcnt(4)
  v_mfma_f32_16x16x32_bf16 v[24:27], a[232:235], a[144:147], v[24:27]
  ds_read_b64_tr_b16 a[248:249], v212 offset:36864
  v_mfma_f32_16x16x32_bf16 v[56:59], a[232:235], a[148:151], v[56:59]
  v_mfma_f32_16x16x32_bf16 v[88:91], a[232:235], a[152:155], v[88:91]
  ds_read_b64_tr_b16 a[250:251], v212 offset:37376
  v_mfma_f32_16x16x32_bf16 v[120:123], a[232:235], a[156:159], v[120:123]
  v_mfma_f32_16x16x32_bf16 v[28:31], a[236:239], a[144:147], v[28:31]
  ds_read_b64_tr_b16 a[252:253], v213 offset:36864
  v_mfma_f32_16x16x32_bf16 v[60:63], a[236:239], a[148:151], v[60:63]
  v_mfma_f32_16x16x32_bf16 v[92:95], a[236:239], a[152:155], v[92:95]
  ds_read_b64_tr_b16 a[254:255], v213 offset:37376
  buffer_load_dwordx4 v181, s[8:11], s37 offen offset:3072 lds
  s_add_u32 s37, s37, 16384
  v_mfma_f32_16x16x32_bf16 v[124:127], a[236:239], a[156:159], v[124:127]
  s_waitcnt vmcnt(16)
  s_barrier
  s_waitcnt lgkmcnt(4)
  v_mfma_f32_16x16x32_bf16 a[0:3], a[240:243], a[144:147], a[0:3]
  ds_read_b64_tr_b16 a[224:225], v202 offset:49152
  v_mfma_f32_16x16x32_bf16 a[16:19], a[240:243], a[148:151], a[16:19]
  v_mfma_f32_16x16x32_bf16 a[32:35], a[240:243], a[152:155], a[32:35]
  ds_read_b64_tr_b16 a[226:227], v202 offset:50176
  v_mfma_f32_16x16x32_bf16 a[48:51], a[240:243], a[156:159], a[48:51]
  v_mfma_f32_16x16x32_bf16 a[4:7], a[244:247], a[144:147], a[4:7]
  ds_read_b64_tr_b16 a[228:229], v203 offset:49152
  v_mfma_f32_16x16x32_bf16 a[20:23], a[244:247], a[148:151], a[20:23]
  v_mfma_f32_16x16x32_bf16 a[36:39], a[244:247], a[152:155], a[36:39]
  ds_read_b64_tr_b16 a[230:231], v203 offset:50176
  v_mfma_f32_16x16x32_bf16 a[52:55], a[244:247], a[156:159], a[52:55]
  s_waitcnt lgkmcnt(4)
  v_mfma_f32_16x16x32_bf16 a[8:11], a[248:251], a[144:147], a[8:11]
  ds_read_b64_tr_b16 a[232:233], v204 offset:49152
  v_mfma_f32_16x16x32_bf16 a[24:27], a[248:251], a[148:151], a[24:27]
  v_mfma_f32_16x16x32_bf16 a[40:43], a[248:251], a[152:155], a[40:43]
  ds_read_b64_tr_b16 a[234:235], v204 offset:50176
  v_mfma_f32_16x16x32_bf16 a[56:59], a[248:251], a[156:159], a[56:59]
  v_mfma_f32_16x16x32_bf16 a[12:15], a[252:255], a[144:147], a[12:15]
  ds_read_b64_tr_b16 a[236:237], v205 offset:49152
  v_mfma_f32_16x16x32_bf16 a[28:31], a[252:255], a[148:151], a[28:31]
  v_mfma_f32_16x16x32_bf16 a[44:47], a[252:255], a[152:155], a[44:47]
  ds_read_b64_tr_b16 a[238:239], v205 offset:50176
  v_mfma_f32_16x16x32_bf16 a[60:63], a[252:255], a[156:159], a[60:63]
  s_waitcnt lgkmcnt(4)
  v_mfma_f32_16x16x32_bf16 v[0:3], a[224:227], a[160:163], v[0:3]
  ds_read_b64_tr_b16 a[240:241], v206 offset:49152
  v_mfma_f32_16x16x32_bf16 v[32:35], a[224:227], a[164:167], v[32:35]
  v_mfma_f32_16x16x32_bf16 v[64:67], a[224:227], a[168:171], v[64:67]
  ds_read_b64_tr_b16 a[242:243], v206 offset:50176
  v_mfma_f32_16x16x32_bf16 v[96:99], a[224:227], a[172:175], v[96:99]
  v_mfma_f32_16x16x32_bf16 v[4:7], a[228:231], a[160:163], v[4:7]
  ds_read_b64_tr_b16 a[244:245], v207 offset:49152
  v_mfma_f32_16x16x32_bf16 v[36:39], a[228:231], a[164:167], v[36:39]
  v_mfma_f32_16x16x32_bf16 v[68:71], a[228:231], a[168:171], v[68:71]
  ds_read_b64_tr_b16 a[246:247], v207 offset:50176
  v_mfma_f32_16x16x32_bf16 v[100:103], a[228:231], a[172:175], v[100:103]
  s_waitcnt lgkmcnt(4)
  v_mfma_f32_16x16x32_bf16 v[8:11], a[232:235], a[160:163], v[8:11]
  ds_read_b64_tr_b16 a[248:249], v208 offset:49152
  v_mfma_f32_16x16x32_bf16 v[40:43], a[232:235], a[164:167], v[40:43]
  s_waitcnt vmcnt(8)
  v_mfma_f32_16x16x32_bf16 v[72:75], a[232:235], a[168:171], v[72:75]
  ds_read_b64_tr_b16 a[250:251], v208 offset:50176
  v_mfma_f32_16x16x32_bf16 v[104:107], a[232:235], a[172:175], v[104:107]
  v_mfma_f32_16x16x32_bf16 v[12:15], a[236:239], a[160:163], v[12:15]
  ds_read_b64_tr_b16 a[252:253], v209 offset:49152
  v_mfma_f32_16x16x32_bf16 v[44:47], a[236:239], a[164:167], v[44:47]
  ds_read_b64_tr_b16 v[216:217], v237 offset:0
  v_mfma_f32_16x16x32_bf16 v[76:79], a[236:239], a[168:171], v[76:79]
  ds_read_b64_tr_b16 a[254:255], v209 offset:50176
  v_mfma_f32_16x16x32_bf16 v[108:111], a[236:239], a[172:175], v[108:111]
  s_waitcnt lgkmcnt(5)
  v_mfma_f32_16x16x32_bf16 v[16:19], a[240:243], a[160:163], v[16:19]
  ds_read_b64_tr_b16 a[224:225], v210 offset:40960
  v_mfma_f32_16x16x32_bf16 v[48:51], a[240:243], a[164:167], v[48:51]
  ds_read_b64_tr_b16 v[218:219], v237 offset:2048
  v_mfma_f32_16x16x32_bf16 v[80:83], a[240:243], a[168:171], v[80:83]
  ds_read_b64_tr_b16 a[226:227], v210 offset:41472
  v_mfma_f32_16x16x32_bf16 v[112:115], a[240:243], a[172:175], v[112:115]
  v_mfma_f32_16x16x32_bf16 v[20:23], a[244:247], a[160:163], v[20:23]
  ds_read_b64_tr_b16 a[228:229], v211 offset:40960
  v_mfma_f32_16x16x32_bf16 v[52:55], a[244:247], a[164:167], v[52:55]
  ds_read_b64_tr_b16 v[220:221], v237 offset:32
  v_mfma_f32_16x16x32_bf16 v[84:87], a[244:247], a[168:171], v[84:87]
  ds_read_b64_tr_b16 a[230:231], v211 offset:41472
  v_mfma_f32_16x16x32_bf16 v[116:119], a[244:247], a[172:175], v[116:119]
  s_waitcnt lgkmcnt(6)
  v_mfma_f32_16x16x32_bf16 v[24:27], a[248:251], a[160:163], v[24:27]
  ds_read_b64_tr_b16 a[232:233], v212 offset:40960
  v_mfma_f32_16x16x32_bf16 v[56:59], a[248:251], a[164:167], v[56:59]
  ds_read_b64_tr_b16 v[222:223], v237 offset:2080
  v_mfma_f32_16x16x32_bf16 v[88:91], a[248:251], a[168:171], v[88:91]
  ds_read_b64_tr_b16 a[234:235], v212 offset:41472
  v_mfma_f32_16x16x32_bf16 v[120:123], a[248:251], a[172:175], v[120:123]
  v_mfma_f32_16x16x32_bf16 v[28:31], a[252:255], a[160:163], v[28:31]
  ds_read_b64_tr_b16 a[236:237], v213 offset:40960
  v_mfma_f32_16x16x32_bf16 v[60:63], a[252:255], a[164:167], v[60:63]
  ds_read_b64_tr_b16 v[224:225], v237 offset:64
  v_mfma_f32_16x16x32_bf16 v[92:95], a[252:255], a[168:171], v[92:95]
  ds_read_b64_tr_b16 a[238:239], v213 offset:41472
  v_mfma_f32_16x16x32_bf16 v[124:127], a[252:255], a[172:175], v[124:127]
  s_waitcnt lgkmcnt(6)
  v_mfma_f32_16x16x32_bf16 a[0:3], a[224:227], a[160:163], a[0:3]
  ds_read_b64_tr_b16 a[240:241], v202 offset:57344
  v_mfma_f32_16x16x32_bf16 a[16:19], a[224:227], a[164:167], a[16:19]
  ds_read_b64_tr_b16 v[226:227], v237 offset:2112
  v_mfma_f32_16x16x32_bf16 a[32:35], a[224:227], a[168:171], a[32:35]
  ds_read_b64_tr_b16 a[242:243], v202 offset:58368
  v_mfma_f32_16x16x32_bf16 a[48:51], a[224:227], a[172:175], a[48:51]
  v_mfma_f32_16x16x32_bf16 a[4:7], a[228:231], a[160:163], a[4:7]
  ds_read_b64_tr_b16 a[244:245], v203 offset:57344
  v_mfma_f32_16x16x32_bf16 a[20:23], a[228:231], a[164:167], a[20:23]
  ds_read_b64_tr_b16 v[228:229], v237 offset:96
  v_mfma_f32_16x16x32_bf16 a[36:39], a[228:231], a[168:171], a[36:39]
  ds_read_b64_tr_b16 a[246:247], v203 offset:58368
  v_mfma_f32_16x16x32_bf16 a[52:55], a[228:231], a[172:175], a[52:55]
  s_waitcnt lgkmcnt(6)
  v_mfma_f32_16x16x32_bf16 a[8:11], a[232:235], a[160:163], a[8:11]
  ds_read_b64_tr_b16 a[248:249], v204 offset:57344
  v_mfma_f32_16x16x32_bf16 a[24:27], a[232:235], a[164:167], a[24:27]
  ds_read_b64_tr_b16 v[230:231], v237 offset:2144
  v_mfma_f32_16x16x32_bf16 a[40:43], a[232:235], a[168:171], a[40:43]
  ds_read_b64_tr_b16 a[250:251], v204 offset:58368
  v_mfma_f32_16x16x32_bf16 a[56:59], a[232:235], a[172:175], a[56:59]
  v_mfma_f32_16x16x32_bf16 a[12:15], a[236:239], a[160:163], a[12:15]
  ds_read_b64_tr_b16 a[252:253], v205 offset:57344
  v_mfma_f32_16x16x32_bf16 a[28:31], a[236:239], a[164:167], a[28:31]
  v_mfma_f32_16x16x32_bf16 a[44:47], a[236:239], a[168:171], a[44:47]
  ds_read_b64_tr_b16 a[254:255], v205 offset:58368
  v_mfma_f32_16x16x32_bf16 a[60:63], a[236:239], a[172:175], a[60:63]
  s_waitcnt lgkmcnt(5)
  v_mfma_f32_16x16x32_bf16 v[0:3], a[240:243], a[176:179], v[0:3]
  ds_read_b64_tr_b16 a[224:225], v206 offset:57344
  s_add_u32 m0, s33, 65536
  s_nop 0
  buffer_load_dwordx4 v180, s[8:11], s37 offen offset:0 lds
  v_mfma_f32_16x16x32_bf16 v[32:35], a[240:243], a[180:183], v[32:35]
  v_mfma_f32_16x16x32_bf16 v[64:67], a[240:243], a[184:187], v[64:67]
  ds_read_b64_tr_b16 a[226:227], v206 offset:58368
  v_mfma_f32_16x16x32_bf16 v[96:99], a[240:243], a[188:191], v[96:99]
  v_mfma_f32_16x16x32_bf16 v[4:7], a[244:247], a[176:179], v[4:7]
  ds_read_b64_tr_b16 a[228:229], v207 offset:57344
  v_mfma_f32_16x16x32_bf16 v[36:39], a[244:247], a[180:183], v[36:39]
  s_add_u32 s47, s95, 0
  buffer_store_dwordx4 v[216:219], v238, s[88:91], s47 offen
  v_mfma_f32_16x16x32_bf16 v[68:71], a[244:247], a[184:187], v[68:71]
  ds_read_b64_tr_b16 a[230:231], v207 offset:58368
  v_mfma_f32_16x16x32_bf16 v[100:103], a[244:247], a[188:191], v[100:103]
  s_waitcnt lgkmcnt(4)
  v_mfma_f32_16x16x32_bf16 v[8:11], a[248:251], a[176:179], v[8:11]
  ds_read_b64_tr_b16 a[232:233], v208 offset:57344
  v_mfma_f32_16x16x32_bf16 v[40:43], a[248:251], a[180:183], v[40:43]
  v_mfma_f32_16x16x32_bf16 v[72:75], a[248:251], a[184:187], v[72:75]
  ds_read_b64_tr_b16 a[234:235], v208 offset:58368
  buffer_load_dwordx4 v181, s[8:11], s37 offen offset:1024 lds
  v_mfma_f32_16x16x32_bf16 v[104:107], a[248:251], a[188:191], v[104:107]
  v_mfma_f32_16x16x32_bf16 v[12:15], a[252:255], a[176:179], v[12:15]
  ds_read_b64_tr_b16 a[236:237], v209 offset:57344
  v_mfma_f32_16x16x32_bf16 v[44:47], a[252:255], a[180:183], v[44:47]
  s_add_u32 s47, s95, 186368
  buffer_store_dwordx4 v[220:223], v238, s[88:91], s47 offen
  v_mfma_f32_16x16x32_bf16 v[76:79], a[252:255], a[184:187], v[76:79]
  ds_read_b64_tr_b16 a[238:239], v209 offset:58368
  v_mfma_f32_16x16x32_bf16 v[108:111], a[252:255], a[188:191], v[108:111]
  s_waitcnt lgkmcnt(4)
  v_mfma_f32_16x16x32_bf16 v[16:19], a[224:227], a[176:179], v[16:19]
  ds_read_b64_tr_b16 a[240:241], v210 offset:45056
  v_mfma_f32_16x16x32_bf16 v[48:51], a[224:227], a[180:183], v[48:51]
  v_mfma_f32_16x16x32_bf16 v[80:83], a[224:227], a[184:187], v[80:83]
  ds_read_b64_tr_b16 a[242:243], v210 offset:45568
  v_mfma_f32_16x16x32_bf16 v[112:115], a[224:227], a[188:191], v[112:115]
  v_mfma_f32_16x16x32_bf16 v[20:23], a[228:231], a[176:179], v[20:23]
  ds_read_b64_tr_b16 a[244:245], v211 offset:45056
  buffer_load_dwordx4 v180, s[8:11], s37 offen offset:2048 lds
  v_mfma_f32_16x16x32_bf16 v[52:55], a[228:231], a[180:183], v[52:55]
  s_add_u32 s47, s95, 372736
  buffer_store_dwordx4 v[224:227], v238, s[88:91], s47 offen
  v_mfma_f32_16x16x32_bf16 v[84:87], a[228:231], a[184:187], v[84:87]
  ds_read_b64_tr_b16 a[246:247], v211 offset:45568
  v_mfma_f32_16x16x32_bf16 v[116:119], a[228:231], a[188:191], v[116:119]
  s_waitcnt lgkmcnt(4)
  v_mfma_f32_16x16x32_bf16 v[24:27], a[232:235], a[176:179], v[24:27]
  ds_read_b64_tr_b16 a[248:249], v212 offset:45056
  v_mfma_f32_16x16x32_bf16 v[56:59], a[232:235], a[180:183], v[56:59]
  v_mfma_f32_16x16x32_bf16 v[88:91], a[232:235], a[184:187], v[88:91]
  ds_read_b64_tr_b16 a[250:251], v212 offset:45568
  v_mfma_f32_16x16x32_bf16 v[120:123], a[232:235], a[188:191], v[120:123]
  v_mfma_f32_16x16x32_bf16 v[28:31], a[236:239], a[176:179], v[28:31]
  ds_read_b64_tr_b16 a[252:253], v213 offset:45056
  v_mfma_f32_16x16x32_bf16 v[60:63], a[236:239], a[180:183], v[60:63]
  s_add_u32 s47, s95, 559104
  buffer_store_dwordx4 v[228:231], v238, s[88:91], s47 offen
  v_mfma_f32_16x16x32_bf16 v[92:95], a[236:239], a[184:187], v[92:95]
  ds_read_b64_tr_b16 a[254:255], v213 offset:45568
  buffer_load_dwordx4 v181, s[8:11], s37 offen offset:3072 lds
  s_add_u32 s37, s37, 16384
  v_mfma_f32_16x16x32_bf16 v[124:127], a[236:239], a[188:191], v[124:127]
  s_barrier
  s_waitcnt lgkmcnt(4)
  v_mfma_f32_16x16x32_bf16 a[0:3], a[240:243], a[176:179], a[0:3]
  ds_read_b64_tr_b16 a[224:225], v202 offset:0
  v_mfma_f32_16x16x32_bf16 a[16:19], a[240:243], a[180:183], a[16:19]
  s_mov_b32 m0, s34
  s_nop 0
  buffer_load_dwordx4 v176, s[4:7], s36 offen offset:0 lds
  v_mfma_f32_16x16x32_bf16 a[32:35], a[240:243], a[184:187], a[32:35]
  ds_read_b64_tr_b16 a[226:227], v202 offset:1024
  v_mfma_f32_16x16x32_bf16 a[48:51], a[240:243], a[188:191], a[48:51]
  v_mfma_f32_16x16x32_bf16 a[4:7], a[244:247], a[176:179], a[4:7]
  ds_read_b64_tr_b16 a[228:229], v203 offset:0
  v_mfma_f32_16x16x32_bf16 a[20:23], a[244:247], a[180:183], a[20:23]
  v_mfma_f32_16x16x32_bf16 a[36:39], a[244:247], a[184:187], a[36:39]
  ds_read_b64_tr_b16 a[230:231], v203 offset:1024
  v_mfma_f32_16x16x32_bf16 a[52:55], a[244:247], a[188:191], a[52:55]
  s_waitcnt lgkmcnt(4)
  v_mfma_f32_16x16x32_bf16 a[8:11], a[248:251], a[176:179], a[8:11]
  ds_read_b64_tr_b16 a[232:233], v204 offset:0
  v_mfma_f32_16x16x32_bf16 a[24:27], a[248:251], a[180:183], a[24:27]
  v_mfma_f32_16x16x32_bf16 a[40:43], a[248:251], a[184:187], a[40:43]
  ds_read_b64_tr_b16 a[234:235], v204 offset:1024
  v_mfma_f32_16x16x32_bf16 a[56:59], a[248:251], a[188:191], a[56:59]
  v_mfma_f32_16x16x32_bf16 a[12:15], a[252:255], a[176:179], a[12:15]
  ds_read_b64_tr_b16 a[236:237], v205 offset:0
  v_mfma_f32_16x16x32_bf16 a[28:31], a[252:255], a[180:183], a[28:31]
  buffer_load_dwordx4 v177, s[4:7], s36 offen offset:1024 lds
  v_mfma_f32_16x16x32_bf16 a[44:47], a[252:255], a[184:187], a[44:47]
  ds_read_b64_tr_b16 a[238:239], v205 offset:1024
  v_mfma_f32_16x16x32_bf16 a[60:63], a[252:255], a[188:191], a[60:63]
  s_waitcnt lgkmcnt(4)
  v_mfma_f32_16x16x32_bf16 v[0:3], a[224:227], a[64:67], v[0:3]
  ds_read_b64_tr_b16 a[240:241], v206 offset:0
  v_mfma_f32_16x16x32_bf16 v[32:35], a[224:227], a[68:71], v[32:35]
  v_mfma_f32_16x16x32_bf16 v[64:67], a[224:227], a[72:75], v[64:67]
  ds_read_b64_tr_b16 a[242:243], v206 offset:1024
  v_mfma_f32_16x16x32_bf16 v[96:99], a[224:227], a[76:79], v[96:99]
  v_mfma_f32_16x16x32_bf16 v[4:7], a[228:231], a[64:67], v[4:7]
  ds_read_b64_tr_b16 a[244:245], v207 offset:0
  v_mfma_f32_16x16x32_bf16 v[36:39], a[228:231], a[68:71], v[36:39]
  v_mfma_f32_16x16x32_bf16 v[68:71], a[228:231], a[72:75], v[68:71]
  ds_read_b64_tr_b16 a[246:247], v207 offset:1024
  v_mfma_f32_16x16x32_bf16 v[100:103], a[228:231], a[76:79], v[100:103]
  s_waitcnt lgkmcnt(4)
  v_mfma_f32_16x16x32_bf16 v[8:11], a[232:235], a[64:67], v[8:11]
  ds_read_b64_tr_b16 a[248:249], v208 offset:0
  v_mfma_f32_16x16x32_bf16 v[40:43], a[232:235], a[68:71], v[40:43]
  buffer_load_dwordx4 v178, s[4:7], s36 offen offset:2048 lds
  v_mfma_f32_16x16x32_bf16 v[72:75], a[232:235], a[72:75], v[72:75]
  ds_read_b64_tr_b16 a[250:251], v208 offset:1024
  v_mfma_f32_16x16x32_bf16 v[104:107], a[232:235], a[76:79], v[104:107]
  v_mfma_f32_16x16x32_bf16 v[12:15], a[236:239], a[64:67], v[12:15]
  ds_read_b64_tr_b16 a[252:253], v209 offset:0
  v_mfma_f32_16x16x32_bf16 v[44:47], a[236:239], a[68:71], v[44:47]
  v_mfma_f32_16x16x32_bf16 v[76:79], a[236:239], a[72:75], v[76:79]
  ds_read_b64_tr_b16 a[254:255], v209 offset:1024
  v_mfma_f32_16x16x32_bf16 v[108:111], a[236:239], a[76:79], v[108:111]
  s_waitcnt lgkmcnt(4)
  v_mfma_f32_16x16x32_bf16 v[16:19], a[240:243], a[64:67], v[16:19]
  ds_read_b64_tr_b16 a[224:225], v210 offset:16384
  v_mfma_f32_16x16x32_bf16 v[48:51], a[240:243], a[68:71], v[48:51]
  v_mfma_f32_16x16x32_bf16 v[80:83], a[240:243], a[72:75], v[80:83]
  ds_read_b64_tr_b16 a[226:227], v210 offset:16896
  v_mfma_f32_16x16x32_bf16 v[112:115], a[240:243], a[76:79], v[112:115]
  v_mfma_f32_16x16x32_bf16 v[20:23], a[244:247], a[64:67], v[20:23]
  ds_read_b64_tr_b16 a[228:229], v211 offset:16384
  v_mfma_f32_16x16x32_bf16 v[52:55], a[244:247], a[68:71], v[52:55]
  buffer_load_dwordx4 v179, s[4:7], s36 offen offset:3072 lds
  s_add_u32 s36, s36, 16384
  v_mfma_f32_16x16x32_bf16 v[84:87], a[244:247], a[72:75], v[84:87]
  ds_read_b64_tr_b16 a[230:231], v211 offset:16896
  v_mfma_f32_16x16x32_bf16 v[116:119], a[244:247], a[76:79], v[116:119]
  s_waitcnt lgkmcnt(4)
  v_mfma_f32_16x16x32_bf16 v[24:27], a[248:251], a[64:67], v[24:27]
  ds_read_b64_tr_b16 a[232:233], v212 offset:16384
  v_mfma_f32_16x16x32_bf16 v[56:59], a[248:251], a[68:71], v[56:59]
  v_mfma_f32_16x16x32_bf16 v[88:91], a[248:251], a[72:75], v[88:91]
  ds_read_b64_tr_b16 a[234:235], v212 offset:16896
  v_mfma_f32_16x16x32_bf16 v[120:123], a[248:251], a[76:79], v[120:123]
  v_mfma_f32_16x16x32_bf16 v[28:31], a[252:255], a[64:67], v[28:31]
  ds_read_b64_tr_b16 a[236:237], v213 offset:16384
  v_mfma_f32_16x16x32_bf16 v[60:63], a[252:255], a[68:71], v[60:63]
  v_mfma_f32_16x16x32_bf16 v[92:95], a[252:255], a[72:75], v[92:95]
  ds_read_b64_tr_b16 a[238:239], v213 offset:16896
  v_mfma_f32_16x16x32_bf16 v[124:127], a[252:255], a[76:79], v[124:127]
  s_waitcnt lgkmcnt(4)
  v_mfma_f32_16x16x32_bf16 a[0:3], a[224:227], a[64:67], a[0:3]
  ds_read_b64_tr_b16 a[240:241], v202 offset:8192
  v_mfma_f32_16x16x32_bf16 a[16:19], a[224:227], a[68:71], a[16:19]
  v_mfma_f32_16x16x32_bf16 a[32:35], a[224:227], a[72:75], a[32:35]
  ds_read_b64_tr_b16 a[242:243], v202 offset:9216
  v_mfma_f32_16x16x32_bf16 a[48:51], a[224:227], a[76:79], a[48:51]
  v_mfma_f32_16x16x32_bf16 a[4:7], a[228:231], a[64:67], a[4:7]
  ds_read_b64_tr_b16 a[244:245], v203 offset:8192
  v_mfma_f32_16x16x32_bf16 a[20:23], a[228:231], a[68:71], a[20:23]
  v_mfma_f32_16x16x32_bf16 a[36:39], a[228:231], a[72:75], a[36:39]
  ds_read_b64_tr_b16 a[246:247], v203 offset:9216
  v_mfma_f32_16x16x32_bf16 a[52:55], a[228:231], a[76:79], a[52:55]
  s_waitcnt lgkmcnt(4)
  v_mfma_f32_16x16x32_bf16 a[8:11], a[232:235], a[64:67], a[8:11]
  ds_read_b64_tr_b16 a[248:249], v204 offset:8192
  v_mfma_f32_16x16x32_bf16 a[24:27], a[232:235], a[68:71], a[24:27]
  v_mfma_f32_16x16x32_bf16 a[40:43], a[232:235], a[72:75], a[40:43]
  ds_read_b64_tr_b16 a[250:251], v204 offset:9216
  v_mfma_f32_16x16x32_bf16 a[56:59], a[232:235], a[76:79], a[56:59]
  v_mfma_f32_16x16x32_bf16 a[12:15], a[236:239], a[64:67], a[12:15]
  ds_read_b64_tr_b16 a[252:253], v205 offset:8192
  v_mfma_f32_16x16x32_bf16 a[28:31], a[236:239], a[68:71], a[28:31]
  v_mfma_f32_16x16x32_bf16 a[44:47], a[236:239], a[72:75], a[44:47]
  ds_read_b64_tr_b16 a[254:255], v205 offset:9216
  v_mfma_f32_16x16x32_bf16 a[60:63], a[236:239], a[76:79], a[60:63]
  s_waitcnt lgkmcnt(4)
  v_mfma_f32_16x16x32_bf16 v[0:3], a[240:243], a[80:83], v[0:3]
  ds_read_b64_tr_b16 a[224:225], v206 offset:8192
  v_mfma_f32_16x16x32_bf16 v[32:35], a[240:243], a[84:87], v[32:35]
  v_mfma_f32_16x16x32_bf16 v[64:67], a[240:243], a[88:91], v[64:67]
  ds_read_b64_tr_b16 a[226:227], v206 offset:9216
  v_mfma_f32_16x16x32_bf16 v[96:99], a[240:243], a[92:95], v[96:99]
  v_mfma_f32_16x16x32_bf16 v[4:7], a[244:247], a[80:83], v[4:7]
  ds_read_b64_tr_b16 a[228:229], v207 offset:8192
  v_mfma_f32_16x16x32_bf16 v[36:39], a[244:247], a[84:87], v[36:39]
  v_mfma_f32_16x16x32_bf16 v[68:71], a[244:247], a[88:91], v[68:71]
  ds_read_b64_tr_b16 a[230:231], v207 offset:9216
  v_mfma_f32_16x16x32_bf16 v[100:103], a[244:247], a[92:95], v[100:103]
  s_waitcnt lgkmcnt(4)
  v_mfma_f32_16x16x32_bf16 v[8:11], a[248:251], a[80:83], v[8:11]
  ds_read_b64_tr_b16 a[232:233], v208 offset:8192
  v_mfma_f32_16x16x32_bf16 v[40:43], a[248:251], a[84:87], v[40:43]
  v_mfma_f32_16x16x32_bf16 v[72:75], a[248:251], a[88:91], v[72:75]
  ds_read_b64_tr_b16 a[234:235], v208 offset:9216
  v_mfma_f32_16x16x32_bf16 v[104:107], a[248:251], a[92:95], v[104:107]
  v_mfma_f32_16x16x32_bf16 v[12:15], a[252:255], a[80:83], v[12:15]
  ds_read_b64_tr_b16 a[236:237], v209 offset:8192
  v_mfma_f32_16x16x32_bf16 v[44:47], a[252:255], a[84:87], v[44:47]
  v_mfma_f32_16x16x32_bf16 v[76:79], a[252:255], a[88:91], v[76:79]
  ds_read_b64_tr_b16 a[238:239], v209 offset:9216
  v_mfma_f32_16x16x32_bf16 v[108:111], a[252:255], a[92:95], v[108:111]
  s_waitcnt lgkmcnt(4)
  v_mfma_f32_16x16x32_bf16 v[16:19], a[224:227], a[80:83], v[16:19]
  ds_read_b64_tr_b16 a[240:241], v210 offset:20480
  v_mfma_f32_16x16x32_bf16 v[48:51], a[224:227], a[84:87], v[48:51]
  v_mfma_f32_16x16x32_bf16 v[80:83], a[224:227], a[88:91], v[80:83]
  ds_read_b64_tr_b16 a[242:243], v210 offset:20992
  v_mfma_f32_16x16x32_bf16 v[112:115], a[224:227], a[92:95], v[112:115]
  v_mfma_f32_16x16x32_bf16 v[20:23], a[228:231], a[80:83], v[20:23]
  ds_read_b64_tr_b16 a[244:245], v211 offset:20480
  v_mfma_f32_16x16x32_bf16 v[52:55], a[228:231], a[84:87], v[52:55]
  v_mfma_f32_16x16x32_bf16 v[84:87], a[228:231], a[88:91], v[84:87]
  ds_read_b64_tr_b16 a[246:247], v211 offset:20992
  v_mfma_f32_16x16x32_bf16 v[116:119], a[228:231], a[92:95], v[116:119]
  s_waitcnt lgkmcnt(4)
  v_mfma_f32_16x16x32_bf16 v[24:27], a[232:235], a[80:83], v[24:27]
  ds_read_b64_tr_b16 a[248:249], v212 offset:20480
  v_mfma_f32_16x16x32_bf16 v[56:59], a[232:235], a[84:87], v[56:59]
  v_mfma_f32_16x16x32_bf16 v[88:91], a[232:235], a[88:91], v[88:91]
  ds_read_b64_tr_b16 a[250:251], v212 offset:20992
  v_mfma_f32_16x16x32_bf16 v[120:123], a[232:235], a[92:95], v[120:123]
  v_mfma_f32_16x16x32_bf16 v[28:31], a[236:239], a[80:83], v[28:31]
  ds_read_b64_tr_b16 a[252:253], v213 offset:20480
  v_mfma_f32_16x16x32_bf16 v[60:63], a[236:239], a[84:87], v[60:63]
  v_mfma_f32_16x16x32_bf16 v[92:95], a[236:239], a[88:91], v[92:95]
  ds_read_b64_tr_b16 a[254:255], v213 offset:20992
  v_mfma_f32_16x16x32_bf16 v[124:127], a[236:239], a[92:95], v[124:127]
  s_barrier
  s_waitcnt lgkmcnt(4)
  v_mfma_f32_16x16x32_bf16 a[0:3], a[240:243], a[80:83], a[0:3]
  ds_read_b64_tr_b16 a[224:225], v202 offset:16384
  v_mfma_f32_16x16x32_bf16 a[16:19], a[240:243], a[84:87], a[16:19]
  s_mov_b32 m0, s35
  s_nop 0
  buffer_load_dwordx4 v176, s[4:7], s36 offen offset:0 lds
  v_mfma_f32_16x16x32_bf16 a[32:35], a[240:243], a[88:91], a[32:35]
  ds_read_b64_tr_b16 a[226:227], v202 offset:17408
  v_mfma_f32_16x16x32_bf16 a[48:51], a[240:243], a[92:95], a[48:51]
  v_mfma_f32_16x16x32_bf16 a[4:7], a[244:247], a[80:83], a[4:7]
  ds_read_b64_tr_b16 a[228:229], v203 offset:16384
  v_mfma_f32_16x16x32_bf16 a[20:23], a[244:247], a[84:87], a[20:23]
  v_mfma_f32_16x16x32_bf16 a[36:39], a[244:247], a[88:91], a[36:39]
  ds_read_b64_tr_b16 a[230:231], v203 offset:17408
  v_mfma_f32_16x16x32_bf16 a[52:55], a[244:247], a[92:95], a[52:55]
  s_waitcnt lgkmcnt(4)
  v_mfma_f32_16x16x32_bf16 a[8:11], a[248:251], a[80:83], a[8:11]
  ds_read_b64_tr_b16 a[232:233], v204 offset:16384
  v_mfma_f32_16x16x32_bf16 a[24:27], a[248:251], a[84:87], a[24:27]
  v_mfma_f32_16x16x32_bf16 a[40:43], a[248:251], a[88:91], a[40:43]
  ds_read_b64_tr_b16 a[234:235], v204 offset:17408
  v_mfma_f32_16x16x32_bf16 a[56:59], a[248:251], a[92:95], a[56:59]
  v_mfma_f32_16x16x32_bf16 a[12:15], a[252:255], a[80:83], a[12:15]
  ds_read_b64_tr_b16 a[236:237], v205 offset:16384
  v_mfma_f32_16x16x32_bf16 a[28:31], a[252:255], a[84:87], a[28:31]
  buffer_load_dwordx4 v177, s[4:7], s36 offen offset:1024 lds
  v_mfma_f32_16x16x32_bf16 a[44:47], a[252:255], a[88:91], a[44:47]
  ds_read_b64_tr_b16 a[238:239], v205 offset:17408
  v_mfma_f32_16x16x32_bf16 a[60:63], a[252:255], a[92:95], a[60:63]
  s_waitcnt lgkmcnt(4)
  v_mfma_f32_16x16x32_bf16 v[0:3], a[224:227], a[96:99], v[0:3]
  ds_read_b64_tr_b16 a[240:241], v206 offset:16384
  v_mfma_f32_16x16x32_bf16 v[32:35], a[224:227], a[100:103], v[32:35]
  v_mfma_f32_16x16x32_bf16 v[64:67], a[224:227], a[104:107], v[64:67]
  ds_read_b64_tr_b16 a[242:243], v206 offset:17408
  v_mfma_f32_16x16x32_bf16 v[96:99], a[224:227], a[108:111], v[96:99]
  v_mfma_f32_16x16x32_bf16 v[4:7], a[228:231], a[96:99], v[4:7]
  ds_read_b64_tr_b16 a[244:245], v207 offset:16384
  v_mfma_f32_16x16x32_bf16 v[36:39], a[228:231], a[100:103], v[36:39]
  v_mfma_f32_16x16x32_bf16 v[68:71], a[228:231], a[104:107], v[68:71]
  ds_read_b64_tr_b16 a[246:247], v207 offset:17408
  v_mfma_f32_16x16x32_bf16 v[100:103], a[228:231], a[108:111], v[100:103]
  s_waitcnt lgkmcnt(4)
  v_mfma_f32_16x16x32_bf16 v[8:11], a[232:235], a[96:99], v[8:11]
  ds_read_b64_tr_b16 a[248:249], v208 offset:16384
  v_mfma_f32_16x16x32_bf16 v[40:43], a[232:235], a[100:103], v[40:43]
  buffer_load_dwordx4 v178, s[4:7], s36 offen offset:2048 lds
  v_mfma_f32_16x16x32_bf16 v[72:75], a[232:235], a[104:107], v[72:75]
  ds_read_b64_tr_b16 a[250:251], v208 offset:17408
  v_mfma_f32_16x16x32_bf16 v[104:107], a[232:235], a[108:111], v[104:107]
  v_mfma_f32_16x16x32_bf16 v[12:15], a[236:239], a[96:99], v[12:15]
  ds_read_b64_tr_b16 a[252:253], v209 offset:16384
  v_mfma_f32_16x16x32_bf16 v[44:47], a[236:239], a[100:103], v[44:47]
  v_mfma_f32_16x16x32_bf16 v[76:79], a[236:239], a[104:107], v[76:79]
  ds_read_b64_tr_b16 a[254:255], v209 offset:17408
  v_mfma_f32_16x16x32_bf16 v[108:111], a[236:239], a[108:111], v[108:111]
  s_waitcnt lgkmcnt(4)
  v_mfma_f32_16x16x32_bf16 v[16:19], a[240:243], a[96:99], v[16:19]
  ds_read_b64_tr_b16 a[224:225], v210 offset:24576
  v_mfma_f32_16x16x32_bf16 v[48:51], a[240:243], a[100:103], v[48:51]
  v_mfma_f32_16x16x32_bf16 v[80:83], a[240:243], a[104:107], v[80:83]
  ds_read_b64_tr_b16 a[226:227], v210 offset:25088
  v_mfma_f32_16x16x32_bf16 v[112:115], a[240:243], a[108:111], v[112:115]
  v_mfma_f32_16x16x32_bf16 v[20:23], a[244:247], a[96:99], v[20:23]
  ds_read_b64_tr_b16 a[228:229], v211 offset:24576
  v_mfma_f32_16x16x32_bf16 v[52:55], a[244:247], a[100:103], v[52:55]
  buffer_load_dwordx4 v179, s[4:7], s36 offen offset:3072 lds
  s_add_u32 s36, s36, 16384
  v_mfma_f32_16x16x32_bf16 v[84:87], a[244:247], a[104:107], v[84:87]
  ds_read_b64_tr_b16 a[230:231], v211 offset:25088
  v_mfma_f32_16x16x32_bf16 v[116:119], a[244:247], a[108:111], v[116:119]
  s_waitcnt lgkmcnt(4)
  v_mfma_f32_16x16x32_bf16 v[24:27], a[248:251], a[96:99], v[24:27]
  ds_read_b64_tr_b16 a[232:233], v212 offset:24576
  v_mfma_f32_16x16x32_bf16 v[56:59], a[248:251], a[100:103], v[56:59]
  v_mfma_f32_16x16x32_bf16 v[88:91], a[248:251], a[104:107], v[88:91]
  ds_read_b64_tr_b16 a[234:235], v212 offset:25088
  v_mfma_f32_16x16x32_bf16 v[120:123], a[248:251], a[108:111], v[120:123]
  v_mfma_f32_16x16x32_bf16 v[28:31], a[252:255], a[96:99], v[28:31]
  ds_read_b64_tr_b16 a[236:237], v213 offset:24576
  v_mfma_f32_16x16x32_bf16 v[60:63], a[252:255], a[100:103], v[60:63]
  v_mfma_f32_16x16x32_bf16 v[92:95], a[252:255], a[104:107], v[92:95]
  ds_read_b64_tr_b16 a[238:239], v213 offset:25088
  v_mfma_f32_16x16x32_bf16 v[124:127], a[252:255], a[108:111], v[124:127]
  s_waitcnt lgkmcnt(4)
  v_mfma_f32_16x16x32_bf16 a[0:3], a[224:227], a[96:99], a[0:3]
  ds_read_b64_tr_b16 a[240:241], v202 offset:24576
  v_mfma_f32_16x16x32_bf16 a[16:19], a[224:227], a[100:103], a[16:19]
  v_mfma_f32_16x16x32_bf16 a[32:35], a[224:227], a[104:107], a[32:35]
  ds_read_b64_tr_b16 a[242:243], v202 offset:25600
  v_mfma_f32_16x16x32_bf16 a[48:51], a[224:227], a[108:111], a[48:51]
  v_mfma_f32_16x16x32_bf16 a[4:7], a[228:231], a[96:99], a[4:7]
  ds_read_b64_tr_b16 a[244:245], v203 offset:24576
  v_mfma_f32_16x16x32_bf16 a[20:23], a[228:231], a[100:103], a[20:23]
  v_mfma_f32_16x16x32_bf16 a[36:39], a[228:231], a[104:107], a[36:39]
  ds_read_b64_tr_b16 a[246:247], v203 offset:25600
  v_mfma_f32_16x16x32_bf16 a[52:55], a[228:231], a[108:111], a[52:55]
  s_waitcnt lgkmcnt(4)
  v_mfma_f32_16x16x32_bf16 a[8:11], a[232:235], a[96:99], a[8:11]
  ds_read_b64_tr_b16 a[248:249], v204 offset:24576
  v_mfma_f32_16x16x32_bf16 a[24:27], a[232:235], a[100:103], a[24:27]
  v_mfma_f32_16x16x32_bf16 a[40:43], a[232:235], a[104:107], a[40:43]
  ds_read_b64_tr_b16 a[250:251], v204 offset:25600
  v_mfma_f32_16x16x32_bf16 a[56:59], a[232:235], a[108:111], a[56:59]
  v_mfma_f32_16x16x32_bf16 a[12:15], a[236:239], a[96:99], a[12:15]
  ds_read_b64_tr_b16 a[252:253], v205 offset:24576
  v_mfma_f32_16x16x32_bf16 a[28:31], a[236:239], a[100:103], a[28:31]
  v_mfma_f32_16x16x32_bf16 a[44:47], a[236:239], a[104:107], a[44:47]
  ds_read_b64_tr_b16 a[254:255], v205 offset:25600
  v_mfma_f32_16x16x32_bf16 a[60:63], a[236:239], a[108:111], a[60:63]
  s_waitcnt vmcnt(20) lgkmcnt(4)
  v_mfma_f32_16x16x32_bf16 v[0:3], a[240:243], a[112:115], v[0:3]
  ds_read_b64_tr_b16 a[224:225], v206 offset:24576
  v_mfma_f32_16x16x32_bf16 v[32:35], a[240:243], a[116:119], v[32:35]
  v_mfma_f32_16x16x32_bf16 v[64:67], a[240:243], a[120:123], v[64:67]
  ds_read_b64_tr_b16 a[226:227], v206 offset:25600
  v_mfma_f32_16x16x32_bf16 v[96:99], a[240:243], a[124:127], v[96:99]
  v_mfma_f32_16x16x32_bf16 v[4:7], a[244:247], a[112:115], v[4:7]
  ds_read_b64_tr_b16 a[228:229], v207 offset:24576
  v_mfma_f32_16x16x32_bf16 v[36:39], a[244:247], a[116:119], v[36:39]
  v_mfma_f32_16x16x32_bf16 v[68:71], a[244:247], a[120:123], v[68:71]
  ds_read_b64_tr_b16 a[230:231], v207 offset:25600
  v_mfma_f32_16x16x32_bf16 v[100:103], a[244:247], a[124:127], v[100:103]
  s_waitcnt lgkmcnt(4)
  v_mfma_f32_16x16x32_bf16 v[8:11], a[248:251], a[112:115], v[8:11]
  ds_read_b64_tr_b16 a[232:233], v208 offset:24576
  v_mfma_f32_16x16x32_bf16 v[40:43], a[248:251], a[116:119], v[40:43]
  v_mfma_f32_16x16x32_bf16 v[72:75], a[248:251], a[120:123], v[72:75]
  ds_read_b64_tr_b16 a[234:235], v208 offset:25600
  v_mfma_f32_16x16x32_bf16 v[104:107], a[248:251], a[124:127], v[104:107]
  v_mfma_f32_16x16x32_bf16 v[12:15], a[252:255], a[112:115], v[12:15]
  ds_read_b64_tr_b16 a[236:237], v209 offset:24576
  v_mfma_f32_16x16x32_bf16 v[44:47], a[252:255], a[116:119], v[44:47]
  v_mfma_f32_16x16x32_bf16 v[76:79], a[252:255], a[120:123], v[76:79]
  ds_read_b64_tr_b16 a[238:239], v209 offset:25600
  v_mfma_f32_16x16x32_bf16 v[108:111], a[252:255], a[124:127], v[108:111]
  s_waitcnt lgkmcnt(4)
  v_mfma_f32_16x16x32_bf16 v[16:19], a[224:227], a[112:115], v[16:19]
  ds_read_b64_tr_b16 a[240:241], v210 offset:28672
  v_mfma_f32_16x16x32_bf16 v[48:51], a[224:227], a[116:119], v[48:51]
  v_mfma_f32_16x16x32_bf16 v[80:83], a[224:227], a[120:123], v[80:83]
  ds_read_b64_tr_b16 a[242:243], v210 offset:29184
  v_mfma_f32_16x16x32_bf16 v[112:115], a[224:227], a[124:127], v[112:115]
  v_mfma_f32_16x16x32_bf16 v[20:23], a[228:231], a[112:115], v[20:23]
  ds_read_b64_tr_b16 a[244:245], v211 offset:28672
  v_mfma_f32_16x16x32_bf16 v[52:55], a[228:231], a[116:119], v[52:55]
  v_mfma_f32_16x16x32_bf16 v[84:87], a[228:231], a[120:123], v[84:87]
  ds_read_b64_tr_b16 a[246:247], v211 offset:29184
  v_mfma_f32_16x16x32_bf16 v[116:119], a[228:231], a[124:127], v[116:119]
  s_waitcnt lgkmcnt(4)
  v_mfma_f32_16x16x32_bf16 v[24:27], a[232:235], a[112:115], v[24:27]
  ds_read_b64_tr_b16 a[248:249], v212 offset:28672
  v_mfma_f32_16x16x32_bf16 v[56:59], a[232:235], a[116:119], v[56:59]
  v_mfma_f32_16x16x32_bf16 v[88:91], a[232:235], a[120:123], v[88:91]
  ds_read_b64_tr_b16 a[250:251], v212 offset:29184
  v_mfma_f32_16x16x32_bf16 v[120:123], a[232:235], a[124:127], v[120:123]
  v_mfma_f32_16x16x32_bf16 v[28:31], a[236:239], a[112:115], v[28:31]
  ds_read_b64_tr_b16 a[252:253], v213 offset:28672
  v_mfma_f32_16x16x32_bf16 v[60:63], a[236:239], a[116:119], v[60:63]
  v_mfma_f32_16x16x32_bf16 v[92:95], a[236:239], a[120:123], v[92:95]
  ds_read_b64_tr_b16 a[254:255], v213 offset:29184
  v_mfma_f32_16x16x32_bf16 v[124:127], a[236:239], a[124:127], v[124:127]
  s_waitcnt lgkmcnt(4)
  v_mfma_f32_16x16x32_bf16 a[0:3], a[240:243], a[112:115], a[0:3]
  v_mfma_f32_16x16x32_bf16 a[16:19], a[240:243], a[116:119], a[16:19]
  v_mfma_f32_16x16x32_bf16 a[32:35], a[240:243], a[120:123], a[32:35]
  v_mfma_f32_16x16x32_bf16 a[48:51], a[240:243], a[124:127], a[48:51]
  v_mfma_f32_16x16x32_bf16 a[4:7], a[244:247], a[112:115], a[4:7]
  v_mfma_f32_16x16x32_bf16 a[20:23], a[244:247], a[116:119], a[20:23]
  v_mfma_f32_16x16x32_bf16 a[36:39], a[244:247], a[120:123], a[36:39]
  v_mfma_f32_16x16x32_bf16 a[52:55], a[244:247], a[124:127], a[52:55]
  s_waitcnt lgkmcnt(0)
  v_mfma_f32_16x16x32_bf16 a[8:11], a[248:251], a[112:115], a[8:11]
  v_mfma_f32_16x16x32_bf16 a[24:27], a[248:251], a[116:119], a[24:27]
  v_mfma_f32_16x16x32_bf16 a[40:43], a[248:251], a[120:123], a[40:43]
  v_mfma_f32_16x16x32_bf16 a[56:59], a[248:251], a[124:127], a[56:59]
  v_mfma_f32_16x16x32_bf16 a[12:15], a[252:255], a[112:115], a[12:15]
  v_mfma_f32_16x16x32_bf16 a[28:31], a[252:255], a[116:119], a[28:31]
  v_mfma_f32_16x16x32_bf16 a[44:47], a[252:255], a[120:123], a[44:47]
  v_mfma_f32_16x16x32_bf16 a[60:63], a[252:255], a[124:127], a[60:63]
  s_nop 7
  s_nop 3
  s_mov_b32 s42, 0x3e0293ee
  s_mov_b32 s43, 0x3e0293ee
  v_pk_mul_f32 v[0:1], v[0:1], s[42:43]
  v_pk_mul_f32 v[2:3], v[2:3], s[42:43]
  v_pk_mul_f32 v[4:5], v[4:5], s[42:43]
  v_pk_mul_f32 v[6:7], v[6:7], s[42:43]
  v_cvt_pk_bf16_f32 v182, v0, v1
  v_cvt_pk_bf16_f32 v183, v2, v3
  v_cvt_pk_bf16_f32 v184, v4, v5
  v_cvt_pk_bf16_f32 v185, v6, v7
  v_accvgpr_write_b32 a128, v182
  v_accvgpr_write_b32 a129, v183
  v_accvgpr_write_b32 a130, v184
  v_accvgpr_write_b32 a131, v185
  v_pk_mul_f32 v[8:9], v[8:9], s[42:43]
  v_pk_mul_f32 v[10:11], v[10:11], s[42:43]
  v_pk_mul_f32 v[12:13], v[12:13], s[42:43]
  v_pk_mul_f32 v[14:15], v[14:15], s[42:43]
  v_cvt_pk_bf16_f32 v186, v8, v9
  v_cvt_pk_bf16_f32 v187, v10, v11
  v_cvt_pk_bf16_f32 v188, v12, v13
  v_cvt_pk_bf16_f32 v189, v14, v15
  v_accvgpr_write_b32 a132, v186
  v_accvgpr_write_b32 a133, v187
  v_accvgpr_write_b32 a134, v188
  v_accvgpr_write_b32 a135, v189
  v_pk_mul_f32 v[16:17], v[16:17], s[42:43]
  v_pk_mul_f32 v[18:19], v[18:19], s[42:43]
  v_pk_mul_f32 v[20:21], v[20:21], s[42:43]
  v_pk_mul_f32 v[22:23], v[22:23], s[42:43]
  v_cvt_pk_bf16_f32 v182, v16, v17
  v_cvt_pk_bf16_f32 v183, v18, v19
  v_cvt_pk_bf16_f32 v184, v20, v21
  v_cvt_pk_bf16_f32 v185, v22, v23
  v_accvgpr_write_b32 a136, v182
  v_accvgpr_write_b32 a137, v183
  v_accvgpr_write_b32 a138, v184
  v_accvgpr_write_b32 a139, v185
  v_pk_mul_f32 v[24:25], v[24:25], s[42:43]
  v_pk_mul_f32 v[26:27], v[26:27], s[42:43]
  v_pk_mul_f32 v[28:29], v[28:29], s[42:43]
  v_pk_mul_f32 v[30:31], v[30:31], s[42:43]
  v_cvt_pk_bf16_f32 v186, v24, v25
  v_cvt_pk_bf16_f32 v187, v26, v27
  v_cvt_pk_bf16_f32 v188, v28, v29
  v_cvt_pk_bf16_f32 v189, v30, v31
  v_accvgpr_write_b32 a140, v186
  v_accvgpr_write_b32 a141, v187
  v_accvgpr_write_b32 a142, v188
  v_accvgpr_write_b32 a143, v189
  v_pk_mul_f32 v[32:33], v[32:33], s[42:43]
  v_pk_mul_f32 v[34:35], v[34:35], s[42:43]
  v_pk_mul_f32 v[36:37], v[36:37], s[42:43]
  v_pk_mul_f32 v[38:39], v[38:39], s[42:43]
  v_cvt_pk_bf16_f32 v182, v32, v33
  v_cvt_pk_bf16_f32 v183, v34, v35
  v_cvt_pk_bf16_f32 v184, v36, v37
  v_cvt_pk_bf16_f32 v185, v38, v39
  v_accvgpr_write_b32 a144, v182
  v_accvgpr_write_b32 a145, v183
  v_accvgpr_write_b32 a146, v184
  v_accvgpr_write_b32 a147, v185
  v_pk_mul_f32 v[40:41], v[40:41], s[42:43]
  v_pk_mul_f32 v[42:43], v[42:43], s[42:43]
  v_pk_mul_f32 v[44:45], v[44:45], s[42:43]
  v_pk_mul_f32 v[46:47], v[46:47], s[42:43]
  v_cvt_pk_bf16_f32 v186, v40, v41
  v_cvt_pk_bf16_f32 v187, v42, v43
  v_cvt_pk_bf16_f32 v188, v44, v45
  v_cvt_pk_bf16_f32 v189, v46, v47
  v_accvgpr_write_b32 a148, v186
  v_accvgpr_write_b32 a149, v187
  v_accvgpr_write_b32 a150, v188
  v_accvgpr_write_b32 a151, v189
  v_pk_mul_f32 v[48:49], v[48:49], s[42:43]
  v_pk_mul_f32 v[50:51], v[50:51], s[42:43]
  v_pk_mul_f32 v[52:53], v[52:53], s[42:43]
  v_pk_mul_f32 v[54:55], v[54:55], s[42:43]
  v_cvt_pk_bf16_f32 v182, v48, v49
  v_cvt_pk_bf16_f32 v183, v50, v51
  v_cvt_pk_bf16_f32 v184, v52, v53
  v_cvt_pk_bf16_f32 v185, v54, v55
  v_accvgpr_write_b32 a152, v182
  v_accvgpr_write_b32 a153, v183
  v_accvgpr_write_b32 a154, v184
  v_accvgpr_write_b32 a155, v185
  v_pk_mul_f32 v[56:57], v[56:57], s[42:43]
  v_pk_mul_f32 v[58:59], v[58:59], s[42:43]
  v_pk_mul_f32 v[60:61], v[60:61], s[42:43]
  v_pk_mul_f32 v[62:63], v[62:63], s[42:43]
  v_cvt_pk_bf16_f32 v186, v56, v57
  v_cvt_pk_bf16_f32 v187, v58, v59
  v_cvt_pk_bf16_f32 v188, v60, v61
  v_cvt_pk_bf16_f32 v189, v62, v63
  v_accvgpr_write_b32 a156, v186
  v_accvgpr_write_b32 a157, v187
  v_accvgpr_write_b32 a158, v188
  v_accvgpr_write_b32 a159, v189
  v_pk_mul_f32 v[64:65], v[64:65], s[42:43]
  v_pk_mul_f32 v[66:67], v[66:67], s[42:43]
  v_pk_mul_f32 v[68:69], v[68:69], s[42:43]
  v_pk_mul_f32 v[70:71], v[70:71], s[42:43]
  v_cvt_pk_bf16_f32 v182, v64, v65
  v_cvt_pk_bf16_f32 v183, v66, v67
  v_cvt_pk_bf16_f32 v184, v68, v69
  v_cvt_pk_bf16_f32 v185, v70, v71
  v_accvgpr_write_b32 a160, v182
  v_accvgpr_write_b32 a161, v183
  v_accvgpr_write_b32 a162, v184
  v_accvgpr_write_b32 a163, v185
  v_pk_mul_f32 v[72:73], v[72:73], s[42:43]
  v_pk_mul_f32 v[74:75], v[74:75], s[42:43]
  v_pk_mul_f32 v[76:77], v[76:77], s[42:43]
  v_pk_mul_f32 v[78:79], v[78:79], s[42:43]
  v_cvt_pk_bf16_f32 v186, v72, v73
  v_cvt_pk_bf16_f32 v187, v74, v75
  v_cvt_pk_bf16_f32 v188, v76, v77
  v_cvt_pk_bf16_f32 v189, v78, v79
  v_accvgpr_write_b32 a164, v186
  v_accvgpr_write_b32 a165, v187
  v_accvgpr_write_b32 a166, v188
  v_accvgpr_write_b32 a167, v189
  v_pk_mul_f32 v[80:81], v[80:81], s[42:43]
  v_pk_mul_f32 v[82:83], v[82:83], s[42:43]
  v_pk_mul_f32 v[84:85], v[84:85], s[42:43]
  v_pk_mul_f32 v[86:87], v[86:87], s[42:43]
  v_cvt_pk_bf16_f32 v182, v80, v81
  v_cvt_pk_bf16_f32 v183, v82, v83
  v_cvt_pk_bf16_f32 v184, v84, v85
  v_cvt_pk_bf16_f32 v185, v86, v87
  v_accvgpr_write_b32 a168, v182
  v_accvgpr_write_b32 a169, v183
  v_accvgpr_write_b32 a170, v184
  v_accvgpr_write_b32 a171, v185
  v_pk_mul_f32 v[88:89], v[88:89], s[42:43]
  v_pk_mul_f32 v[90:91], v[90:91], s[42:43]
  v_pk_mul_f32 v[92:93], v[92:93], s[42:43]
  v_pk_mul_f32 v[94:95], v[94:95], s[42:43]
  v_cvt_pk_bf16_f32 v186, v88, v89
  v_cvt_pk_bf16_f32 v187, v90, v91
  v_cvt_pk_bf16_f32 v188, v92, v93
  v_cvt_pk_bf16_f32 v189, v94, v95
  v_accvgpr_write_b32 a172, v186
  v_accvgpr_write_b32 a173, v187
  v_accvgpr_write_b32 a174, v188
  v_accvgpr_write_b32 a175, v189
  v_pk_mul_f32 v[96:97], v[96:97], s[42:43]
  v_pk_mul_f32 v[98:99], v[98:99], s[42:43]
  v_pk_mul_f32 v[100:101], v[100:101], s[42:43]
  v_pk_mul_f32 v[102:103], v[102:103], s[42:43]
  v_cvt_pk_bf16_f32 v182, v96, v97
  v_cvt_pk_bf16_f32 v183, v98, v99
  v_cvt_pk_bf16_f32 v184, v100, v101
  v_cvt_pk_bf16_f32 v185, v102, v103
  v_accvgpr_write_b32 a176, v182
  v_accvgpr_write_b32 a177, v183
  v_accvgpr_write_b32 a178, v184
  v_accvgpr_write_b32 a179, v185
  v_pk_mul_f32 v[104:105], v[104:105], s[42:43]
  v_pk_mul_f32 v[106:107], v[106:107], s[42:43]
  v_pk_mul_f32 v[108:109], v[108:109], s[42:43]
  v_pk_mul_f32 v[110:111], v[110:111], s[42:43]
  v_cvt_pk_bf16_f32 v186, v104, v105
  v_cvt_pk_bf16_f32 v187, v106, v107
  v_cvt_pk_bf16_f32 v188, v108, v109
  v_cvt_pk_bf16_f32 v189, v110, v111
  v_accvgpr_write_b32 a180, v186
  v_accvgpr_write_b32 a181, v187
  v_accvgpr_write_b32 a182, v188
  v_accvgpr_write_b32 a183, v189
  v_pk_mul_f32 v[112:113], v[112:113], s[42:43]
  v_pk_mul_f32 v[114:115], v[114:115], s[42:43]
  v_pk_mul_f32 v[116:117], v[116:117], s[42:43]
  v_pk_mul_f32 v[118:119], v[118:119], s[42:43]
  v_cvt_pk_bf16_f32 v182, v112, v113
  v_cvt_pk_bf16_f32 v183, v114, v115
  v_cvt_pk_bf16_f32 v184, v116, v117
  v_cvt_pk_bf16_f32 v185, v118, v119
  v_accvgpr_write_b32 a184, v182
  v_accvgpr_write_b32 a185, v183
  v_accvgpr_write_b32 a186, v184
  v_accvgpr_write_b32 a187, v185
  v_pk_mul_f32 v[120:121], v[120:121], s[42:43]
  v_pk_mul_f32 v[122:123], v[122:123], s[42:43]
  v_pk_mul_f32 v[124:125], v[124:125], s[42:43]
  v_pk_mul_f32 v[126:127], v[126:127], s[42:43]
  v_cvt_pk_bf16_f32 v186, v120, v121
  v_cvt_pk_bf16_f32 v187, v122, v123
  v_cvt_pk_bf16_f32 v188, v124, v125
  v_cvt_pk_bf16_f32 v189, v126, v127
  v_accvgpr_write_b32 a188, v186
  v_accvgpr_write_b32 a189, v187
  v_accvgpr_write_b32 a190, v188
  v_accvgpr_write_b32 a191, v189
  s_waitcnt vmcnt(4)
  s_barrier
  s_mov_b32 m0, s32
  s_nop 0
  buffer_load_dwordx4 v176, s[4:7], s36 offen offset:0 lds
  buffer_load_dwordx4 v177, s[4:7], s36 offen offset:1024 lds
  buffer_load_dwordx4 v178, s[4:7], s36 offen offset:2048 lds
  buffer_load_dwordx4 v179, s[4:7], s36 offen offset:3072 lds
  s_add_u32 s36, s36, 16384
  s_mov_b32 m0, s33
  s_nop 0
  buffer_load_dwordx4 v176, s[4:7], s36 offen offset:0 lds
  buffer_load_dwordx4 v177, s[4:7], s36 offen offset:1024 lds
  buffer_load_dwordx4 v178, s[4:7], s36 offen offset:2048 lds
  buffer_load_dwordx4 v179, s[4:7], s36 offen offset:3072 lds
  s_add_u32 s36, s36, 16384
  s_lshl_b32 s63, s41, 11
  s_add_u32 s63, s63, 131072
  s_cmp_lt_u32 s29, 27
  s_cselect_b32 s63, s63, 0x40000000
  s_branch L_qk0_first
L_qk0:
  ds_read_b128 a[192:195], v160 offset:32768
  ds_read_b128 a[196:199], v161 offset:32768
  ds_read_b128 a[200:203], v162 offset:32768
  ds_read_b128 a[204:207], v163 offset:32768
  ds_read_b128 a[208:211], v160 offset:36864
  s_waitcnt lgkmcnt(1)
  v_mfma_f32_16x16x32_bf16 v[0:3], a[192:195], a[128:131], 0
  ds_read_b128 a[212:215], v161 offset:36864
  v_mfma_f32_16x16x32_bf16 v[0:3], a[196:199], a[132:135], v[0:3]
  v_mfma_f32_16x16x32_bf16 v[0:3], a[200:203], a[136:139], v[0:3]
  v_mfma_f32_16x16x32_bf16 v[0:3], a[204:207], a[140:143], v[0:3]
  v_mfma_f32_16x16x32_bf16 v[8:11], a[192:195], a[144:147], 0
  ds_read_b128 a[216:219], v162 offset:36864
  v_mfma_f32_16x16x32_bf16 v[8:11], a[196:199], a[148:151], v[8:11]
  v_mfma_f32_16x16x32_bf16 v[8:11], a[200:203], a[152:155], v[8:11]
  v_mfma_f32_16x16x32_bf16 v[8:11], a[204:207], a[156:159], v[8:11]
  v_mfma_f32_16x16x32_bf16 v[16:19], a[192:195], a[160:163], 0
  ds_read_b128 a[220:223], v163 offset:36864
  v_mfma_f32_16x16x32_bf16 v[16:19], a[196:199], a[164:167], v[16:19]
  v_mfma_f32_16x16x32_bf16 v[16:19], a[200:203], a[168:171], v[16:19]
  v_mfma_f32_16x16x32_bf16 v[16:19], a[204:207], a[172:175], v[16:19]
  v_mfma_f32_16x16x32_bf16 v[24:27], a[192:195], a[176:179], 0
  ds_read_b128 a[192:195], v160 offset:40960
  v_mfma_f32_16x16x32_bf16 v[24:27], a[196:199], a[180:183], v[24:27]
  v_mfma_f32_16x16x32_bf16 v[24:27], a[200:203], a[184:187], v[24:27]
  v_mfma_f32_16x16x32_bf16 v[24:27], a[204:207], a[188:191], v[24:27]
  s_waitcnt lgkmcnt(1)
  v_mfma_f32_16x16x32_bf16 v[4:7], a[208:211], a[128:131], 0
  ds_read_b128 a[196:199], v161 offset:40960
  v_mfma_f32_16x16x32_bf16 v[4:7], a[212:215], a[132:135], v[4:7]
  v_mfma_f32_16x16x32_bf16 v[4:7], a[216:219], a[136:139], v[4:7]
  v_mfma_f32_16x16x32_bf16 v[4:7], a[220:223], a[140:143], v[4:7]
  v_mfma_f32_16x16x32_bf16 v[12:15], a[208:211], a[144:147], 0
  ds_read_b128 a[200:203], v162 offset:40960
  v_mfma_f32_16x16x32_bf16 v[12:15], a[212:215], a[148:151], v[12:15]
  v_mfma_f32_16x16x32_bf16 v[12:15], a[216:219], a[152:155], v[12:15]
  v_mfma_f32_16x16x32_bf16 v[12:15], a[220:223], a[156:159], v[12:15]
  v_mfma_f32_16x16x32_bf16 v[20:23], a[208:211], a[160:163], 0
  ds_read_b128 a[204:207], v163 offset:40960
  v_mfma_f32_16x16x32_bf16 v[20:23], a[212:215], a[164:167], v[20:23]
  v_mfma_f32_16x16x32_bf16 v[20:23], a[216:219], a[168:171], v[20:23]
  v_mfma_f32_16x16x32_bf16 v[20:23], a[220:223], a[172:175], v[20:23]
  v_mfma_f32_16x16x32_bf16 v[28:31], a[208:211], a[176:179], 0
  ds_read_b128 a[208:211], v160 offset:45056
  v_mfma_f32_16x16x32_bf16 v[28:31], a[212:215], a[180:183], v[28:31]
  v_mfma_f32_16x16x32_bf16 v[28:31], a[216:219], a[184:187], v[28:31]
  v_mfma_f32_16x16x32_bf16 v[28:31], a[220:223], a[188:191], v[28:31]
  s_waitcnt lgkmcnt(1)
  v_mfma_f32_16x16x32_bf16 v[32:35], a[192:195], a[128:131], 0
  ds_read_b128 a[212:215], v161 offset:45056
  v_mfma_f32_16x16x32_bf16 v[32:35], a[196:199], a[132:135], v[32:35]
  v_mfma_f32_16x16x32_bf16 v[32:35], a[200:203], a[136:139], v[32:35]
  v_mfma_f32_16x16x32_bf16 v[32:35], a[204:207], a[140:143], v[32:35]
  v_mfma_f32_16x16x32_bf16 v[40:43], a[192:195], a[144:147], 0
  ds_read_b128 a[216:219], v162 offset:45056
  v_mfma_f32_16x16x32_bf16 v[40:43], a[196:199], a[148:151], v[40:43]
  v_mfma_f32_16x16x32_bf16 v[40:43], a[200:203], a[152:155], v[40:43]
  v_mfma_f32_16x16x32_bf16 v[40:43], a[204:207], a[156:159], v[40:43]
  v_mfma_f32_16x16x32_bf16 v[48:51], a[192:195], a[160:163], 0
  ds_read_b128 a[220:223], v163 offset:45056
  v_mfma_f32_16x16x32_bf16 v[48:51], a[196:199], a[164:167], v[48:51]
  v_mfma_f32_16x16x32_bf16 v[48:51], a[200:203], a[168:171], v[48:51]
  v_mfma_f32_16x16x32_bf16 v[48:51], a[204:207], a[172:175], v[48:51]
  v_mfma_f32_16x16x32_bf16 v[56:59], a[192:195], a[176:179], 0
  v_mfma_f32_16x16x32_bf16 v[56:59], a[196:199], a[180:183], v[56:59]
  v_mfma_f32_16x16x32_bf16 v[56:59], a[200:203], a[184:187], v[56:59]
  v_mfma_f32_16x16x32_bf16 v[56:59], a[204:207], a[188:191], v[56:59]
  s_waitcnt lgkmcnt(0)
  v_mfma_f32_16x16x32_bf16 v[36:39], a[208:211], a[128:131], 0
  v_mfma_f32_16x16x32_bf16 v[36:39], a[212:215], a[132:135], v[36:39]
  v_mfma_f32_16x16x32_bf16 v[36:39], a[216:219], a[136:139], v[36:39]
  v_mfma_f32_16x16x32_bf16 v[36:39], a[220:223], a[140:143], v[36:39]
  v_mfma_f32_16x16x32_bf16 v[44:47], a[208:211], a[144:147], 0
  v_mfma_f32_16x16x32_bf16 v[44:47], a[212:215], a[148:151], v[44:47]
  v_mfma_f32_16x16x32_bf16 v[44:47], a[216:219], a[152:155], v[44:47]
  v_mfma_f32_16x16x32_bf16 v[44:47], a[220:223], a[156:159], v[44:47]
  v_mfma_f32_16x16x32_bf16 v[52:55], a[208:211], a[160:163], 0
  v_mfma_f32_16x16x32_bf16 v[52:55], a[212:215], a[164:167], v[52:55]
  v_mfma_f32_16x16x32_bf16 v[52:55], a[216:219], a[168:171], v[52:55]
  v_mfma_f32_16x16x32_bf16 v[52:55], a[220:223], a[172:175], v[52:55]
  v_mfma_f32_16x16x32_bf16 v[60:63], a[208:211], a[176:179], 0
  v_mfma_f32_16x16x32_bf16 v[60:63], a[212:215], a[180:183], v[60:63]
  v_mfma_f32_16x16x32_bf16 v[60:63], a[216:219], a[184:187], v[60:63]
  v_mfma_f32_16x16x32_bf16 v[60:63], a[220:223], a[188:191], v[60:63]
  s_branch L_qk0_done
L_qk0_first:
  ds_read_b128 a[192:195], v160 offset:32768
  ds_read_b128 a[196:199], v161 offset:32768
  ds_read_b128 a[200:203], v162 offset:32768
  ds_read_b128 a[204:207], v163 offset:32768
  ds_read_b128 a[208:211], v160 offset:36864
  s_waitcnt lgkmcnt(1)
  v_mfma_f32_16x16x32_bf16 v[0:3], a[192:195], a[128:131], 0
  ds_read_b128 a[212:215], v161 offset:36864
  v_mfma_f32_16x16x32_bf16 v[0:3], a[196:199], a[132:135], v[0:3]
  v_mfma_f32_16x16x32_bf16 v[0:3], a[200:203], a[136:139], v[0:3]
  v_mfma_f32_16x16x32_bf16 v[0:3], a[204:207], a[140:143], v[0:3]
  v_mfma_f32_16x16x32_bf16 v[8:11], a[192:195], a[144:147], 0
  ds_read_b128 a[216:219], v162 offset:36864
  v_accvgpr_read_b32 v216, a0
  v_accvgpr_read_b32 v217, a1
  v_mul_f32 v190, 0xbfb8aa3b, v216
  v_mfma_f32_16x16x32_bf16 v[8:11], a[196:199], a[148:151], v[8:11]
  v_mul_f32 v191, 0xbfb8aa3b, v217
  v_exp_f32 v190, v190
  v_exp_f32 v191, v191
  v_mfma_f32_16x16x32_bf16 v[8:11], a[200:203], a[152:155], v[8:11]
  v_add_f32 v190, 1.0, v190
  v_add_f32 v191, 1.0, v191
  v_rcp_f32 v190, v190
  v_mfma_f32_16x16x32_bf16 v[8:11], a[204:207], a[156:159], v[8:11]
  v_rcp_f32 v191, v191
  v_mul_f32 v216, v216, v190
  v_mul_f32 v217, v217, v191
  v_mfma_f32_16x16x32_bf16 v[16:19], a[192:195], a[160:163], 0
  ds_read_b128 a[220:223], v163 offset:36864
  v_cvt_pk_bf16_f32 v216, v216, v217
  v_accvgpr_read_b32 v218, a2
  v_accvgpr_read_b32 v219, a3
  v_mfma_f32_16x16x32_bf16 v[16:19], a[196:199], a[164:167], v[16:19]
  v_mul_f32 v192, 0xbfb8aa3b, v218
  v_mul_f32 v193, 0xbfb8aa3b, v219
  v_exp_f32 v192, v192
  v_mfma_f32_16x16x32_bf16 v[16:19], a[200:203], a[168:171], v[16:19]
  v_exp_f32 v193, v193
  v_add_f32 v192, 1.0, v192
  v_add_f32 v193, 1.0, v193
  v_mfma_f32_16x16x32_bf16 v[16:19], a[204:207], a[172:175], v[16:19]
  v_rcp_f32 v192, v192
  v_rcp_f32 v193, v193
  v_mul_f32 v218, v218, v192
  v_mfma_f32_16x16x32_bf16 v[24:27], a[192:195], a[176:179], 0
  ds_read_b128 a[192:195], v160 offset:40960
  v_mul_f32 v219, v219, v193
  v_cvt_pk_bf16_f32 v217, v218, v219
  v_accvgpr_read_b32 v220, a4
  v_mfma_f32_16x16x32_bf16 v[24:27], a[196:199], a[180:183], v[24:27]
  v_accvgpr_read_b32 v221, a5
  v_mul_f32 v190, 0xbfb8aa3b, v220
  v_mul_f32 v191, 0xbfb8aa3b, v221
  v_mfma_f32_16x16x32_bf16 v[24:27], a[200:203], a[184:187], v[24:27]
  v_exp_f32 v190, v190
  v_exp_f32 v191, v191
  v_add_f32 v190, 1.0, v190
  v_mfma_f32_16x16x32_bf16 v[24:27], a[204:207], a[188:191], v[24:27]
  v_add_f32 v191, 1.0, v191
  v_rcp_f32 v190, v190
  v_rcp_f32 v191, v191
  s_waitcnt lgkmcnt(1)
  v_mfma_f32_16x16x32_bf16 v[4:7], a[208:211], a[128:131], 0
  ds_read_b128 a[196:199], v161 offset:40960
  v_mul_f32 v220, v220, v190
  v_mul_f32 v221, v221, v191
  v_cvt_pk_bf16_f32 v218, v220, v221
  v_mfma_f32_16x16x32_bf16 v[4:7], a[212:215], a[132:135], v[4:7]
  v_accvgpr_read_b32 v222, a6
  v_accvgpr_read_b32 v223, a7
  v_mul_f32 v192, 0xbfb8aa3b, v222
  v_mfma_f32_16x16x32_bf16 v[4:7], a[216:219], a[136:139], v[4:7]
  v_mul_f32 v193, 0xbfb8aa3b, v223
  v_exp_f32 v192, v192
  v_exp_f32 v193, v193
  v_mfma_f32_16x16x32_bf16 v[4:7], a[220:223], a[140:143], v[4:7]
  v_add_f32 v192, 1.0, v192
  v_add_f32 v193, 1.0, v193
  v_rcp_f32 v192, v192
  v_mfma_f32_16x16x32_bf16 v[12:15], a[208:211], a[144:147], 0
  ds_read_b128 a[200:203], v162 offset:40960
  v_rcp_f32 v193, v193
  v_mul_f32 v222, v222, v192
  v_mul_f32 v223, v223, v193
  v_mfma_f32_16x16x32_bf16 v[12:15], a[212:215], a[148:151], v[12:15]
  v_cvt_pk_bf16_f32 v219, v222, v223
  s_add_u32 s47, s63, 0
  buffer_store_dwordx4 v[216:219], v201, s[24:27], s47 offen
  v_mfma_f32_16x16x32_bf16 v[12:15], a[216:219], a[152:155], v[12:15]
  v_accvgpr_read_b32 v224, a8
  v_accvgpr_read_b32 v225, a9
  v_mul_f32 v190, 0xbfb8aa3b, v224
  v_mfma_f32_16x16x32_bf16 v[12:15], a[220:223], a[156:159], v[12:15]
  v_mul_f32 v191, 0xbfb8aa3b, v225
  v_exp_f32 v190, v190
  v_exp_f32 v191, v191
  v_mfma_f32_16x16x32_bf16 v[20:23], a[208:211], a[160:163], 0
  ds_read_b128 a[204:207], v163 offset:40960
  v_add_f32 v190, 1.0, v190
  v_add_f32 v191, 1.0, v191
  v_rcp_f32 v190, v190
  v_mfma_f32_16x16x32_bf16 v[20:23], a[212:215], a[164:167], v[20:23]
  v_rcp_f32 v191, v191
  v_mul_f32 v224, v224, v190
  v_mul_f32 v225, v225, v191
  v_mfma_f32_16x16x32_bf16 v[20:23], a[216:219], a[168:171], v[20:23]
  v_cvt_pk_bf16_f32 v224, v224, v225
  v_accvgpr_read_b32 v226, a10
  v_accvgpr_read_b32 v227, a11
  v_mfma_f32_16x16x32_bf16 v[20:23], a[220:223], a[172:175], v[20:23]
  v_mul_f32 v192, 0xbfb8aa3b, v226
  v_mul_f32 v193, 0xbfb8aa3b, v227
  v_exp_f32 v192, v192
  v_mfma_f32_16x16x32_bf16 v[28:31], a[208:211], a[176:179], 0
  ds_read_b128 a[208:211], v160 offset:45056
  v_exp_f32 v193, v193
  v_add_f32 v192, 1.0, v192
  v_add_f32 v193, 1.0, v193
  v_mfma_f32_16x16x32_bf16 v[28:31], a[212:215], a[180:183], v[28:31]
  v_rcp_f32 v192, v192
  v_rcp_f32 v193, v193
  v_mul_f32 v226, v226, v192
  v_mfma_f32_16x16x32_bf16 v[28:31], a[216:219], a[184:187], v[28:31]
  v_mul_f32 v227, v227, v193
  v_cvt_pk_bf16_f32 v225, v226, v227
  v_accvgpr_read_b32 v228, a12
  v_mfma_f32_16x16x32_bf16 v[28:31], a[220:223], a[188:191], v[28:31]
  v_accvgpr_read_b32 v229, a13
  v_mul_f32 v190, 0xbfb8aa3b, v228
  v_mul_f32 v191, 0xbfb8aa3b, v229
  s_waitcnt lgkmcnt(1)
  v_mfma_f32_16x16x32_bf16 v[32:35], a[192:195], a[128:131], 0
  ds_read_b128 a[212:215], v161 offset:45056
  v_exp_f32 v190, v190
  v_exp_f32 v191, v191
  v_add_f32 v190, 1.0, v190
  v_mfma_f32_16x16x32_bf16 v[32:35], a[196:199], a[132:135], v[32:35]
  v_add_f32 v191, 1.0, v191
  v_rcp_f32 v190, v190
  v_rcp_f32 v191, v191
  v_mfma_f32_16x16x32_bf16 v[32:35], a[200:203], a[136:139], v[32:35]
  v_mul_f32 v228, v228, v190
  v_mul_f32 v229, v229, v191
  v_cvt_pk_bf16_f32 v226, v228, v229
  v_mfma_f32_16x16x32_bf16 v[32:35], a[204:207], a[140:143], v[32:35]
  v_accvgpr_read_b32 v230, a14
  v_accvgpr_read_b32 v231, a15
  v_mul_f32 v192, 0xbfb8aa3b, v230
  v_mfma_f32_16x16x32_bf16 v[40:43], a[192:195], a[144:147], 0
  ds_read_b128 a[216:219], v162 offset:45056
  v_mul_f32 v193, 0xbfb8aa3b, v231
  v_exp_f32 v192, v192
  v_exp_f32 v193, v193
  v_mfma_f32_16x16x32_bf16 v[40:43], a[196:199], a[148:151], v[40:43]
  v_add_f32 v192, 1.0, v192
  v_add_f32 v193, 1.0, v193
  v_rcp_f32 v192, v192
  v_mfma_f32_16x16x32_bf16 v[40:43], a[200:203], a[152:155], v[40:43]
  v_rcp_f32 v193, v193
  v_mul_f32 v230, v230, v192
  v_mul_f32 v231, v231, v193
  v_mfma_f32_16x16x32_bf16 v[40:43], a[204:207], a[156:159], v[40:43]
  v_cvt_pk_bf16_f32 v227, v230, v231
  s_add_u32 s47, s63, 1024
  buffer_store_dwordx4 v[224:227], v201, s[24:27], s47 offen
  v_mfma_f32_16x16x32_bf16 v[48:51], a[192:195], a[160:163], 0
  ds_read_b128 a[220:223], v163 offset:45056
  v_accvgpr_read_b32 v216, a16
  v_accvgpr_read_b32 v217, a17
  v_mul_f32 v190, 0xbfb8aa3b, v216
  v_mfma_f32_16x16x32_bf16 v[48:51], a[196:199], a[164:167], v[48:51]
  v_mul_f32 v191, 0xbfb8aa3b, v217
  v_exp_f32 v190, v190
  v_exp_f32 v191, v191
  v_mfma_f32_16x16x32_bf16 v[48:51], a[200:203], a[168:171], v[48:51]
  v_add_f32 v190, 1.0, v190
  v_add_f32 v191, 1.0, v191
  v_rcp_f32 v190, v190
  v_mfma_f32_16x16x32_bf16 v[48:51], a[204:207], a[172:175], v[48:51]
  v_rcp_f32 v191, v191
  v_mul_f32 v216, v216, v190
  v_mul_f32 v217, v217, v191
  v_mfma_f32_16x16x32_bf16 v[56:59], a[192:195], a[176:179], 0
  v_cvt_pk_bf16_f32 v216, v216, v217
  v_accvgpr_read_b32 v218, a18
  v_accvgpr_read_b32 v219, a19
  v_mfma_f32_16x16x32_bf16 v[56:59], a[196:199], a[180:183], v[56:59]
  v_mul_f32 v192, 0xbfb8aa3b, v218
  v_mul_f32 v193, 0xbfb8aa3b, v219
  v_exp_f32 v192, v192
  v_mfma_f32_16x16x32_bf16 v[56:59], a[200:203], a[184:187], v[56:59]
  v_exp_f32 v193, v193
  v_add_f32 v192, 1.0, v192
  v_add_f32 v193, 1.0, v193
  v_mfma_f32_16x16x32_bf16 v[56:59], a[204:207], a[188:191], v[56:59]
  v_rcp_f32 v192, v192
  v_rcp_f32 v193, v193
  v_mul_f32 v218, v218, v192
  s_waitcnt lgkmcnt(0)
  v_mfma_f32_16x16x32_bf16 v[36:39], a[208:211], a[128:131], 0
  v_mul_f32 v219, v219, v193
  v_cvt_pk_bf16_f32 v217, v218, v219
  v_accvgpr_read_b32 v220, a20
  v_mfma_f32_16x16x32_bf16 v[36:39], a[212:215], a[132:135], v[36:39]
  v_accvgpr_read_b32 v221, a21
  v_mul_f32 v190, 0xbfb8aa3b, v220
  v_mul_f32 v191, 0xbfb8aa3b, v221
  v_mfma_f32_16x16x32_bf16 v[36:39], a[216:219], a[136:139], v[36:39]
  v_exp_f32 v190, v190
  v_exp_f32 v191, v191
  v_add_f32 v190, 1.0, v190
  v_mfma_f32_16x16x32_bf16 v[36:39], a[220:223], a[140:143], v[36:39]
  v_add_f32 v191, 1.0, v191
  v_rcp_f32 v190, v190
  v_rcp_f32 v191, v191
  v_mfma_f32_16x16x32_bf16 v[44:47], a[208:211], a[144:147], 0
  v_mul_f32 v220, v220, v190
  v_mul_f32 v221, v221, v191
  v_cvt_pk_bf16_f32 v218, v220, v221
  v_mfma_f32_16x16x32_bf16 v[44:47], a[212:215], a[148:151], v[44:47]
  v_accvgpr_read_b32 v222, a22
  v_accvgpr_read_b32 v223, a23
  v_mul_f32 v192, 0xbfb8aa3b, v222
  v_mfma_f32_16x16x32_bf16 v[44:47], a[216:219], a[152:155], v[44:47]
  v_mul_f32 v193, 0xbfb8aa3b, v223
  v_exp_f32 v192, v192
  v_exp_f32 v193, v193
  v_mfma_f32_16x16x32_bf16 v[44:47], a[220:223], a[156:159], v[44:47]
  v_add_f32 v192, 1.0, v192
  v_add_f32 v193, 1.0, v193
  v_rcp_f32 v192, v192
  v_mfma_f32_16x16x32_bf16 v[52:55], a[208:211], a[160:163], 0
  v_rcp_f32 v193, v193
  v_mul_f32 v222, v222, v192
  v_mul_f32 v223, v223, v193
  v_mfma_f32_16x16x32_bf16 v[52:55], a[212:215], a[164:167], v[52:55]
  v_cvt_pk_bf16_f32 v219, v222, v223
  s_add_u32 s47, s63, 186368
  buffer_store_dwordx4 v[216:219], v201, s[24:27], s47 offen
  v_mfma_f32_16x16x32_bf16 v[52:55], a[216:219], a[168:171], v[52:55]
  v_accvgpr_read_b32 v224, a24
  v_accvgpr_read_b32 v225, a25
  v_mul_f32 v190, 0xbfb8aa3b, v224
  v_mfma_f32_16x16x32_bf16 v[52:55], a[220:223], a[172:175], v[52:55]
  v_mul_f32 v191, 0xbfb8aa3b, v225
  v_exp_f32 v190, v190
  v_exp_f32 v191, v191
  v_mfma_f32_16x16x32_bf16 v[60:63], a[208:211], a[176:179], 0
  v_add_f32 v190, 1.0, v190
  v_add_f32 v191, 1.0, v191
  v_rcp_f32 v190, v190
  v_mfma_f32_16x16x32_bf16 v[60:63], a[212:215], a[180:183], v[60:63]
  v_rcp_f32 v191, v191
  v_mul_f32 v224, v224, v190
  v_mul_f32 v225, v225, v191
  v_mfma_f32_16x16x32_bf16 v[60:63], a[216:219], a[184:187], v[60:63]
  v_cvt_pk_bf16_f32 v224, v224, v225
  v_accvgpr_read_b32 v226, a26
  v_accvgpr_read_b32 v227, a27
  v_mfma_f32_16x16x32_bf16 v[60:63], a[220:223], a[188:191], v[60:63]
  v_mul_f32 v192, 0xbfb8aa3b, v226
  v_mul_f32 v193, 0xbfb8aa3b, v227
  v_exp_f32 v192, v192
  v_exp_f32 v193, v193
  v_add_f32 v192, 1.0, v192
  v_add_f32 v193, 1.0, v193
  v_rcp_f32 v192, v192
  v_rcp_f32 v193, v193
  v_mul_f32 v226, v226, v192
  v_mul_f32 v227, v227, v193
  v_cvt_pk_bf16_f32 v225, v226, v227
  v_accvgpr_read_b32 v228, a28
  v_accvgpr_read_b32 v229, a29
  v_mul_f32 v190, 0xbfb8aa3b, v228
  v_mul_f32 v191, 0xbfb8aa3b, v229
  v_exp_f32 v190, v190
  v_exp_f32 v191, v191
  v_add_f32 v190, 1.0, v190
  v_add_f32 v191, 1.0, v191
  v_rcp_f32 v190, v190
  v_rcp_f32 v191, v191
  v_mul_f32 v228, v228, v190
  v_mul_f32 v229, v229, v191
  v_cvt_pk_bf16_f32 v226, v228, v229
  v_accvgpr_read_b32 v230, a30
  v_accvgpr_read_b32 v231, a31
  v_mul_f32 v192, 0xbfb8aa3b, v230
  v_mul_f32 v193, 0xbfb8aa3b, v231
  v_exp_f32 v192, v192
  v_exp_f32 v193, v193
  v_add_f32 v192, 1.0, v192
  v_add_f32 v193, 1.0, v193
  v_rcp_f32 v192, v192
  v_rcp_f32 v193, v193
  v_mul_f32 v230, v230, v192
  v_mul_f32 v231, v231, v193
  v_cvt_pk_bf16_f32 v227, v230, v231
  s_add_u32 s47, s63, 187392
  buffer_store_dwordx4 v[224:227], v201, s[24:27], s47 offen
  v_accvgpr_read_b32 v216, a32
  v_accvgpr_read_b32 v217, a33
  v_mul_f32 v190, 0xbfb8aa3b, v216
  v_mul_f32 v191, 0xbfb8aa3b, v217
  v_exp_f32 v190, v190
  v_exp_f32 v191, v191
  v_add_f32 v190, 1.0, v190
  v_add_f32 v191, 1.0, v191
  v_rcp_f32 v190, v190
  v_rcp_f32 v191, v191
  v_mul_f32 v216, v216, v190
  v_mul_f32 v217, v217, v191
  v_cvt_pk_bf16_f32 v216, v216, v217
  v_accvgpr_read_b32 v218, a34
  v_accvgpr_read_b32 v219, a35
  v_mul_f32 v192, 0xbfb8aa3b, v218
  v_mul_f32 v193, 0xbfb8aa3b, v219
  v_exp_f32 v192, v192
  v_exp_f32 v193, v193
  v_add_f32 v192, 1.0, v192
  v_add_f32 v193, 1.0, v193
  v_rcp_f32 v192, v192
  v_rcp_f32 v193, v193
  v_mul_f32 v218, v218, v192
  v_mul_f32 v219, v219, v193
  v_cvt_pk_bf16_f32 v217, v218, v219
  v_accvgpr_read_b32 v220, a36
  v_accvgpr_read_b32 v221, a37
  v_mul_f32 v190, 0xbfb8aa3b, v220
  v_mul_f32 v191, 0xbfb8aa3b, v221
  v_exp_f32 v190, v190
  v_exp_f32 v191, v191
  v_add_f32 v190, 1.0, v190
  v_add_f32 v191, 1.0, v191
  v_rcp_f32 v190, v190
  v_rcp_f32 v191, v191
  v_mul_f32 v220, v220, v190
  v_mul_f32 v221, v221, v191
  v_cvt_pk_bf16_f32 v218, v220, v221
  v_accvgpr_read_b32 v222, a38
  v_accvgpr_read_b32 v223, a39
  v_mul_f32 v192, 0xbfb8aa3b, v222
  v_mul_f32 v193, 0xbfb8aa3b, v223
  v_exp_f32 v192, v192
  v_exp_f32 v193, v193
  v_add_f32 v192, 1.0, v192
  v_add_f32 v193, 1.0, v193
  v_rcp_f32 v192, v192
  v_rcp_f32 v193, v193
  v_mul_f32 v222, v222, v192
  v_mul_f32 v223, v223, v193
  v_cvt_pk_bf16_f32 v219, v222, v223
  s_add_u32 s47, s63, 372736
  buffer_store_dwordx4 v[216:219], v201, s[24:27], s47 offen
  v_accvgpr_read_b32 v224, a40
  v_accvgpr_read_b32 v225, a41
  v_mul_f32 v190, 0xbfb8aa3b, v224
  v_mul_f32 v191, 0xbfb8aa3b, v225
  v_exp_f32 v190, v190
  v_exp_f32 v191, v191
  v_add_f32 v190, 1.0, v190
  v_add_f32 v191, 1.0, v191
  v_rcp_f32 v190, v190
  v_rcp_f32 v191, v191
  v_mul_f32 v224, v224, v190
  v_mul_f32 v225, v225, v191
  v_cvt_pk_bf16_f32 v224, v224, v225
  v_accvgpr_read_b32 v226, a42
  v_accvgpr_read_b32 v227, a43
  v_mul_f32 v192, 0xbfb8aa3b, v226
  v_mul_f32 v193, 0xbfb8aa3b, v227
  v_exp_f32 v192, v192
  v_exp_f32 v193, v193
  v_add_f32 v192, 1.0, v192
  v_add_f32 v193, 1.0, v193
  v_rcp_f32 v192, v192
  v_rcp_f32 v193, v193
  v_mul_f32 v226, v226, v192
  v_mul_f32 v227, v227, v193
  v_cvt_pk_bf16_f32 v225, v226, v227
  v_accvgpr_read_b32 v228, a44
  v_accvgpr_read_b32 v229, a45
  v_mul_f32 v190, 0xbfb8aa3b, v228
  v_mul_f32 v191, 0xbfb8aa3b, v229
  v_exp_f32 v190, v190
  v_exp_f32 v191, v191
  v_add_f32 v190, 1.0, v190
  v_add_f32 v191, 1.0, v191
  v_rcp_f32 v190, v190
  v_rcp_f32 v191, v191
  v_mul_f32 v228, v228, v190
  v_mul_f32 v229, v229, v191
  v_cvt_pk_bf16_f32 v226, v228, v229
  v_accvgpr_read_b32 v230, a46
  v_accvgpr_read_b32 v231, a47
  v_mul_f32 v192, 0xbfb8aa3b, v230
  v_mul_f32 v193, 0xbfb8aa3b, v231
  v_exp_f32 v192, v192
  v_exp_f32 v193, v193
  v_add_f32 v192, 1.0, v192
  v_add_f32 v193, 1.0, v193
  v_rcp_f32 v192, v192
  v_rcp_f32 v193, v193
  v_mul_f32 v230, v230, v192
  v_mul_f32 v231, v231, v193
  v_cvt_pk_bf16_f32 v227, v230, v231
  s_add_u32 s47, s63, 373760
  buffer_store_dwordx4 v[224:227], v201, s[24:27], s47 offen
  v_accvgpr_read_b32 v216, a48
  v_accvgpr_read_b32 v217, a49
  v_mul_f32 v190, 0xbfb8aa3b, v216
  v_mul_f32 v191, 0xbfb8aa3b, v217
  v_exp_f32 v190, v190
  v_exp_f32 v191, v191
  v_add_f32 v190, 1.0, v190
  v_add_f32 v191, 1.0, v191
  v_rcp_f32 v190, v190
  v_rcp_f32 v191, v191
  v_mul_f32 v216, v216, v190
  v_mul_f32 v217, v217, v191
  v_cvt_pk_bf16_f32 v216, v216, v217
  v_accvgpr_read_b32 v218, a50
  v_accvgpr_read_b32 v219, a51
  v_mul_f32 v192, 0xbfb8aa3b, v218
  v_mul_f32 v193, 0xbfb8aa3b, v219
  v_exp_f32 v192, v192
  v_exp_f32 v193, v193
  v_add_f32 v192, 1.0, v192
  v_add_f32 v193, 1.0, v193
  v_rcp_f32 v192, v192
  v_rcp_f32 v193, v193
  v_mul_f32 v218, v218, v192
  v_mul_f32 v219, v219, v193
  v_cvt_pk_bf16_f32 v217, v218, v219
  v_accvgpr_read_b32 v220, a52
  v_accvgpr_read_b32 v221, a53
  v_mul_f32 v190, 0xbfb8aa3b, v220
  v_mul_f32 v191, 0xbfb8aa3b, v221
  v_exp_f32 v190, v190
  v_exp_f32 v191, v191
  v_add_f32 v190, 1.0, v190
  v_add_f32 v191, 1.0, v191
  v_rcp_f32 v190, v190
  v_rcp_f32 v191, v191
  v_mul_f32 v220, v220, v190
  v_mul_f32 v221, v221, v191
  v_cvt_pk_bf16_f32 v218, v220, v221
  v_accvgpr_read_b32 v222, a54
  v_accvgpr_read_b32 v223, a55
  v_mul_f32 v192, 0xbfb8aa3b, v222
  v_mul_f32 v193, 0xbfb8aa3b, v223
  v_exp_f32 v192, v192
  v_exp_f32 v193, v193
  v_add_f32 v192, 1.0, v192
  v_add_f32 v193, 1.0, v193
  v_rcp_f32 v192, v192
  v_rcp_f32 v193, v193
  v_mul_f32 v222, v222, v192
  v_mul_f32 v223, v223, v193
  v_cvt_pk_bf16_f32 v219, v222, v223
  s_add_u32 s47, s63, 559104
  buffer_store_dwordx4 v[216:219], v201, s[24:27], s47 offen
  v_accvgpr_read_b32 v224, a56
  v_accvgpr_read_b32 v225, a57
  v_mul_f32 v190, 0xbfb8aa3b, v224
  v_mul_f32 v191, 0xbfb8aa3b, v225
  v_exp_f32 v190, v190
  v_exp_f32 v191, v191
  v_add_f32 v190, 1.0, v190
  v_add_f32 v191, 1.0, v191
  v_rcp_f32 v190, v190
  v_rcp_f32 v191, v191
  v_mul_f32 v224, v224, v190
  v_mul_f32 v225, v225, v191
  v_cvt_pk_bf16_f32 v224, v224, v225
  v_accvgpr_read_b32 v226, a58
  v_accvgpr_read_b32 v227, a59
  v_mul_f32 v192, 0xbfb8aa3b, v226
  v_mul_f32 v193, 0xbfb8aa3b, v227
  v_exp_f32 v192, v192
  v_exp_f32 v193, v193
  v_add_f32 v192, 1.0, v192
  v_add_f32 v193, 1.0, v193
  v_rcp_f32 v192, v192
  v_rcp_f32 v193, v193
  v_mul_f32 v226, v226, v192
  v_mul_f32 v227, v227, v193
  v_cvt_pk_bf16_f32 v225, v226, v227
  v_accvgpr_read_b32 v228, a60
  v_accvgpr_read_b32 v229, a61
  v_mul_f32 v190, 0xbfb8aa3b, v228
  v_mul_f32 v191, 0xbfb8aa3b, v229
  v_exp_f32 v190, v190
  v_exp_f32 v191, v191
  v_add_f32 v190, 1.0, v190
  v_add_f32 v191, 1.0, v191
  v_rcp_f32 v190, v190
  v_rcp_f32 v191, v191
  v_mul_f32 v228, v228, v190
  v_mul_f32 v229, v229, v191
  v_cvt_pk_bf16_f32 v226, v228, v229
  v_accvgpr_read_b32 v230, a62
  v_accvgpr_read_b32 v231, a63
  v_mul_f32 v192, 0xbfb8aa3b, v230
  v_mul_f32 v193, 0xbfb8aa3b, v231
  v_exp_f32 v192, v192
  v_exp_f32 v193, v193
  v_add_f32 v192, 1.0, v192
  v_add_f32 v193, 1.0, v193
  v_rcp_f32 v192, v192
  v_rcp_f32 v193, v193
  v_mul_f32 v230, v230, v192
  v_mul_f32 v231, v231, v193
  v_cvt_pk_bf16_f32 v227, v230, v231
  s_add_u32 s47, s63, 560128
  buffer_store_dwordx4 v[224:227], v201, s[24:27], s47 offen
L_qk0_done:
  v_mov_b32 v182, 0
  v_mov_b32 v183, 0
  v_mov_b32 v184, 0
  v_mov_b32 v185, 0
  v_mov_b32 v144, 0
  v_mov_b32 v145, 0
  v_mov_b32 v146, 0
  v_mov_b32 v147, 0
  v_mov_b32 v148, 0
  v_mov_b32 v149, 0
  v_mov_b32 v150, 0
  v_mov_b32 v151, 0
  v_mov_b32 v152, 0
  v_mov_b32 v153, 0
  v_mov_b32 v154, 0
  v_mov_b32 v155, 0
  v_mov_b32 v156, 0
  v_mov_b32 v157, 0
  v_mov_b32 v158, 0
  v_mov_b32 v159, 0
  s_nop 1
  v_mfma_f32_16x16x32_bf16 a[0:3], v[182:185], v[182:185], 0
  v_max3_f32 v186, v0, v1, v232
  v_max3_f32 v186, v2, v3, v186
  v_max3_f32 v186, v4, v5, v186
  v_max3_f32 v186, v6, v7, v186
  v_max3_f32 v186, v32, v33, v186
  v_mfma_f32_16x16x32_bf16 a[4:7], v[182:185], v[182:185], 0
  v_max3_f32 v186, v34, v35, v186
  v_max3_f32 v186, v36, v37, v186
  v_max3_f32 v186, v38, v39, v186
  v_mov_b32 v187, v186
  s_nop 1
  v_mfma_f32_16x16x32_bf16 a[8:11], v[182:185], v[182:185], 0
  v_permlane16_swap_b32 v186, v187
  s_nop 1
  v_max_f32 v186, v186, v187
  v_mov_b32 v187, v186
  s_nop 1
  v_mfma_f32_16x16x32_bf16 a[12:15], v[182:185], v[182:185], 0
  v_permlane32_swap_b32 v186, v187
  s_nop 1
  v_max_f32 v186, v186, v187
  v_add_f32 v186, s31, v186
  v_sub_f32 v128, 0, v186
  v_mfma_f32_16x16x32_bf16 a[16:19], v[182:185], v[182:185], 0
  v_sub_f32 v129, 0, v186
  v_sub_f32 v130, 0, v186
  v_sub_f32 v131, 0, v186
  v_sub_f32 v0, v0, v186
  v_sub_f32 v1, v1, v186
  v_mfma_f32_16x16x32_bf16 a[20:23], v[182:185], v[182:185], 0
  v_sub_f32 v2, v2, v186
  v_sub_f32 v3, v3, v186
  v_sub_f32 v4, v4, v186
  v_sub_f32 v5, v5, v186
  v_sub_f32 v6, v6, v186
  v_mfma_f32_16x16x32_bf16 a[24:27], v[182:185], v[182:185], 0
  v_sub_f32 v7, v7, v186
  v_sub_f32 v32, v32, v186
  v_sub_f32 v33, v33, v186
  v_sub_f32 v34, v34, v186
  v_sub_f32 v35, v35, v186
  v_mfma_f32_16x16x32_bf16 a[28:31], v[182:185], v[182:185], 0
  v_sub_f32 v36, v36, v186
  v_sub_f32 v37, v37, v186
  v_sub_f32 v38, v38, v186
  v_sub_f32 v39, v39, v186
  v_max3_f32 v188, v8, v9, v233
  v_mfma_f32_16x16x32_bf16 a[32:35], v[182:185], v[182:185], 0
  v_max3_f32 v188, v10, v11, v188
  v_max3_f32 v188, v12, v13, v188
  v_max3_f32 v188, v14, v15, v188
  v_max3_f32 v188, v40, v41, v188
  v_max3_f32 v188, v42, v43, v188
  v_mfma_f32_16x16x32_bf16 a[36:39], v[182:185], v[182:185], 0
  v_max3_f32 v188, v44, v45, v188
  v_max3_f32 v188, v46, v47, v188
  v_mov_b32 v189, v188
  s_nop 1
  v_permlane16_swap_b32 v188, v189
  v_mfma_f32_16x16x32_bf16 a[40:43], v[182:185], v[182:185], 0
  s_nop 1
  v_max_f32 v188, v188, v189
  v_mov_b32 v189, v188
  s_nop 1
  v_permlane32_swap_b32 v188, v189
  v_mfma_f32_16x16x32_bf16 a[44:47], v[182:185], v[182:185], 0
  s_nop 1
  v_max_f32 v188, v188, v189
  v_add_f32 v188, s31, v188
  v_sub_f32 v132, 0, v188
  v_sub_f32 v133, 0, v188
  v_mfma_f32_16x16x32_bf16 a[48:51], v[182:185], v[182:185], 0
  v_sub_f32 v134, 0, v188
  v_sub_f32 v135, 0, v188
  v_sub_f32 v8, v8, v188
  v_sub_f32 v9, v9, v188
  v_sub_f32 v10, v10, v188
  v_mfma_f32_16x16x32_bf16 a[52:55], v[182:185], v[182:185], 0
  v_sub_f32 v11, v11, v188
  v_sub_f32 v12, v12, v188
  v_sub_f32 v13, v13, v188
  v_sub_f32 v14, v14, v188
  v_sub_f32 v15, v15, v188
  v_mfma_f32_16x16x32_bf16 a[56:59], v[182:185], v[182:185], 0
  v_sub_f32 v40, v40, v188
  v_sub_f32 v41, v41, v188
  v_sub_f32 v42, v42, v188
  v_sub_f32 v43, v43, v188
  v_sub_f32 v44, v44, v188
  v_mfma_f32_16x16x32_bf16 a[60:63], v[182:185], v[182:185], 0
  v_sub_f32 v45, v45, v188
  v_sub_f32 v46, v46, v188
  v_sub_f32 v47, v47, v188
  v_max3_f32 v190, v16, v17, v234
  v_max3_f32 v190, v18, v19, v190
  v_mfma_f32_16x16x32_bf16 a[64:67], v[182:185], v[182:185], 0
  v_max3_f32 v190, v20, v21, v190
  v_max3_f32 v190, v22, v23, v190
  v_max3_f32 v190, v48, v49, v190
  v_max3_f32 v190, v50, v51, v190
  v_max3_f32 v190, v52, v53, v190
  v_mfma_f32_16x16x32_bf16 a[68:71], v[182:185], v[182:185], 0
  v_max3_f32 v190, v54, v55, v190
  v_mov_b32 v191, v190
  s_nop 1
  v_permlane16_swap_b32 v190, v191
  s_nop 1
  v_mfma_f32_16x16x32_bf16 a[72:75], v[182:185], v[182:185], 0
  v_max_f32 v190, v190, v191
  v_mov_b32 v191, v190
  s_nop 1
  v_permlane32_swap_b32 v190, v191
  s_nop 1
  v_mfma_f32_16x16x32_bf16 a[76:79], v[182:185], v[182:185], 0
  v_max_f32 v190, v190, v191
  v_add_f32 v190, s31, v190
  v_sub_f32 v136, 0, v190
  v_sub_f32 v137, 0, v190
  v_sub_f32 v138, 0, v190
  v_mfma_f32_16x16x32_bf16 a[80:83], v[182:185], v[182:185], 0
  v_sub_f32 v139, 0, v190
  v_sub_f32 v16, v16, v190
  v_sub_f32 v17, v17, v190
  v_sub_f32 v18, v18, v190
  v_sub_f32 v19, v19, v190
  v_mfma_f32_16x16x32_bf16 a[84:87], v[182:185], v[182:185], 0
  v_sub_f32 v20, v20, v190
  v_sub_f32 v21, v21, v190
  v_sub_f32 v22, v22, v190
  v_sub_f32 v23, v23, v190
  v_sub_f32 v48, v48, v190
  v_mfma_f32_16x16x32_bf16 a[88:91], v[182:185], v[182:185], 0
  v_sub_f32 v49, v49, v190
  v_sub_f32 v50, v50, v190
  v_sub_f32 v51, v51, v190
  v_sub_f32 v52, v52, v190
  v_sub_f32 v53, v53, v190
  v_mfma_f32_16x16x32_bf16 a[92:95], v[182:185], v[182:185], 0
  v_sub_f32 v54, v54, v190
  v_sub_f32 v55, v55, v190
  v_max3_f32 v192, v24, v25, v235
  v_max3_f32 v192, v26, v27, v192
  v_max3_f32 v192, v28, v29, v192
  v_mfma_f32_16x16x32_bf16 a[96:99], v[182:185], v[182:185], 0
  v_max3_f32 v192, v30, v31, v192
  v_max3_f32 v192, v56, v57, v192
  v_max3_f32 v192, v58, v59, v192
  v_max3_f32 v192, v60, v61, v192
  v_max3_f32 v192, v62, v63, v192
  v_mfma_f32_16x16x32_bf16 a[100:103], v[182:185], v[182:185], 0
  v_mov_b32 v193, v192
  s_nop 1
  v_permlane16_swap_b32 v192, v193
  s_nop 1
  v_max_f32 v192, v192, v193
  v_mfma_f32_16x16x32_bf16 a[104:107], v[182:185], v[182:185], 0
  v_mov_b32 v193, v192
  s_nop 1
  v_permlane32_swap_b32 v192, v193
  s_nop 1
  v_max_f32 v192, v192, v193
  v_mfma_f32_16x16x32_bf16 a[108:111], v[182:185], v[182:185], 0
  v_add_f32 v192, s31, v192
  v_sub_f32 v140, 0, v192
  v_sub_f32 v141, 0, v192
  v_sub_f32 v142, 0, v192
  v_sub_f32 v143, 0, v192
  v_mfma_f32_16x16x32_bf16 a[112:115], v[182:185], v[182:185], 0
  v_sub_f32 v24, v24, v192
  v_sub_f32 v25, v25, v192
  v_sub_f32 v26, v26, v192
  v_sub_f32 v27, v27, v192
  v_sub_f32 v28, v28, v192
  v_mfma_f32_16x16x32_bf16 a[116:119], v[182:185], v[182:185], 0
  v_sub_f32 v29, v29, v192
  v_sub_f32 v30, v30, v192
  v_sub_f32 v31, v31, v192
  v_sub_f32 v56, v56, v192
  v_sub_f32 v57, v57, v192
  v_mfma_f32_16x16x32_bf16 a[120:123], v[182:185], v[182:185], 0
  v_sub_f32 v58, v58, v192
  v_sub_f32 v59, v59, v192
  v_sub_f32 v60, v60, v192
  v_sub_f32 v61, v61, v192
  v_sub_f32 v62, v62, v192
  v_mfma_f32_16x16x32_bf16 a[124:127], v[182:185], v[182:185], 0
  v_sub_f32 v63, v63, v192
  s_waitcnt vmcnt(16)
  s_barrier
  ds_read_b128 a[192:195], v160 offset:49152
  ds_read_b128 a[196:199], v161 offset:49152
  ds_read_b128 a[200:203], v162 offset:49152
  ds_read_b128 a[204:207], v163 offset:49152
  ds_read_b128 a[208:211], v160 offset:53248
  s_add_u32 m0, s34, 65536
  s_nop 0
  buffer_load_dwordx4 v180, s[8:11], s37 offen offset:0 lds
  buffer_load_dwordx4 v181, s[8:11], s37 offen offset:1024 lds
  buffer_load_dwordx4 v180, s[8:11], s37 offen offset:2048 lds
  buffer_load_dwordx4 v181, s[8:11], s37 offen offset:3072 lds
  s_add_u32 s37, s37, 16384
  s_mov_b32 m0, s34
  s_nop 0
  buffer_load_dwordx4 v176, s[4:7], s36 offen offset:0 lds
  v_exp_f32 v0, v0
  v_exp_f32 v1, v1
  s_nop 0
  v_cvt_pk_bf16_f32 v0, v0, v1
  v_exp_f32 v2, v2
  v_exp_f32 v3, v3
  s_nop 0
  v_cvt_pk_bf16_f32 v1, v2, v3
  v_exp_f32 v4, v4
  v_exp_f32 v5, v5
  s_nop 0
  v_cvt_pk_bf16_f32 v2, v4, v5
  v_exp_f32 v6, v6
  v_exp_f32 v7, v7
  s_nop 0
  v_cvt_pk_bf16_f32 v3, v6, v7
  v_exp_f32 v8, v8
  v_exp_f32 v9, v9
  s_nop 0
  v_cvt_pk_bf16_f32 v8, v8, v9
  v_exp_f32 v10, v10
  v_exp_f32 v11, v11
  s_nop 0
  v_cvt_pk_bf16_f32 v9, v10, v11
  v_exp_f32 v12, v12
  v_exp_f32 v13, v13
  s_nop 0
  v_cvt_pk_bf16_f32 v10, v12, v13
  v_exp_f32 v14, v14
  v_exp_f32 v15, v15
  s_nop 0
  v_cvt_pk_bf16_f32 v11, v14, v15
  v_exp_f32 v16, v16
  v_exp_f32 v17, v17
  s_nop 0
  v_cvt_pk_bf16_f32 v16, v16, v17
  v_exp_f32 v18, v18
  v_exp_f32 v19, v19
  s_nop 0
  v_cvt_pk_bf16_f32 v17, v18, v19
  s_mov_b32 s38, 7
.p2align 6
L_loop:
  s_waitcnt lgkmcnt(1)
  v_mfma_f32_16x16x32_bf16 v[64:67], a[192:195], a[128:131], v[128:131]
  v_exp_f32 v20, v20
  v_mfma_f32_16x16x32_bf16 v[64:67], a[196:199], a[132:135], v[64:67]
  ds_read_b128 a[212:215], v161 offset:53248
  v_mfma_f32_16x16x32_bf16 v[64:67], a[200:203], a[136:139], v[64:67]
  v_exp_f32 v21, v21
  v_mfma_f32_16x16x32_bf16 v[64:67], a[204:207], a[140:143], v[64:67]
  v_cvt_pk_bf16_f32 v18, v20, v21
  v_mfma_f32_16x16x32_bf16 v[72:75], a[192:195], a[144:147], v[132:135]
  v_exp_f32 v22, v22
  v_mfma_f32_16x16x32_bf16 v[72:75], a[196:199], a[148:151], v[72:75]
  ds_read_b128 a[216:219], v162 offset:53248
  buffer_load_dwordx4 v177, s[4:7], s36 offen offset:1024 lds
  v_mfma_f32_16x16x32_bf16 v[72:75], a[200:203], a[152:155], v[72:75]
  v_exp_f32 v23, v23
  v_mfma_f32_16x16x32_bf16 v[72:75], a[204:207], a[156:159], v[72:75]
  v_cvt_pk_bf16_f32 v19, v22, v23
  v_mfma_f32_16x16x32_bf16 v[80:83], a[192:195], a[160:163], v[136:139]
  v_exp_f32 v24, v24
  v_mfma_f32_16x16x32_bf16 v[80:83], a[196:199], a[164:167], v[80:83]
  ds_read_b128 a[220:223], v163 offset:53248
  v_mfma_f32_16x16x32_bf16 v[80:83], a[200:203], a[168:171], v[80:83]
  v_exp_f32 v25, v25
  v_mfma_f32_16x16x32_bf16 v[80:83], a[204:207], a[172:175], v[80:83]
  v_cvt_pk_bf16_f32 v24, v24, v25
  v_mfma_f32_16x16x32_bf16 v[88:91], a[192:195], a[176:179], v[140:143]
  v_exp_f32 v26, v26
  v_mfma_f32_16x16x32_bf16 v[88:91], a[196:199], a[180:183], v[88:91]
  ds_read_b128 a[192:195], v160 offset:57344
  buffer_load_dwordx4 v178, s[4:7], s36 offen offset:2048 lds
  v_mfma_f32_16x16x32_bf16 v[88:91], a[200:203], a[184:187], v[88:91]
  v_exp_f32 v27, v27
  v_mfma_f32_16x16x32_bf16 v[88:91], a[204:207], a[188:191], v[88:91]
  v_cvt_pk_bf16_f32 v25, v26, v27
  s_waitcnt lgkmcnt(1)
  v_mfma_f32_16x16x32_bf16 v[68:71], a[208:211], a[128:131], v[128:131]
  v_exp_f32 v28, v28
  v_mfma_f32_16x16x32_bf16 v[68:71], a[212:215], a[132:135], v[68:71]
  ds_read_b128 a[196:199], v161 offset:57344
  v_mfma_f32_16x16x32_bf16 v[68:71], a[216:219], a[136:139], v[68:71]
  v_exp_f32 v29, v29
  v_mfma_f32_16x16x32_bf16 v[68:71], a[220:223], a[140:143], v[68:71]
  v_cvt_pk_bf16_f32 v26, v28, v29
  v_mfma_f32_16x16x32_bf16 v[76:79], a[208:211], a[144:147], v[132:135]
  v_exp_f32 v30, v30
  v_mfma_f32_16x16x32_bf16 v[76:79], a[212:215], a[148:151], v[76:79]
  ds_read_b128 a[200:203], v162 offset:57344
  buffer_load_dwordx4 v179, s[4:7], s36 offen offset:3072 lds
  v_mfma_f32_16x16x32_bf16 v[76:79], a[216:219], a[152:155], v[76:79]
  v_exp_f32 v31, v31
  v_mfma_f32_16x16x32_bf16 v[76:79], a[220:223], a[156:159], v[76:79]
  v_cvt_pk_bf16_f32 v27, v30, v31
  s_add_u32 s36, s36, 16384
  v_mfma_f32_16x16x32_bf16 v[84:87], a[208:211], a[160:163], v[136:139]
  v_exp_f32 v32, v32
  v_mfma_f32_16x16x32_bf16 v[84:87], a[212:215], a[164:167], v[84:87]
  ds_read_b128 a[204:207], v163 offset:57344
  v_mfma_f32_16x16x32_bf16 v[84:87], a[216:219], a[168:171], v[84:87]
  v_exp_f32 v33, v33
  v_mfma_f32_16x16x32_bf16 v[84:87], a[220:223], a[172:175], v[84:87]
  v_cvt_pk_bf16_f32 v32, v32, v33
  v_mfma_f32_16x16x32_bf16 v[92:95], a[208:211], a[176:179], v[140:143]
  v_exp_f32 v34, v34
  v_mfma_f32_16x16x32_bf16 v[92:95], a[212:215], a[180:183], v[92:95]
  ds_read_b128 a[208:211], v160 offset:61440
  v_mfma_f32_16x16x32_bf16 v[92:95], a[216:219], a[184:187], v[92:95]
  v_exp_f32 v35, v35
  v_mfma_f32_16x16x32_bf16 v[92:95], a[220:223], a[188:191], v[92:95]
  v_cvt_pk_bf16_f32 v33, v34, v35
  s_waitcnt lgkmcnt(1)
  v_mfma_f32_16x16x32_bf16 v[96:99], a[192:195], a[128:131], v[128:131]
  v_exp_f32 v36, v36
  v_mfma_f32_16x16x32_bf16 v[96:99], a[196:199], a[132:135], v[96:99]
  ds_read_b128 a[212:215], v161 offset:61440
  v_mfma_f32_16x16x32_bf16 v[96:99], a[200:203], a[136:139], v[96:99]
  v_exp_f32 v37, v37
  v_mfma_f32_16x16x32_bf16 v[96:99], a[204:207], a[140:143], v[96:99]
  v_cvt_pk_bf16_f32 v34, v36, v37
  v_mfma_f32_16x16x32_bf16 v[104:107], a[192:195], a[144:147], v[132:135]
  v_exp_f32 v38, v38
  v_mfma_f32_16x16x32_bf16 v[104:107], a[196:199], a[148:151], v[104:107]
  ds_read_b128 a[216:219], v162 offset:61440
  v_mfma_f32_16x16x32_bf16 v[104:107], a[200:203], a[152:155], v[104:107]
  v_exp_f32 v39, v39
  v_mfma_f32_16x16x32_bf16 v[104:107], a[204:207], a[156:159], v[104:107]
  v_cvt_pk_bf16_f32 v35, v38, v39
  v_mfma_f32_16x16x32_bf16 v[112:115], a[192:195], a[160:163], v[136:139]
  v_exp_f32 v40, v40
  v_mfma_f32_16x16x32_bf16 v[112:115], a[196:199], a[164:167], v[112:115]
  ds_read_b128 a[220:223], v163 offset:61440
  v_mfma_f32_16x16x32_bf16 v[112:115], a[200:203], a[168:171], v[112:115]
  v_exp_f32 v41, v41
  v_mfma_f32_16x16x32_bf16 v[112:115], a[204:207], a[172:175], v[112:115]
  v_cvt_pk_bf16_f32 v40, v40, v41
  v_mfma_f32_16x16x32_bf16 v[120:123], a[192:195], a[176:179], v[140:143]
  v_exp_f32 v42, v42
  v_mfma_f32_16x16x32_bf16 v[120:123], a[196:199], a[180:183], v[120:123]
  v_mfma_f32_16x16x32_bf16 v[120:123], a[200:203], a[184:187], v[120:123]
  v_exp_f32 v43, v43
  v_mfma_f32_16x16x32_bf16 v[120:123], a[204:207], a[188:191], v[120:123]
  v_cvt_pk_bf16_f32 v41, v42, v43
  s_waitcnt lgkmcnt(0)
  v_mfma_f32_16x16x32_bf16 v[100:103], a[208:211], a[128:131], v[128:131]
  v_exp_f32 v44, v44
  v_mfma_f32_16x16x32_bf16 v[100:103], a[212:215], a[132:135], v[100:103]
  ds_read_b64_tr_b16 a[224:225], v168 offset:0
  ds_read_b64_tr_b16 a[226:227], v168 offset:4096
  v_mfma_f32_16x16x32_bf16 v[100:103], a[216:219], a[136:139], v[100:103]
  v_exp_f32 v45, v45
  v_mfma_f32_16x16x32_bf16 v[100:103], a[220:223], a[140:143], v[100:103]
  v_cvt_pk_bf16_f32 v42, v44, v45
  v_mfma_f32_16x16x32_bf16 v[108:111], a[208:211], a[144:147], v[132:135]
  v_exp_f32 v46, v46
  v_mfma_f32_16x16x32_bf16 v[108:111], a[212:215], a[148:151], v[108:111]
  ds_read_b64_tr_b16 a[228:229], v169 offset:0
  ds_read_b64_tr_b16 a[230:231], v169 offset:4096
  v_mfma_f32_16x16x32_bf16 v[108:111], a[216:219], a[152:155], v[108:111]
  v_exp_f32 v47, v47
  v_mfma_f32_16x16x32_bf16 v[108:111], a[220:223], a[156:159], v[108:111]
  v_cvt_pk_bf16_f32 v43, v46, v47
  v_mfma_f32_16x16x32_bf16 v[116:119], a[208:211], a[160:163], v[136:139]
  v_exp_f32 v48, v48
  v_mfma_f32_16x16x32_bf16 v[116:119], a[212:215], a[164:167], v[116:119]
  ds_read_b64_tr_b16 a[232:233], v170 offset:0
  ds_read_b64_tr_b16 a[234:235], v170 offset:4096
  v_mfma_f32_16x16x32_bf16 v[116:119], a[216:219], a[168:171], v[116:119]
  v_exp_f32 v49, v49
  v_mfma_f32_16x16x32_bf16 v[116:119], a[220:223], a[172:175], v[116:119]
  v_cvt_pk_bf16_f32 v48, v48, v49
  v_mfma_f32_16x16x32_bf16 v[124:127], a[208:211], a[176:179], v[140:143]
  v_exp_f32 v50, v50
  v_mfma_f32_16x16x32_bf16 v[124:127], a[212:215], a[180:183], v[124:127]
  ds_read_b64_tr_b16 a[236:237], v171 offset:0
  ds_read_b64_tr_b16 a[238:239], v171 offset:4096
  v_mfma_f32_16x16x32_bf16 v[124:127], a[216:219], a[184:187], v[124:127]
  v_exp_f32 v51, v51
  v_mfma_f32_16x16x32_bf16 v[124:127], a[220:223], a[188:191], v[124:127]
  v_cvt_pk_bf16_f32 v49, v50, v51
  s_waitcnt lgkmcnt(4)
  v_mfma_f32_16x16x32_bf16 a[0:3], a[224:227], v[0:3], a[0:3]
  v_exp_f32 v52, v52
  v_mfma_f32_16x16x32_bf16 a[32:35], a[224:227], v[8:11], a[32:35]
  ds_read_b64_tr_b16 a[240:241], v172 offset:0
  ds_read_b64_tr_b16 a[242:243], v172 offset:4096
  v_mfma_f32_16x16x32_bf16 a[64:67], a[224:227], v[16:19], a[64:67]
  v_exp_f32 v53, v53
  v_mfma_f32_16x16x32_bf16 a[96:99], a[224:227], v[24:27], a[96:99]
  v_cvt_pk_bf16_f32 v50, v52, v53
  v_mfma_f32_16x16x32_bf16 a[4:7], a[228:231], v[0:3], a[4:7]
  v_exp_f32 v54, v54
  v_mfma_f32_16x16x32_bf16 a[36:39], a[228:231], v[8:11], a[36:39]
  ds_read_b64_tr_b16 a[244:245], v173 offset:0
  ds_read_b64_tr_b16 a[246:247], v173 offset:4096
  v_mfma_f32_16x16x32_bf16 a[68:71], a[228:231], v[16:19], a[68:71]
  v_exp_f32 v55, v55
  v_mfma_f32_16x16x32_bf16 a[100:103], a[228:231], v[24:27], a[100:103]
  v_cvt_pk_bf16_f32 v51, v54, v55
  s_waitcnt lgkmcnt(4)
  v_mfma_f32_16x16x32_bf16 a[8:11], a[232:235], v[0:3], a[8:11]
  v_exp_f32 v56, v56
  v_mfma_f32_16x16x32_bf16 a[40:43], a[232:235], v[8:11], a[40:43]
  ds_read_b64_tr_b16 a[248:249], v174 offset:0
  ds_read_b64_tr_b16 a[250:251], v174 offset:4096
  v_mfma_f32_16x16x32_bf16 a[72:75], a[232:235], v[16:19], a[72:75]
  v_exp_f32 v57, v57
  v_mfma_f32_16x16x32_bf16 a[104:107], a[232:235], v[24:27], a[104:107]
  v_cvt_pk_bf16_f32 v56, v56, v57
  v_mfma_f32_16x16x32_bf16 a[12:15], a[236:239], v[0:3], a[12:15]
  v_exp_f32 v58, v58
  v_mfma_f32_16x16x32_bf16 a[44:47], a[236:239], v[8:11], a[44:47]
  ds_read_b64_tr_b16 a[252:253], v175 offset:0
  ds_read_b64_tr_b16 a[254:255], v175 offset:4096
  v_mfma_f32_16x16x32_bf16 a[76:79], a[236:239], v[16:19], a[76:79]
  v_exp_f32 v59, v59
  v_mfma_f32_16x16x32_bf16 a[108:111], a[236:239], v[24:27], a[108:111]
  v_cvt_pk_bf16_f32 v57, v58, v59
  s_waitcnt lgkmcnt(4)
  v_mfma_f32_16x16x32_bf16 a[16:19], a[240:243], v[0:3], a[16:19]
  v_exp_f32 v60, v60
  v_mfma_f32_16x16x32_bf16 a[48:51], a[240:243], v[8:11], a[48:51]
  v_mfma_f32_16x16x32_bf16 a[80:83], a[240:243], v[16:19], a[80:83]
  v_exp_f32 v61, v61
  v_mfma_f32_16x16x32_bf16 a[112:115], a[240:243], v[24:27], a[112:115]
  v_cvt_pk_bf16_f32 v58, v60, v61
  v_mfma_f32_16x16x32_bf16 a[20:23], a[244:247], v[0:3], a[20:23]
  v_exp_f32 v62, v62
  v_mfma_f32_16x16x32_bf16 a[52:55], a[244:247], v[8:11], a[52:55]
  ds_read_b64_tr_b16 a[224:225], v168 offset:8192
  ds_read_b64_tr_b16 a[226:227], v168 offset:12288
  v_mfma_f32_16x16x32_bf16 a[84:87], a[244:247], v[16:19], a[84:87]
  v_exp_f32 v63, v63
  v_mfma_f32_16x16x32_bf16 a[116:119], a[244:247], v[24:27], a[116:119]
  v_cvt_pk_bf16_f32 v59, v62, v63
  s_waitcnt lgkmcnt(2)
  v_mfma_f32_16x16x32_bf16 a[24:27], a[248:251], v[0:3], a[24:27]
  v_mfma_f32_16x16x32_bf16 a[56:59], a[248:251], v[8:11], a[56:59]
  ds_read_b64_tr_b16 a[228:229], v169 offset:8192
  ds_read_b64_tr_b16 a[230:231], v169 offset:12288
  v_mfma_f32_16x16x32_bf16 a[88:91], a[248:251], v[16:19], a[88:91]
  v_mfma_f32_16x16x32_bf16 a[120:123], a[248:251], v[24:27], a[120:123]
  v_mfma_f32_16x16x32_bf16 a[28:31], a[252:255], v[0:3], a[28:31]
  s_waitcnt vmcnt(12)
  s_barrier
  v_mfma_f32_16x16x32_bf16 a[60:63], a[252:255], v[8:11], a[60:63]
  ds_read_b64_tr_b16 a[232:233], v170 offset:8192
  ds_read_b64_tr_b16 a[234:235], v170 offset:12288
  v_mfma_f32_16x16x32_bf16 a[92:95], a[252:255], v[16:19], a[92:95]
  s_add_u32 m0, s35, 65536
  v_mfma_f32_16x16x32_bf16 a[124:127], a[252:255], v[24:27], a[124:127]
  s_waitcnt lgkmcnt(4)
  v_mfma_f32_16x16x32_bf16 v[144:147], v[164:167], v[0:3], v[144:147]
  v_exp_f32 v64, v64
  v_mfma_f32_16x16x32_bf16 v[148:151], v[164:167], v[8:11], v[148:151]
  ds_read_b64_tr_b16 a[236:237], v171 offset:8192
  ds_read_b64_tr_b16 a[238:239], v171 offset:12288
  v_mfma_f32_16x16x32_bf16 v[152:155], v[164:167], v[16:19], v[152:155]
  v_exp_f32 v65, v65
  v_mfma_f32_16x16x32_bf16 v[156:159], v[164:167], v[24:27], v[156:159]
  v_cvt_pk_bf16_f32 v64, v64, v65
  v_mfma_f32_16x16x32_bf16 a[0:3], a[224:227], v[32:35], a[0:3]
  v_exp_f32 v66, v66
  v_mfma_f32_16x16x32_bf16 a[32:35], a[224:227], v[40:43], a[32:35]
  ds_read_b64_tr_b16 a[240:241], v172 offset:8192
  ds_read_b64_tr_b16 a[242:243], v172 offset:12288
  buffer_load_dwordx4 v180, s[8:11], s37 offen offset:0 lds
  v_mfma_f32_16x16x32_bf16 a[64:67], a[224:227], v[48:51], a[64:67]
  v_exp_f32 v67, v67
  v_mfma_f32_16x16x32_bf16 a[96:99], a[224:227], v[56:59], a[96:99]
  v_cvt_pk_bf16_f32 v65, v66, v67
  s_waitcnt lgkmcnt(4)
  v_mfma_f32_16x16x32_bf16 a[4:7], a[228:231], v[32:35], a[4:7]
  v_exp_f32 v68, v68
  v_mfma_f32_16x16x32_bf16 a[36:39], a[228:231], v[40:43], a[36:39]
  ds_read_b64_tr_b16 a[244:245], v173 offset:8192
  ds_read_b64_tr_b16 a[246:247], v173 offset:12288
  v_mfma_f32_16x16x32_bf16 a[68:71], a[228:231], v[48:51], a[68:71]
  v_exp_f32 v69, v69
  v_mfma_f32_16x16x32_bf16 a[100:103], a[228:231], v[56:59], a[100:103]
  v_cvt_pk_bf16_f32 v66, v68, v69
  v_mfma_f32_16x16x32_bf16 a[8:11], a[232:235], v[32:35], a[8:11]
  v_exp_f32 v70, v70
  v_mfma_f32_16x16x32_bf16 a[40:43], a[232:235], v[40:43], a[40:43]
  ds_read_b64_tr_b16 a[248:249], v174 offset:8192
  ds_read_b64_tr_b16 a[250:251], v174 offset:12288
  buffer_load_dwordx4 v181, s[8:11], s37 offen offset:1024 lds
  v_mfma_f32_16x16x32_bf16 a[72:75], a[232:235], v[48:51], a[72:75]
  v_exp_f32 v71, v71
  v_mfma_f32_16x16x32_bf16 a[104:107], a[232:235], v[56:59], a[104:107]
  v_cvt_pk_bf16_f32 v67, v70, v71
  s_waitcnt lgkmcnt(4)
  v_mfma_f32_16x16x32_bf16 a[12:15], a[236:239], v[32:35], a[12:15]
  v_exp_f32 v72, v72
  v_mfma_f32_16x16x32_bf16 a[44:47], a[236:239], v[40:43], a[44:47]
  ds_read_b64_tr_b16 a[252:253], v175 offset:8192
  ds_read_b64_tr_b16 a[254:255], v175 offset:12288
  v_mfma_f32_16x16x32_bf16 a[76:79], a[236:239], v[48:51], a[76:79]
  v_exp_f32 v73, v73
  v_mfma_f32_16x16x32_bf16 a[108:111], a[236:239], v[56:59], a[108:111]
  v_cvt_pk_bf16_f32 v72, v72, v73
  v_mfma_f32_16x16x32_bf16 a[16:19], a[240:243], v[32:35], a[16:19]
  v_exp_f32 v74, v74
  v_mfma_f32_16x16x32_bf16 a[48:51], a[240:243], v[40:43], a[48:51]
  ds_read_b128 a[192:195], v160 offset:0
  buffer_load_dwordx4 v180, s[8:11], s37 offen offset:2048 lds
  v_mfma_f32_16x16x32_bf16 a[80:83], a[240:243], v[48:51], a[80:83]
  v_exp_f32 v75, v75
  v_mfma_f32_16x16x32_bf16 a[112:115], a[240:243], v[56:59], a[112:115]
  v_cvt_pk_bf16_f32 v73, v74, v75
  s_waitcnt lgkmcnt(3)
  v_mfma_f32_16x16x32_bf16 a[20:23], a[244:247], v[32:35], a[20:23]
  v_exp_f32 v76, v76
  v_mfma_f32_16x16x32_bf16 a[52:55], a[244:247], v[40:43], a[52:55]
  ds_read_b128 a[196:199], v161 offset:0
  v_mfma_f32_16x16x32_bf16 a[84:87], a[244:247], v[48:51], a[84:87]
  v_exp_f32 v77, v77
  v_mfma_f32_16x16x32_bf16 a[116:119], a[244:247], v[56:59], a[116:119]
  v_cvt_pk_bf16_f32 v74, v76, v77
  v_mfma_f32_16x16x32_bf16 a[24:27], a[248:251], v[32:35], a[24:27]
  v_exp_f32 v78, v78
  v_mfma_f32_16x16x32_bf16 a[56:59], a[248:251], v[40:43], a[56:59]
  ds_read_b128 a[200:203], v162 offset:0
  buffer_load_dwordx4 v181, s[8:11], s37 offen offset:3072 lds
  v_mfma_f32_16x16x32_bf16 a[88:91], a[248:251], v[48:51], a[88:91]
  v_exp_f32 v79, v79
  v_mfma_f32_16x16x32_bf16 a[120:123], a[248:251], v[56:59], a[120:123]
  v_cvt_pk_bf16_f32 v75, v78, v79
  s_add_u32 s37, s37, 16384
  s_waitcnt lgkmcnt(3)
  v_mfma_f32_16x16x32_bf16 a[28:31], a[252:255], v[32:35], a[28:31]
  v_exp_f32 v80, v80
  v_mfma_f32_16x16x32_bf16 a[60:63], a[252:255], v[40:43], a[60:63]
  ds_read_b128 a[204:207], v163 offset:0
  v_mfma_f32_16x16x32_bf16 a[92:95], a[252:255], v[48:51], a[92:95]
  v_exp_f32 v81, v81
  v_mfma_f32_16x16x32_bf16 a[124:127], a[252:255], v[56:59], a[124:127]
  v_cvt_pk_bf16_f32 v80, v80, v81
  s_mov_b32 m0, s35
  v_mfma_f32_16x16x32_bf16 v[144:147], v[164:167], v[32:35], v[144:147]
  v_exp_f32 v82, v82
  v_mfma_f32_16x16x32_bf16 v[148:151], v[164:167], v[40:43], v[148:151]
  ds_read_b128 a[208:211], v160 offset:4096
  buffer_load_dwordx4 v176, s[4:7], s36 offen offset:0 lds
  v_mfma_f32_16x16x32_bf16 v[152:155], v[164:167], v[48:51], v[152:155]
  v_exp_f32 v83, v83
  v_mfma_f32_16x16x32_bf16 v[156:159], v[164:167], v[56:59], v[156:159]
  v_cvt_pk_bf16_f32 v81, v82, v83
  s_waitcnt lgkmcnt(1)
  v_mfma_f32_16x16x32_bf16 v[0:3], a[192:195], a[128:131], v[128:131]
  v_exp_f32 v84, v84
  v_mfma_f32_16x16x32_bf16 v[0:3], a[196:199], a[132:135], v[0:3]
  ds_read_b128 a[212:215], v161 offset:4096
  v_mfma_f32_16x16x32_bf16 v[0:3], a[200:203], a[136:139], v[0:3]
  v_exp_f32 v85, v85
  v_mfma_f32_16x16x32_bf16 v[0:3], a[204:207], a[140:143], v[0:3]
  v_cvt_pk_bf16_f32 v82, v84, v85
  v_mfma_f32_16x16x32_bf16 v[8:11], a[192:195], a[144:147], v[132:135]
  v_exp_f32 v86, v86
  v_mfma_f32_16x16x32_bf16 v[8:11], a[196:199], a[148:151], v[8:11]
  ds_read_b128 a[216:219], v162 offset:4096
  buffer_load_dwordx4 v177, s[4:7], s36 offen offset:1024 lds
  v_mfma_f32_16x16x32_bf16 v[8:11], a[200:203], a[152:155], v[8:11]
  v_exp_f32 v87, v87
  v_mfma_f32_16x16x32_bf16 v[8:11], a[204:207], a[156:159], v[8:11]
  v_cvt_pk_bf16_f32 v83, v86, v87
  v_mfma_f32_16x16x32_bf16 v[16:19], a[192:195], a[160:163], v[136:139]
  v_exp_f32 v88, v88
  v_mfma_f32_16x16x32_bf16 v[16:19], a[196:199], a[164:167], v[16:19]
  ds_read_b128 a[220:223], v163 offset:4096
  v_mfma_f32_16x16x32_bf16 v[16:19], a[200:203], a[168:171], v[16:19]
  v_exp_f32 v89, v89
  v_mfma_f32_16x16x32_bf16 v[16:19], a[204:207], a[172:175], v[16:19]
  v_cvt_pk_bf16_f32 v88, v88, v89
  v_mfma_f32_16x16x32_bf16 v[24:27], a[192:195], a[176:179], v[140:143]
  v_exp_f32 v90, v90
  v_mfma_f32_16x16x32_bf16 v[24:27], a[196:199], a[180:183], v[24:27]
  ds_read_b128 a[192:195], v160 offset:8192
  buffer_load_dwordx4 v178, s[4:7], s36 offen offset:2048 lds
  v_mfma_f32_16x16x32_bf16 v[24:27], a[200:203], a[184:187], v[24:27]
  v_exp_f32 v91, v91
  v_mfma_f32_16x16x32_bf16 v[24:27], a[204:207], a[188:191], v[24:27]
  v_cvt_pk_bf16_f32 v89, v90, v91
  s_waitcnt lgkmcnt(1)
  v_mfma_f32_16x16x32_bf16 v[4:7], a[208:211], a[128:131], v[128:131]
  v_exp_f32 v92, v92
  v_mfma_f32_16x16x32_bf16 v[4:7], a[212:215], a[132:135], v[4:7]
  ds_read_b128 a[196:199], v161 offset:8192
  v_mfma_f32_16x16x32_bf16 v[4:7], a[216:219], a[136:139], v[4:7]
  v_exp_f32 v93, v93
  v_mfma_f32_16x16x32_bf16 v[4:7], a[220:223], a[140:143], v[4:7]
  v_cvt_pk_bf16_f32 v90, v92, v93
  v_mfma_f32_16x16x32_bf16 v[12:15], a[208:211], a[144:147], v[132:135]
  v_exp_f32 v94, v94
  v_mfma_f32_16x16x32_bf16 v[12:15], a[212:215], a[148:151], v[12:15]
  ds_read_b128 a[200:203], v162 offset:8192
  buffer_load_dwordx4 v179, s[4:7], s36 offen offset:3072 lds
  v_mfma_f32_16x16x32_bf16 v[12:15], a[216:219], a[152:155], v[12:15]
  v_exp_f32 v95, v95
  v_mfma_f32_16x16x32_bf16 v[12:15], a[220:223], a[156:159], v[12:15]
  v_cvt_pk_bf16_f32 v91, v94, v95
  s_add_u32 s36, s36, 16384
  v_mfma_f32_16x16x32_bf16 v[20:23], a[208:211], a[160:163], v[136:139]
  v_exp_f32 v96, v96
  v_mfma_f32_16x16x32_bf16 v[20:23], a[212:215], a[164:167], v[20:23]
  ds_read_b128 a[204:207], v163 offset:8192
  v_mfma_f32_16x16x32_bf16 v[20:23], a[216:219], a[168:171], v[20:23]
  v_exp_f32 v97, v97
  v_mfma_f32_16x16x32_bf16 v[20:23], a[220:223], a[172:175], v[20:23]
  v_cvt_pk_bf16_f32 v96, v96, v97
  v_mfma_f32_16x16x32_bf16 v[28:31], a[208:211], a[176:179], v[140:143]
  v_exp_f32 v98, v98
  v_mfma_f32_16x16x32_bf16 v[28:31], a[212:215], a[180:183], v[28:31]
  ds_read_b128 a[208:211], v160 offset:12288
  v_mfma_f32_16x16x32_bf16 v[28:31], a[216:219], a[184:187], v[28:31]
  v_exp_f32 v99, v99
  v_mfma_f32_16x16x32_bf16 v[28:31], a[220:223], a[188:191], v[28:31]
  v_cvt_pk_bf16_f32 v97, v98, v99
  s_waitcnt lgkmcnt(1)
  v_mfma_f32_16x16x32_bf16 v[32:35], a[192:195], a[128:131], v[128:131]
  v_exp_f32 v100, v100
  v_mfma_f32_16x16x32_bf16 v[32:35], a[196:199], a[132:135], v[32:35]
  ds_read_b128 a[212:215], v161 offset:12288
  v_mfma_f32_16x16x32_bf16 v[32:35], a[200:203], a[136:139], v[32:35]
  v_exp_f32 v101, v101
  v_mfma_f32_16x16x32_bf16 v[32:35], a[204:207], a[140:143], v[32:35]
  v_cvt_pk_bf16_f32 v98, v100, v101
  v_mfma_f32_16x16x32_bf16 v[40:43], a[192:195], a[144:147], v[132:135]
  v_exp_f32 v102, v102
  v_mfma_f32_16x16x32_bf16 v[40:43], a[196:199], a[148:151], v[40:43]
  ds_read_b128 a[216:219], v162 offset:12288
  v_mfma_f32_16x16x32_bf16 v[40:43], a[200:203], a[152:155], v[40:43]
  v_exp_f32 v103, v103
  v_mfma_f32_16x16x32_bf16 v[40:43], a[204:207], a[156:159], v[40:43]
  v_cvt_pk_bf16_f32 v99, v102, v103
  v_mfma_f32_16x16x32_bf16 v[48:51], a[192:195], a[160:163], v[136:139]
  v_exp_f32 v104, v104
  v_mfma_f32_16x16x32_bf16 v[48:51], a[196:199], a[164:167], v[48:51]
  ds_read_b128 a[220:223], v163 offset:12288
  v_mfma_f32_16x16x32_bf16 v[48:51], a[200:203], a[168:171], v[48:51]
  v_exp_f32 v105, v105
  v_mfma_f32_16x16x32_bf16 v[48:51], a[204:207], a[172:175], v[48:51]
  v_cvt_pk_bf16_f32 v104, v104, v105
  v_mfma_f32_16x16x32_bf16 v[56:59], a[192:195], a[176:179], v[140:143]
  v_exp_f32 v106, v106
  v_mfma_f32_16x16x32_bf16 v[56:59], a[196:199], a[180:183], v[56:59]
  v_mfma_f32_16x16x32_bf16 v[56:59], a[200:203], a[184:187], v[56:59]
  v_exp_f32 v107, v107
  v_mfma_f32_16x16x32_bf16 v[56:59], a[204:207], a[188:191], v[56:59]
  v_cvt_pk_bf16_f32 v105, v106, v107
  s_waitcnt lgkmcnt(0)
  v_mfma_f32_16x16x32_bf16 v[36:39], a[208:211], a[128:131], v[128:131]
  v_exp_f32 v108, v108
  v_mfma_f32_16x16x32_bf16 v[36:39], a[212:215], a[132:135], v[36:39]
  ds_read_b64_tr_b16 a[224:225], v168 offset:16384
  ds_read_b64_tr_b16 a[226:227], v168 offset:20480
  v_mfma_f32_16x16x32_bf16 v[36:39], a[216:219], a[136:139], v[36:39]
  v_exp_f32 v109, v109
  v_mfma_f32_16x16x32_bf16 v[36:39], a[220:223], a[140:143], v[36:39]
  v_cvt_pk_bf16_f32 v106, v108, v109
  v_mfma_f32_16x16x32_bf16 v[44:47], a[208:211], a[144:147], v[132:135]
  v_exp_f32 v110, v110
  v_mfma_f32_16x16x32_bf16 v[44:47], a[212:215], a[148:151], v[44:47]
  ds_read_b64_tr_b16 a[228:229], v169 offset:16384
  ds_read_b64_tr_b16 a[230:231], v169 offset:20480
  v_mfma_f32_16x16x32_bf16 v[44:47], a[216:219], a[152:155], v[44:47]
  v_exp_f32 v111, v111
  v_mfma_f32_16x16x32_bf16 v[44:47], a[220:223], a[156:159], v[44:47]
  v_cvt_pk_bf16_f32 v107, v110, v111
  v_mfma_f32_16x16x32_bf16 v[52:55], a[208:211], a[160:163], v[136:139]
  v_exp_f32 v112, v112
  v_mfma_f32_16x16x32_bf16 v[52:55], a[212:215], a[164:167], v[52:55]
  ds_read_b64_tr_b16 a[232:233], v170 offset:16384
  ds_read_b64_tr_b16 a[234:235], v170 offset:20480
  v_mfma_f32_16x16x32_bf16 v[52:55], a[216:219], a[168:171], v[52:55]
  v_exp_f32 v113, v113
  v_mfma_f32_16x16x32_bf16 v[52:55], a[220:223], a[172:175], v[52:55]
  v_cvt_pk_bf16_f32 v112, v112, v113
  v_mfma_f32_16x16x32_bf16 v[60:63], a[208:211], a[176:179], v[140:143]
  v_exp_f32 v114, v114
  v_mfma_f32_16x16x32_bf16 v[60:63], a[212:215], a[180:183], v[60:63]
  ds_read_b64_tr_b16 a[236:237], v171 offset:16384
  ds_read_b64_tr_b16 a[238:239], v171 offset:20480
  v_mfma_f32_16x16x32_bf16 v[60:63], a[216:219], a[184:187], v[60:63]
  v_exp_f32 v115, v115
  v_mfma_f32_16x16x32_bf16 v[60:63], a[220:223], a[188:191], v[60:63]
  v_cvt_pk_bf16_f32 v113, v114, v115
  s_waitcnt lgkmcnt(4)
  v_mfma_f32_16x16x32_bf16 a[0:3], a[224:227], v[64:67], a[0:3]
  v_exp_f32 v116, v116
  v_mfma_f32_16x16x32_bf16 a[32:35], a[224:227], v[72:75], a[32:35]
  ds_read_b64_tr_b16 a[240:241], v172 offset:16384
  ds_read_b64_tr_b16 a[242:243], v172 offset:20480
  v_mfma_f32_16x16x32_bf16 a[64:67], a[224:227], v[80:83], a[64:67]
  v_exp_f32 v117, v117
  v_mfma_f32_16x16x32_bf16 a[96:99], a[224:227], v[88:91], a[96:99]
  v_cvt_pk_bf16_f32 v114, v116, v117
  v_mfma_f32_16x16x32_bf16 a[4:7], a[228:231], v[64:67], a[4:7]
  v_exp_f32 v118, v118
  v_mfma_f32_16x16x32_bf16 a[36:39], a[228:231], v[72:75], a[36:39]
  ds_read_b64_tr_b16 a[244:245], v173 offset:16384
  ds_read_b64_tr_b16 a[246:247], v173 offset:20480
  v_mfma_f32_16x16x32_bf16 a[68:71], a[228:231], v[80:83], a[68:71]
  v_exp_f32 v119, v119
  v_mfma_f32_16x16x32_bf16 a[100:103], a[228:231], v[88:91], a[100:103]
  v_cvt_pk_bf16_f32 v115, v118, v119
  s_waitcnt lgkmcnt(4)
  v_mfma_f32_16x16x32_bf16 a[8:11], a[232:235], v[64:67], a[8:11]
  v_exp_f32 v120, v120
  v_mfma_f32_16x16x32_bf16 a[40:43], a[232:235], v[72:75], a[40:43]
  ds_read_b64_tr_b16 a[248:249], v174 offset:16384
  ds_read_b64_tr_b16 a[250:251], v174 offset:20480
  v_mfma_f32_16x16x32_bf16 a[72:75], a[232:235], v[80:83], a[72:75]
  v_exp_f32 v121, v121
  v_mfma_f32_16x16x32_bf16 a[104:107], a[232:235], v[88:91], a[104:107]
  v_cvt_pk_bf16_f32 v120, v120, v121
  v_mfma_f32_16x16x32_bf16 a[12:15], a[236:239], v[64:67], a[12:15]
  v_exp_f32 v122, v122
  v_mfma_f32_16x16x32_bf16 a[44:47], a[236:239], v[72:75], a[44:47]
  ds_read_b64_tr_b16 a[252:253], v175 offset:16384
  ds_read_b64_tr_b16 a[254:255], v175 offset:20480
  v_mfma_f32_16x16x32_bf16 a[76:79], a[236:239], v[80:83], a[76:79]
  v_exp_f32 v123, v123
  v_mfma_f32_16x16x32_bf16 a[108:111], a[236:239], v[88:91], a[108:111]
  v_cvt_pk_bf16_f32 v121, v122, v123
  s_waitcnt lgkmcnt(4)
  v_mfma_f32_16x16x32_bf16 a[16:19], a[240:243], v[64:67], a[16:19]
  v_exp_f32 v124, v124
  v_mfma_f32_16x16x32_bf16 a[48:51], a[240:243], v[72:75], a[48:51]
  v_mfma_f32_16x16x32_bf16 a[80:83], a[240:243], v[80:83], a[80:83]
  v_exp_f32 v125, v125
  v_mfma_f32_16x16x32_bf16 a[112:115], a[240:243], v[88:91], a[112:115]
  v_cvt_pk_bf16_f32 v122, v124, v125
  v_mfma_f32_16x16x32_bf16 a[20:23], a[244:247], v[64:67], a[20:23]
  v_exp_f32 v126, v126
  v_mfma_f32_16x16x32_bf16 a[52:55], a[244:247], v[72:75], a[52:55]
  ds_read_b64_tr_b16 a[224:225], v168 offset:24576
  ds_read_b64_tr_b16 a[226:227], v168 offset:28672
  v_mfma_f32_16x16x32_bf16 a[84:87], a[244:247], v[80:83], a[84:87]
  v_exp_f32 v127, v127
  v_mfma_f32_16x16x32_bf16 a[116:119], a[244:247], v[88:91], a[116:119]
  v_cvt_pk_bf16_f32 v123, v126, v127
  s_waitcnt lgkmcnt(2)
  v_mfma_f32_16x16x32_bf16 a[24:27], a[248:251], v[64:67], a[24:27]
  v_mfma_f32_16x16x32_bf16 a[56:59], a[248:251], v[72:75], a[56:59]
  ds_read_b64_tr_b16 a[228:229], v169 offset:24576
  ds_read_b64_tr_b16 a[230:231], v169 offset:28672
  v_mfma_f32_16x16x32_bf16 a[88:91], a[248:251], v[80:83], a[88:91]
  v_mfma_f32_16x16x32_bf16 a[120:123], a[248:251], v[88:91], a[120:123]
  v_mfma_f32_16x16x32_bf16 a[28:31], a[252:255], v[64:67], a[28:31]
  s_waitcnt vmcnt(12)
  s_barrier
  v_mfma_f32_16x16x32_bf16 a[60:63], a[252:255], v[72:75], a[60:63]
  ds_read_b64_tr_b16 a[232:233], v170 offset:24576
  ds_read_b64_tr_b16 a[234:235], v170 offset:28672
  v_mfma_f32_16x16x32_bf16 a[92:95], a[252:255], v[80:83], a[92:95]
  s_add_u32 m0, s32, 65536
  v_mfma_f32_16x16x32_bf16 a[124:127], a[252:255], v[88:91], a[124:127]
  s_waitcnt lgkmcnt(4)
  v_mfma_f32_16x16x32_bf16 v[144:147], v[164:167], v[64:67], v[144:147]
  v_exp_f32 v0, v0
  v_mfma_f32_16x16x32_bf16 v[148:151], v[164:167], v[72:75], v[148:151]
  ds_read_b64_tr_b16 a[236:237], v171 offset:24576
  ds_read_b64_tr_b16 a[238:239], v171 offset:28672
  v_mfma_f32_16x16x32_bf16 v[152:155], v[164:167], v[80:83], v[152:155]
  v_exp_f32 v1, v1
  v_mfma_f32_16x16x32_bf16 v[156:159], v[164:167], v[88:91], v[156:159]
  v_cvt_pk_bf16_f32 v0, v0, v1
  v_mfma_f32_16x16x32_bf16 a[0:3], a[224:227], v[96:99], a[0:3]
  v_exp_f32 v2, v2
  v_mfma_f32_16x16x32_bf16 a[32:35], a[224:227], v[104:107], a[32:35]
  ds_read_b64_tr_b16 a[240:241], v172 offset:24576
  ds_read_b64_tr_b16 a[242:243], v172 offset:28672
  buffer_load_dwordx4 v180, s[8:11], s37 offen offset:0 lds
  v_mfma_f32_16x16x32_bf16 a[64:67], a[224:227], v[112:115], a[64:67]
  v_exp_f32 v3, v3
  v_mfma_f32_16x16x32_bf16 a[96:99], a[224:227], v[120:123], a[96:99]
  v_cvt_pk_bf16_f32 v1, v2, v3
  s_waitcnt lgkmcnt(4)
  v_mfma_f32_16x16x32_bf16 a[4:7], a[228:231], v[96:99], a[4:7]
  v_exp_f32 v4, v4
  v_mfma_f32_16x16x32_bf16 a[36:39], a[228:231], v[104:107], a[36:39]
  ds_read_b64_tr_b16 a[244:245], v173 offset:24576
  ds_read_b64_tr_b16 a[246:247], v173 offset:28672
  v_mfma_f32_16x16x32_bf16 a[68:71], a[228:231], v[112:115], a[68:71]
  v_exp_f32 v5, v5
  v_mfma_f32_16x16x32_bf16 a[100:103], a[228:231], v[120:123], a[100:103]
  v_cvt_pk_bf16_f32 v2, v4, v5
  v_mfma_f32_16x16x32_bf16 a[8:11], a[232:235], v[96:99], a[8:11]
  v_exp_f32 v6, v6
  v_mfma_f32_16x16x32_bf16 a[40:43], a[232:235], v[104:107], a[40:43]
  ds_read_b64_tr_b16 a[248:249], v174 offset:24576
  ds_read_b64_tr_b16 a[250:251], v174 offset:28672
  buffer_load_dwordx4 v181, s[8:11], s37 offen offset:1024 lds
  v_mfma_f32_16x16x32_bf16 a[72:75], a[232:235], v[112:115], a[72:75]
  v_exp_f32 v7, v7
  v_mfma_f32_16x16x32_bf16 a[104:107], a[232:235], v[120:123], a[104:107]
  v_cvt_pk_bf16_f32 v3, v6, v7
  s_waitcnt lgkmcnt(4)
  v_mfma_f32_16x16x32_bf16 a[12:15], a[236:239], v[96:99], a[12:15]
  v_exp_f32 v8, v8
  v_mfma_f32_16x16x32_bf16 a[44:47], a[236:239], v[104:107], a[44:47]
  ds_read_b64_tr_b16 a[252:253], v175 offset:24576
  ds_read_b64_tr_b16 a[254:255], v175 offset:28672
  v_mfma_f32_16x16x32_bf16 a[76:79], a[236:239], v[112:115], a[76:79]
  v_exp_f32 v9, v9
  v_mfma_f32_16x16x32_bf16 a[108:111], a[236:239], v[120:123], a[108:111]
  v_cvt_pk_bf16_f32 v8, v8, v9
  v_mfma_f32_16x16x32_bf16 a[16:19], a[240:243], v[96:99], a[16:19]
  v_exp_f32 v10, v10
  v_mfma_f32_16x16x32_bf16 a[48:51], a[240:243], v[104:107], a[48:51]
  ds_read_b128 a[192:195], v160 offset:16384
  buffer_load_dwordx4 v180, s[8:11], s37 offen offset:2048 lds
  v_mfma_f32_16x16x32_bf16 a[80:83], a[240:243], v[112:115], a[80:83]
  v_exp_f32 v11, v11
  v_mfma_f32_16x16x32_bf16 a[112:115], a[240:243], v[120:123], a[112:115]
  v_cvt_pk_bf16_f32 v9, v10, v11
  s_waitcnt lgkmcnt(3)
  v_mfma_f32_16x16x32_bf16 a[20:23], a[244:247], v[96:99], a[20:23]
  v_exp_f32 v12, v12
  v_mfma_f32_16x16x32_bf16 a[52:55], a[244:247], v[104:107], a[52:55]
  ds_read_b128 a[196:199], v161 offset:16384
  v_mfma_f32_16x16x32_bf16 a[84:87], a[244:247], v[112:115], a[84:87]
  v_exp_f32 v13, v13
  v_mfma_f32_16x16x32_bf16 a[116:119], a[244:247], v[120:123], a[116:119]
  v_cvt_pk_bf16_f32 v10, v12, v13
  v_mfma_f32_16x16x32_bf16 a[24:27], a[248:251], v[96:99], a[24:27]
  v_exp_f32 v14, v14
  v_mfma_f32_16x16x32_bf16 a[56:59], a[248:251], v[104:107], a[56:59]
  ds_read_b128 a[200:203], v162 offset:16384
  buffer_load_dwordx4 v181, s[8:11], s37 offen offset:3072 lds
  v_mfma_f32_16x16x32_bf16 a[88:91], a[248:251], v[112:115], a[88:91]
  v_exp_f32 v15, v15
  v_mfma_f32_16x16x32_bf16 a[120:123], a[248:251], v[120:123], a[120:123]
  v_cvt_pk_bf16_f32 v11, v14, v15
  s_add_u32 s37, s37, 16384
  s_waitcnt lgkmcnt(3)
  v_mfma_f32_16x16x32_bf16 a[28:31], a[252:255], v[96:99], a[28:31]
  v_exp_f32 v16, v16
  v_mfma_f32_16x16x32_bf16 a[60:63], a[252:255], v[104:107], a[60:63]
  ds_read_b128 a[204:207], v163 offset:16384
  v_mfma_f32_16x16x32_bf16 a[92:95], a[252:255], v[112:115], a[92:95]
  v_exp_f32 v17, v17
  v_mfma_f32_16x16x32_bf16 a[124:127], a[252:255], v[120:123], a[124:127]
  v_cvt_pk_bf16_f32 v16, v16, v17
  s_mov_b32 m0, s32
  v_mfma_f32_16x16x32_bf16 v[144:147], v[164:167], v[96:99], v[144:147]
  v_exp_f32 v18, v18
  v_mfma_f32_16x16x32_bf16 v[148:151], v[164:167], v[104:107], v[148:151]
  ds_read_b128 a[208:211], v160 offset:20480
  buffer_load_dwordx4 v176, s[4:7], s36 offen offset:0 lds
  v_mfma_f32_16x16x32_bf16 v[152:155], v[164:167], v[112:115], v[152:155]
  v_exp_f32 v19, v19
  v_mfma_f32_16x16x32_bf16 v[156:159], v[164:167], v[120:123], v[156:159]
  v_cvt_pk_bf16_f32 v17, v18, v19
  s_waitcnt lgkmcnt(1)
  v_mfma_f32_16x16x32_bf16 v[64:67], a[192:195], a[128:131], v[128:131]
  v_exp_f32 v20, v20
  v_mfma_f32_16x16x32_bf16 v[64:67], a[196:199], a[132:135], v[64:67]
  ds_read_b128 a[212:215], v161 offset:20480
  v_mfma_f32_16x16x32_bf16 v[64:67], a[200:203], a[136:139], v[64:67]
  v_exp_f32 v21, v21
  v_mfma_f32_16x16x32_bf16 v[64:67], a[204:207], a[140:143], v[64:67]
  v_cvt_pk_bf16_f32 v18, v20, v21
  v_mfma_f32_16x16x32_bf16 v[72:75], a[192:195], a[144:147], v[132:135]
  v_exp_f32 v22, v22
  v_mfma_f32_16x16x32_bf16 v[72:75], a[196:199], a[148:151], v[72:75]
  ds_read_b128 a[216:219], v162 offset:20480
  buffer_load_dwordx4 v177, s[4:7], s36 offen offset:1024 lds
  v_mfma_f32_16x16x32_bf16 v[72:75], a[200:203], a[152:155], v[72:75]
  v_exp_f32 v23, v23
  v_mfma_f32_16x16x32_bf16 v[72:75], a[204:207], a[156:159], v[72:75]
  v_cvt_pk_bf16_f32 v19, v22, v23
  v_mfma_f32_16x16x32_bf16 v[80:83], a[192:195], a[160:163], v[136:139]
  v_exp_f32 v24, v24
  v_mfma_f32_16x16x32_bf16 v[80:83], a[196:199], a[164:167], v[80:83]
  ds_read_b128 a[220:223], v163 offset:20480
  v_mfma_f32_16x16x32_bf16 v[80:83], a[200:203], a[168:171], v[80:83]
  v_exp_f32 v25, v25
  v_mfma_f32_16x16x32_bf16 v[80:83], a[204:207], a[172:175], v[80:83]
  v_cvt_pk_bf16_f32 v24, v24, v25
  v_mfma_f32_16x16x32_bf16 v[88:91], a[192:195], a[176:179], v[140:143]
  v_exp_f32 v26, v26
  v_mfma_f32_16x16x32_bf16 v[88:91], a[196:199], a[180:183], v[88:91]
  ds_read_b128 a[192:195], v160 offset:24576
  buffer_load_dwordx4 v178, s[4:7], s36 offen offset:2048 lds
  v_mfma_f32_16x16x32_bf16 v[88:91], a[200:203], a[184:187], v[88:91]
  v_exp_f32 v27, v27
  v_mfma_f32_16x16x32_bf16 v[88:91], a[204:207], a[188:191], v[88:91]
  v_cvt_pk_bf16_f32 v25, v26, v27
  s_waitcnt lgkmcnt(1)
  v_mfma_f32_16x16x32_bf16 v[68:71], a[208:211], a[128:131], v[128:131]
  v_exp_f32 v28, v28
  v_mfma_f32_16x16x32_bf16 v[68:71], a[212:215], a[132:135], v[68:71]
  ds_read_b128 a[196:199], v161 offset:24576
  v_mfma_f32_16x16x32_bf16 v[68:71], a[216:219], a[136:139], v[68:71]
  v_exp_f32 v29, v29
  v_mfma_f32_16x16x32_bf16 v[68:71], a[220:223], a[140:143], v[68:71]
  v_cvt_pk_bf16_f32 v26, v28, v29
  v_mfma_f32_16x16x32_bf16 v[76:79], a[208:211], a[144:147], v[132:135]
  v_exp_f32 v30, v30
  v_mfma_f32_16x16x32_bf16 v[76:79], a[212:215], a[148:151], v[76:79]
  ds_read_b128 a[200:203], v162 offset:24576
  buffer_load_dwordx4 v179, s[4:7], s36 offen offset:3072 lds
  v_mfma_f32_16x16x32_bf16 v[76:79], a[216:219], a[152:155], v[76:79]
  v_exp_f32 v31, v31
  v_mfma_f32_16x16x32_bf16 v[76:79], a[220:223], a[156:159], v[76:79]
  v_cvt_pk_bf16_f32 v27, v30, v31
  s_add_u32 s36, s36, 16384
  v_mfma_f32_16x16x32_bf16 v[84:87], a[208:211], a[160:163], v[136:139]
  v_exp_f32 v32, v32
  v_mfma_f32_16x16x32_bf16 v[84:87], a[212:215], a[164:167], v[84:87]
  ds_read_b128 a[204:207], v163 offset:24576
  v_mfma_f32_16x16x32_bf16 v[84:87], a[216:219], a[168:171], v[84:87]
  v_exp_f32 v33, v33
  v_mfma_f32_16x16x32_bf16 v[84:87], a[220:223], a[172:175], v[84:87]
  v_cvt_pk_bf16_f32 v32, v32, v33
  v_mfma_f32_16x16x32_bf16 v[92:95], a[208:211], a[176:179], v[140:143]
  v_exp_f32 v34, v34
  v_mfma_f32_16x16x32_bf16 v[92:95], a[212:215], a[180:183], v[92:95]
  ds_read_b128 a[208:211], v160 offset:28672
  v_mfma_f32_16x16x32_bf16 v[92:95], a[216:219], a[184:187], v[92:95]
  v_exp_f32 v35, v35
  v_mfma_f32_16x16x32_bf16 v[92:95], a[220:223], a[188:191], v[92:95]
  v_cvt_pk_bf16_f32 v33, v34, v35
  s_waitcnt lgkmcnt(1)
  v_mfma_f32_16x16x32_bf16 v[96:99], a[192:195], a[128:131], v[128:131]
  v_exp_f32 v36, v36
  v_mfma_f32_16x16x32_bf16 v[96:99], a[196:199], a[132:135], v[96:99]
  ds_read_b128 a[212:215], v161 offset:28672
  v_mfma_f32_16x16x32_bf16 v[96:99], a[200:203], a[136:139], v[96:99]
  v_exp_f32 v37, v37
  v_mfma_f32_16x16x32_bf16 v[96:99], a[204:207], a[140:143], v[96:99]
  v_cvt_pk_bf16_f32 v34, v36, v37
  v_mfma_f32_16x16x32_bf16 v[104:107], a[192:195], a[144:147], v[132:135]
  v_exp_f32 v38, v38
  v_mfma_f32_16x16x32_bf16 v[104:107], a[196:199], a[148:151], v[104:107]
  ds_read_b128 a[216:219], v162 offset:28672
  v_mfma_f32_16x16x32_bf16 v[104:107], a[200:203], a[152:155], v[104:107]
  v_exp_f32 v39, v39
  v_mfma_f32_16x16x32_bf16 v[104:107], a[204:207], a[156:159], v[104:107]
  v_cvt_pk_bf16_f32 v35, v38, v39
  v_mfma_f32_16x16x32_bf16 v[112:115], a[192:195], a[160:163], v[136:139]
  v_exp_f32 v40, v40
  v_mfma_f32_16x16x32_bf16 v[112:115], a[196:199], a[164:167], v[112:115]
  ds_read_b128 a[220:223], v163 offset:28672
  v_mfma_f32_16x16x32_bf16 v[112:115], a[200:203], a[168:171], v[112:115]
  v_exp_f32 v41, v41
  v_mfma_f32_16x16x32_bf16 v[112:115], a[204:207], a[172:175], v[112:115]
  v_cvt_pk_bf16_f32 v40, v40, v41
  v_mfma_f32_16x16x32_bf16 v[120:123], a[192:195], a[176:179], v[140:143]
  v_exp_f32 v42, v42
  v_mfma_f32_16x16x32_bf16 v[120:123], a[196:199], a[180:183], v[120:123]
  v_mfma_f32_16x16x32_bf16 v[120:123], a[200:203], a[184:187], v[120:123]
  v_exp_f32 v43, v43
  v_mfma_f32_16x16x32_bf16 v[120:123], a[204:207], a[188:191], v[120:123]
  v_cvt_pk_bf16_f32 v41, v42, v43
  s_waitcnt lgkmcnt(0)
  v_mfma_f32_16x16x32_bf16 v[100:103], a[208:211], a[128:131], v[128:131]
  v_exp_f32 v44, v44
  v_mfma_f32_16x16x32_bf16 v[100:103], a[212:215], a[132:135], v[100:103]
  ds_read_b64_tr_b16 a[224:225], v168 offset:32768
  ds_read_b64_tr_b16 a[226:227], v168 offset:36864
  v_mfma_f32_16x16x32_bf16 v[100:103], a[216:219], a[136:139], v[100:103]
  v_exp_f32 v45, v45
  v_mfma_f32_16x16x32_bf16 v[100:103], a[220:223], a[140:143], v[100:103]
  v_cvt_pk_bf16_f32 v42, v44, v45
  v_mfma_f32_16x16x32_bf16 v[108:111], a[208:211], a[144:147], v[132:135]
  v_exp_f32 v46, v46
  v_mfma_f32_16x16x32_bf16 v[108:111], a[212:215], a[148:151], v[108:111]
  ds_read_b64_tr_b16 a[228:229], v169 offset:32768
  ds_read_b64_tr_b16 a[230:231], v169 offset:36864
  v_mfma_f32_16x16x32_bf16 v[108:111], a[216:219], a[152:155], v[108:111]
  v_exp_f32 v47, v47
  v_mfma_f32_16x16x32_bf16 v[108:111], a[220:223], a[156:159], v[108:111]
  v_cvt_pk_bf16_f32 v43, v46, v47
  v_mfma_f32_16x16x32_bf16 v[116:119], a[208:211], a[160:163], v[136:139]
  v_exp_f32 v48, v48
  v_mfma_f32_16x16x32_bf16 v[116:119], a[212:215], a[164:167], v[116:119]
  ds_read_b64_tr_b16 a[232:233], v170 offset:32768
  ds_read_b64_tr_b16 a[234:235], v170 offset:36864
  v_mfma_f32_16x16x32_bf16 v[116:119], a[216:219], a[168:171], v[116:119]
  v_exp_f32 v49, v49
  v_mfma_f32_16x16x32_bf16 v[116:119], a[220:223], a[172:175], v[116:119]
  v_cvt_pk_bf16_f32 v48, v48, v49
  v_mfma_f32_16x16x32_bf16 v[124:127], a[208:211], a[176:179], v[140:143]
  v_exp_f32 v50, v50
  v_mfma_f32_16x16x32_bf16 v[124:127], a[212:215], a[180:183], v[124:127]
  ds_read_b64_tr_b16 a[236:237], v171 offset:32768
  ds_read_b64_tr_b16 a[238:239], v171 offset:36864
  v_mfma_f32_16x16x32_bf16 v[124:127], a[216:219], a[184:187], v[124:127]
  v_exp_f32 v51, v51
  v_mfma_f32_16x16x32_bf16 v[124:127], a[220:223], a[188:191], v[124:127]
  v_cvt_pk_bf16_f32 v49, v50, v51
  s_waitcnt lgkmcnt(4)
  v_mfma_f32_16x16x32_bf16 a[0:3], a[224:227], v[0:3], a[0:3]
  v_exp_f32 v52, v52
  v_mfma_f32_16x16x32_bf16 a[32:35], a[224:227], v[8:11], a[32:35]
  ds_read_b64_tr_b16 a[240:241], v172 offset:32768
  ds_read_b64_tr_b16 a[242:243], v172 offset:36864
  v_mfma_f32_16x16x32_bf16 a[64:67], a[224:227], v[16:19], a[64:67]
  v_exp_f32 v53, v53
  v_mfma_f32_16x16x32_bf16 a[96:99], a[224:227], v[24:27], a[96:99]
  v_cvt_pk_bf16_f32 v50, v52, v53
  v_mfma_f32_16x16x32_bf16 a[4:7], a[228:231], v[0:3], a[4:7]
  v_exp_f32 v54, v54
  v_mfma_f32_16x16x32_bf16 a[36:39], a[228:231], v[8:11], a[36:39]
  ds_read_b64_tr_b16 a[244:245], v173 offset:32768
  ds_read_b64_tr_b16 a[246:247], v173 offset:36864
  v_mfma_f32_16x16x32_bf16 a[68:71], a[228:231], v[16:19], a[68:71]
  v_exp_f32 v55, v55
  v_mfma_f32_16x16x32_bf16 a[100:103], a[228:231], v[24:27], a[100:103]
  v_cvt_pk_bf16_f32 v51, v54, v55
  s_waitcnt lgkmcnt(4)
  v_mfma_f32_16x16x32_bf16 a[8:11], a[232:235], v[0:3], a[8:11]
  v_exp_f32 v56, v56
  v_mfma_f32_16x16x32_bf16 a[40:43], a[232:235], v[8:11], a[40:43]
  ds_read_b64_tr_b16 a[248:249], v174 offset:32768
  ds_read_b64_tr_b16 a[250:251], v174 offset:36864
  v_mfma_f32_16x16x32_bf16 a[72:75], a[232:235], v[16:19], a[72:75]
  v_exp_f32 v57, v57
  v_mfma_f32_16x16x32_bf16 a[104:107], a[232:235], v[24:27], a[104:107]
  v_cvt_pk_bf16_f32 v56, v56, v57
  v_mfma_f32_16x16x32_bf16 a[12:15], a[236:239], v[0:3], a[12:15]
  v_exp_f32 v58, v58
  v_mfma_f32_16x16x32_bf16 a[44:47], a[236:239], v[8:11], a[44:47]
  ds_read_b64_tr_b16 a[252:253], v175 offset:32768
  ds_read_b64_tr_b16 a[254:255], v175 offset:36864
  v_mfma_f32_16x16x32_bf16 a[76:79], a[236:239], v[16:19], a[76:79]
  v_exp_f32 v59, v59
  v_mfma_f32_16x16x32_bf16 a[108:111], a[236:239], v[24:27], a[108:111]
  v_cvt_pk_bf16_f32 v57, v58, v59
  s_waitcnt lgkmcnt(4)
  v_mfma_f32_16x16x32_bf16 a[16:19], a[240:243], v[0:3], a[16:19]
  v_exp_f32 v60, v60
  v_mfma_f32_16x16x32_bf16 a[48:51], a[240:243], v[8:11], a[48:51]
  v_mfma_f32_16x16x32_bf16 a[80:83], a[240:243], v[16:19], a[80:83]
  v_exp_f32 v61, v61
  v_mfma_f32_16x16x32_bf16 a[112:115], a[240:243], v[24:27], a[112:115]
  v_cvt_pk_bf16_f32 v58, v60, v61
  v_mfma_f32_16x16x32_bf16 a[20:23], a[244:247], v[0:3], a[20:23]
  v_exp_f32 v62, v62
  v_mfma_f32_16x16x32_bf16 a[52:55], a[244:247], v[8:11], a[52:55]
  ds_read_b64_tr_b16 a[224:225], v168 offset:40960
  ds_read_b64_tr_b16 a[226:227], v168 offset:45056
  v_mfma_f32_16x16x32_bf16 a[84:87], a[244:247], v[16:19], a[84:87]
  v_exp_f32 v63, v63
  v_mfma_f32_16x16x32_bf16 a[116:119], a[244:247], v[24:27], a[116:119]
  v_cvt_pk_bf16_f32 v59, v62, v63
  s_waitcnt lgkmcnt(2)
  v_mfma_f32_16x16x32_bf16 a[24:27], a[248:251], v[0:3], a[24:27]
  v_mfma_f32_16x16x32_bf16 a[56:59], a[248:251], v[8:11], a[56:59]
  ds_read_b64_tr_b16 a[228:229], v169 offset:40960
  ds_read_b64_tr_b16 a[230:231], v169 offset:45056
  v_mfma_f32_16x16x32_bf16 a[88:91], a[248:251], v[16:19], a[88:91]
  v_mfma_f32_16x16x32_bf16 a[120:123], a[248:251], v[24:27], a[120:123]
  v_mfma_f32_16x16x32_bf16 a[28:31], a[252:255], v[0:3], a[28:31]
  s_waitcnt vmcnt(12)
  s_barrier
  v_mfma_f32_16x16x32_bf16 a[60:63], a[252:255], v[8:11], a[60:63]
  ds_read_b64_tr_b16 a[232:233], v170 offset:40960
  ds_read_b64_tr_b16 a[234:235], v170 offset:45056
  v_mfma_f32_16x16x32_bf16 a[92:95], a[252:255], v[16:19], a[92:95]
  s_add_u32 m0, s33, 65536
  v_mfma_f32_16x16x32_bf16 a[124:127], a[252:255], v[24:27], a[124:127]
  s_waitcnt lgkmcnt(4)
  v_mfma_f32_16x16x32_bf16 v[144:147], v[164:167], v[0:3], v[144:147]
  v_exp_f32 v64, v64
  v_mfma_f32_16x16x32_bf16 v[148:151], v[164:167], v[8:11], v[148:151]
  ds_read_b64_tr_b16 a[236:237], v171 offset:40960
  ds_read_b64_tr_b16 a[238:239], v171 offset:45056
  v_mfma_f32_16x16x32_bf16 v[152:155], v[164:167], v[16:19], v[152:155]
  v_exp_f32 v65, v65
  v_mfma_f32_16x16x32_bf16 v[156:159], v[164:167], v[24:27], v[156:159]
  v_cvt_pk_bf16_f32 v64, v64, v65
  v_mfma_f32_16x16x32_bf16 a[0:3], a[224:227], v[32:35], a[0:3]
  v_exp_f32 v66, v66
  v_mfma_f32_16x16x32_bf16 a[32:35], a[224:227], v[40:43], a[32:35]
  ds_read_b64_tr_b16 a[240:241], v172 offset:40960
  ds_read_b64_tr_b16 a[242:243], v172 offset:45056
  buffer_load_dwordx4 v180, s[8:11], s37 offen offset:0 lds
  v_mfma_f32_16x16x32_bf16 a[64:67], a[224:227], v[48:51], a[64:67]
  v_exp_f32 v67, v67
  v_mfma_f32_16x16x32_bf16 a[96:99], a[224:227], v[56:59], a[96:99]
  v_cvt_pk_bf16_f32 v65, v66, v67
  s_waitcnt lgkmcnt(4)
  v_mfma_f32_16x16x32_bf16 a[4:7], a[228:231], v[32:35], a[4:7]
  v_exp_f32 v68, v68
  v_mfma_f32_16x16x32_bf16 a[36:39], a[228:231], v[40:43], a[36:39]
  ds_read_b64_tr_b16 a[244:245], v173 offset:40960
  ds_read_b64_tr_b16 a[246:247], v173 offset:45056
  v_mfma_f32_16x16x32_bf16 a[68:71], a[228:231], v[48:51], a[68:71]
  v_exp_f32 v69, v69
  v_mfma_f32_16x16x32_bf16 a[100:103], a[228:231], v[56:59], a[100:103]
  v_cvt_pk_bf16_f32 v66, v68, v69
  v_mfma_f32_16x16x32_bf16 a[8:11], a[232:235], v[32:35], a[8:11]
  v_exp_f32 v70, v70
  v_mfma_f32_16x16x32_bf16 a[40:43], a[232:235], v[40:43], a[40:43]
  ds_read_b64_tr_b16 a[248:249], v174 offset:40960
  ds_read_b64_tr_b16 a[250:251], v174 offset:45056
  buffer_load_dwordx4 v181, s[8:11], s37 offen offset:1024 lds
  v_mfma_f32_16x16x32_bf16 a[72:75], a[232:235], v[48:51], a[72:75]
  v_exp_f32 v71, v71
  v_mfma_f32_16x16x32_bf16 a[104:107], a[232:235], v[56:59], a[104:107]
  v_cvt_pk_bf16_f32 v67, v70, v71
  s_waitcnt lgkmcnt(4)
  v_mfma_f32_16x16x32_bf16 a[12:15], a[236:239], v[32:35], a[12:15]
  v_exp_f32 v72, v72
  v_mfma_f32_16x16x32_bf16 a[44:47], a[236:239], v[40:43], a[44:47]
  ds_read_b64_tr_b16 a[252:253], v175 offset:40960
  ds_read_b64_tr_b16 a[254:255], v175 offset:45056
  v_mfma_f32_16x16x32_bf16 a[76:79], a[236:239], v[48:51], a[76:79]
  v_exp_f32 v73, v73
  v_mfma_f32_16x16x32_bf16 a[108:111], a[236:239], v[56:59], a[108:111]
  v_cvt_pk_bf16_f32 v72, v72, v73
  v_mfma_f32_16x16x32_bf16 a[16:19], a[240:243], v[32:35], a[16:19]
  v_exp_f32 v74, v74
  v_mfma_f32_16x16x32_bf16 a[48:51], a[240:243], v[40:43], a[48:51]
  ds_read_b128 a[192:195], v160 offset:32768
  buffer_load_dwordx4 v180, s[8:11], s37 offen offset:2048 lds
  v_mfma_f32_16x16x32_bf16 a[80:83], a[240:243], v[48:51], a[80:83]
  v_exp_f32 v75, v75
  v_mfma_f32_16x16x32_bf16 a[112:115], a[240:243], v[56:59], a[112:115]
  v_cvt_pk_bf16_f32 v73, v74, v75
  s_waitcnt lgkmcnt(3)
  v_mfma_f32_16x16x32_bf16 a[20:23], a[244:247], v[32:35], a[20:23]
  v_exp_f32 v76, v76
  v_mfma_f32_16x16x32_bf16 a[52:55], a[244:247], v[40:43], a[52:55]
  ds_read_b128 a[196:199], v161 offset:32768
  v_mfma_f32_16x16x32_bf16 a[84:87], a[244:247], v[48:51], a[84:87]
  v_exp_f32 v77, v77
  v_mfma_f32_16x16x32_bf16 a[116:119], a[244:247], v[56:59], a[116:119]
  v_cvt_pk_bf16_f32 v74, v76, v77
  v_mfma_f32_16x16x32_bf16 a[24:27], a[248:251], v[32:35], a[24:27]
  v_exp_f32 v78, v78
  v_mfma_f32_16x16x32_bf16 a[56:59], a[248:251], v[40:43], a[56:59]
  ds_read_b128 a[200:203], v162 offset:32768
  buffer_load_dwordx4 v181, s[8:11], s37 offen offset:3072 lds
  v_mfma_f32_16x16x32_bf16 a[88:91], a[248:251], v[48:51], a[88:91]
  v_exp_f32 v79, v79
  v_mfma_f32_16x16x32_bf16 a[120:123], a[248:251], v[56:59], a[120:123]
  v_cvt_pk_bf16_f32 v75, v78, v79
  s_add_u32 s37, s37, 16384
  s_waitcnt lgkmcnt(3)
  v_mfma_f32_16x16x32_bf16 a[28:31], a[252:255], v[32:35], a[28:31]
  v_exp_f32 v80, v80
  v_mfma_f32_16x16x32_bf16 a[60:63], a[252:255], v[40:43], a[60:63]
  ds_read_b128 a[204:207], v163 offset:32768
  v_mfma_f32_16x16x32_bf16 a[92:95], a[252:255], v[48:51], a[92:95]
  v_exp_f32 v81, v81
  v_mfma_f32_16x16x32_bf16 a[124:127], a[252:255], v[56:59], a[124:127]
  v_cvt_pk_bf16_f32 v80, v80, v81
  s_mov_b32 m0, s33
  v_mfma_f32_16x16x32_bf16 v[144:147], v[164:167], v[32:35], v[144:147]
  v_exp_f32 v82, v82
  v_mfma_f32_16x16x32_bf16 v[148:151], v[164:167], v[40:43], v[148:151]
  ds_read_b128 a[208:211], v160 offset:36864
  buffer_load_dwordx4 v176, s[4:7], s36 offen offset:0 lds
  v_mfma_f32_16x16x32_bf16 v[152:155], v[164:167], v[48:51], v[152:155]
  v_exp_f32 v83, v83
  v_mfma_f32_16x16x32_bf16 v[156:159], v[164:167], v[56:59], v[156:159]
  v_cvt_pk_bf16_f32 v81, v82, v83
  s_waitcnt lgkmcnt(1)
  v_mfma_f32_16x16x32_bf16 v[0:3], a[192:195], a[128:131], v[128:131]
  v_exp_f32 v84, v84
  v_mfma_f32_16x16x32_bf16 v[0:3], a[196:199], a[132:135], v[0:3]
  ds_read_b128 a[212:215], v161 offset:36864
  v_mfma_f32_16x16x32_bf16 v[0:3], a[200:203], a[136:139], v[0:3]
  v_exp_f32 v85, v85
  v_mfma_f32_16x16x32_bf16 v[0:3], a[204:207], a[140:143], v[0:3]
  v_cvt_pk_bf16_f32 v82, v84, v85
  v_mfma_f32_16x16x32_bf16 v[8:11], a[192:195], a[144:147], v[132:135]
  v_exp_f32 v86, v86
  v_mfma_f32_16x16x32_bf16 v[8:11], a[196:199], a[148:151], v[8:11]
  ds_read_b128 a[216:219], v162 offset:36864
  buffer_load_dwordx4 v177, s[4:7], s36 offen offset:1024 lds
  v_mfma_f32_16x16x32_bf16 v[8:11], a[200:203], a[152:155], v[8:11]
  v_exp_f32 v87, v87
  v_mfma_f32_16x16x32_bf16 v[8:11], a[204:207], a[156:159], v[8:11]
  v_cvt_pk_bf16_f32 v83, v86, v87
  v_mfma_f32_16x16x32_bf16 v[16:19], a[192:195], a[160:163], v[136:139]
  v_exp_f32 v88, v88
  v_mfma_f32_16x16x32_bf16 v[16:19], a[196:199], a[164:167], v[16:19]
  ds_read_b128 a[220:223], v163 offset:36864
  v_mfma_f32_16x16x32_bf16 v[16:19], a[200:203], a[168:171], v[16:19]
  v_exp_f32 v89, v89
  v_mfma_f32_16x16x32_bf16 v[16:19], a[204:207], a[172:175], v[16:19]
  v_cvt_pk_bf16_f32 v88, v88, v89
  v_mfma_f32_16x16x32_bf16 v[24:27], a[192:195], a[176:179], v[140:143]
  v_exp_f32 v90, v90
  v_mfma_f32_16x16x32_bf16 v[24:27], a[196:199], a[180:183], v[24:27]
  ds_read_b128 a[192:195], v160 offset:40960
  buffer_load_dwordx4 v178, s[4:7], s36 offen offset:2048 lds
  v_mfma_f32_16x16x32_bf16 v[24:27], a[200:203], a[184:187], v[24:27]
  v_exp_f32 v91, v91
  v_mfma_f32_16x16x32_bf16 v[24:27], a[204:207], a[188:191], v[24:27]
  v_cvt_pk_bf16_f32 v89, v90, v91
  s_waitcnt lgkmcnt(1)
  v_mfma_f32_16x16x32_bf16 v[4:7], a[208:211], a[128:131], v[128:131]
  v_exp_f32 v92, v92
  v_mfma_f32_16x16x32_bf16 v[4:7], a[212:215], a[132:135], v[4:7]
  ds_read_b128 a[196:199], v161 offset:40960
  v_mfma_f32_16x16x32_bf16 v[4:7], a[216:219], a[136:139], v[4:7]
  v_exp_f32 v93, v93
  v_mfma_f32_16x16x32_bf16 v[4:7], a[220:223], a[140:143], v[4:7]
  v_cvt_pk_bf16_f32 v90, v92, v93
  v_mfma_f32_16x16x32_bf16 v[12:15], a[208:211], a[144:147], v[132:135]
  v_exp_f32 v94, v94
  v_mfma_f32_16x16x32_bf16 v[12:15], a[212:215], a[148:151], v[12:15]
  ds_read_b128 a[200:203], v162 offset:40960
  buffer_load_dwordx4 v179, s[4:7], s36 offen offset:3072 lds
  v_mfma_f32_16x16x32_bf16 v[12:15], a[216:219], a[152:155], v[12:15]
  v_exp_f32 v95, v95
  v_mfma_f32_16x16x32_bf16 v[12:15], a[220:223], a[156:159], v[12:15]
  v_cvt_pk_bf16_f32 v91, v94, v95
  s_add_u32 s36, s36, 16384
  v_mfma_f32_16x16x32_bf16 v[20:23], a[208:211], a[160:163], v[136:139]
  v_exp_f32 v96, v96
  v_mfma_f32_16x16x32_bf16 v[20:23], a[212:215], a[164:167], v[20:23]
  ds_read_b128 a[204:207], v163 offset:40960
  v_mfma_f32_16x16x32_bf16 v[20:23], a[216:219], a[168:171], v[20:23]
  v_exp_f32 v97, v97
  v_mfma_f32_16x16x32_bf16 v[20:23], a[220:223], a[172:175], v[20:23]
  v_cvt_pk_bf16_f32 v96, v96, v97
  v_mfma_f32_16x16x32_bf16 v[28:31], a[208:211], a[176:179], v[140:143]
  v_exp_f32 v98, v98
  v_mfma_f32_16x16x32_bf16 v[28:31], a[212:215], a[180:183], v[28:31]
  ds_read_b128 a[208:211], v160 offset:45056
  v_mfma_f32_16x16x32_bf16 v[28:31], a[216:219], a[184:187], v[28:31]
  v_exp_f32 v99, v99
  v_mfma_f32_16x16x32_bf16 v[28:31], a[220:223], a[188:191], v[28:31]
  v_cvt_pk_bf16_f32 v97, v98, v99
  s_waitcnt lgkmcnt(1)
  v_mfma_f32_16x16x32_bf16 v[32:35], a[192:195], a[128:131], v[128:131]
  v_exp_f32 v100, v100
  v_mfma_f32_16x16x32_bf16 v[32:35], a[196:199], a[132:135], v[32:35]
  ds_read_b128 a[212:215], v161 offset:45056
  v_mfma_f32_16x16x32_bf16 v[32:35], a[200:203], a[136:139], v[32:35]
  v_exp_f32 v101, v101
  v_mfma_f32_16x16x32_bf16 v[32:35], a[204:207], a[140:143], v[32:35]
  v_cvt_pk_bf16_f32 v98, v100, v101
  v_mfma_f32_16x16x32_bf16 v[40:43], a[192:195], a[144:147], v[132:135]
  v_exp_f32 v102, v102
  v_mfma_f32_16x16x32_bf16 v[40:43], a[196:199], a[148:151], v[40:43]
  ds_read_b128 a[216:219], v162 offset:45056
  v_mfma_f32_16x16x32_bf16 v[40:43], a[200:203], a[152:155], v[40:43]
  v_exp_f32 v103, v103
  v_mfma_f32_16x16x32_bf16 v[40:43], a[204:207], a[156:159], v[40:43]
  v_cvt_pk_bf16_f32 v99, v102, v103
  v_mfma_f32_16x16x32_bf16 v[48:51], a[192:195], a[160:163], v[136:139]
  v_exp_f32 v104, v104
  v_mfma_f32_16x16x32_bf16 v[48:51], a[196:199], a[164:167], v[48:51]
  ds_read_b128 a[220:223], v163 offset:45056
  v_mfma_f32_16x16x32_bf16 v[48:51], a[200:203], a[168:171], v[48:51]
  v_exp_f32 v105, v105
  v_mfma_f32_16x16x32_bf16 v[48:51], a[204:207], a[172:175], v[48:51]
  v_cvt_pk_bf16_f32 v104, v104, v105
  v_mfma_f32_16x16x32_bf16 v[56:59], a[192:195], a[176:179], v[140:143]
  v_exp_f32 v106, v106
  v_mfma_f32_16x16x32_bf16 v[56:59], a[196:199], a[180:183], v[56:59]
  v_mfma_f32_16x16x32_bf16 v[56:59], a[200:203], a[184:187], v[56:59]
  v_exp_f32 v107, v107
  v_mfma_f32_16x16x32_bf16 v[56:59], a[204:207], a[188:191], v[56:59]
  v_cvt_pk_bf16_f32 v105, v106, v107
  s_waitcnt lgkmcnt(0)
  v_mfma_f32_16x16x32_bf16 v[36:39], a[208:211], a[128:131], v[128:131]
  v_exp_f32 v108, v108
  v_mfma_f32_16x16x32_bf16 v[36:39], a[212:215], a[132:135], v[36:39]
  ds_read_b64_tr_b16 a[224:225], v168 offset:49152
  ds_read_b64_tr_b16 a[226:227], v168 offset:53248
  v_mfma_f32_16x16x32_bf16 v[36:39], a[216:219], a[136:139], v[36:39]
  v_exp_f32 v109, v109
  v_mfma_f32_16x16x32_bf16 v[36:39], a[220:223], a[140:143], v[36:39]
  v_cvt_pk_bf16_f32 v106, v108, v109
  v_mfma_f32_16x16x32_bf16 v[44:47], a[208:211], a[144:147], v[132:135]
  v_exp_f32 v110, v110
  v_mfma_f32_16x16x32_bf16 v[44:47], a[212:215], a[148:151], v[44:47]
  ds_read_b64_tr_b16 a[228:229], v169 offset:49152
  ds_read_b64_tr_b16 a[230:231], v169 offset:53248
  v_mfma_f32_16x16x32_bf16 v[44:47], a[216:219], a[152:155], v[44:47]
  v_exp_f32 v111, v111
  v_mfma_f32_16x16x32_bf16 v[44:47], a[220:223], a[156:159], v[44:47]
  v_cvt_pk_bf16_f32 v107, v110, v111
  v_mfma_f32_16x16x32_bf16 v[52:55], a[208:211], a[160:163], v[136:139]
  v_exp_f32 v112, v112
  v_mfma_f32_16x16x32_bf16 v[52:55], a[212:215], a[164:167], v[52:55]
  ds_read_b64_tr_b16 a[232:233], v170 offset:49152
  ds_read_b64_tr_b16 a[234:235], v170 offset:53248
  v_mfma_f32_16x16x32_bf16 v[52:55], a[216:219], a[168:171], v[52:55]
  v_exp_f32 v113, v113
  v_mfma_f32_16x16x32_bf16 v[52:55], a[220:223], a[172:175], v[52:55]
  v_cvt_pk_bf16_f32 v112, v112, v113
  v_mfma_f32_16x16x32_bf16 v[60:63], a[208:211], a[176:179], v[140:143]
  v_exp_f32 v114, v114
  v_mfma_f32_16x16x32_bf16 v[60:63], a[212:215], a[180:183], v[60:63]
  ds_read_b64_tr_b16 a[236:237], v171 offset:49152
  ds_read_b64_tr_b16 a[238:239], v171 offset:53248
  v_mfma_f32_16x16x32_bf16 v[60:63], a[216:219], a[184:187], v[60:63]
  v_exp_f32 v115, v115
  v_mfma_f32_16x16x32_bf16 v[60:63], a[220:223], a[188:191], v[60:63]
  v_cvt_pk_bf16_f32 v113, v114, v115
  s_waitcnt lgkmcnt(4)
  v_mfma_f32_16x16x32_bf16 a[0:3], a[224:227], v[64:67], a[0:3]
  v_exp_f32 v116, v116
  v_mfma_f32_16x16x32_bf16 a[32:35], a[224:227], v[72:75], a[32:35]
  ds_read_b64_tr_b16 a[240:241], v172 offset:49152
  ds_read_b64_tr_b16 a[242:243], v172 offset:53248
  v_mfma_f32_16x16x32_bf16 a[64:67], a[224:227], v[80:83], a[64:67]
  v_exp_f32 v117, v117
  v_mfma_f32_16x16x32_bf16 a[96:99], a[224:227], v[88:91], a[96:99]
  v_cvt_pk_bf16_f32 v114, v116, v117
  v_mfma_f32_16x16x32_bf16 a[4:7], a[228:231], v[64:67], a[4:7]
  v_exp_f32 v118, v118
  v_mfma_f32_16x16x32_bf16 a[36:39], a[228:231], v[72:75], a[36:39]
  ds_read_b64_tr_b16 a[244:245], v173 offset:49152
  ds_read_b64_tr_b16 a[246:247], v173 offset:53248
  v_mfma_f32_16x16x32_bf16 a[68:71], a[228:231], v[80:83], a[68:71]
  v_exp_f32 v119, v119
  v_mfma_f32_16x16x32_bf16 a[100:103], a[228:231], v[88:91], a[100:103]
  v_cvt_pk_bf16_f32 v115, v118, v119
  s_waitcnt lgkmcnt(4)
  v_mfma_f32_16x16x32_bf16 a[8:11], a[232:235], v[64:67], a[8:11]
  v_exp_f32 v120, v120
  v_mfma_f32_16x16x32_bf16 a[40:43], a[232:235], v[72:75], a[40:43]
  ds_read_b64_tr_b16 a[248:249], v174 offset:49152
  ds_read_b64_tr_b16 a[250:251], v174 offset:53248
  v_mfma_f32_16x16x32_bf16 a[72:75], a[232:235], v[80:83], a[72:75]
  v_exp_f32 v121, v121
  v_mfma_f32_16x16x32_bf16 a[104:107], a[232:235], v[88:91], a[104:107]
  v_cvt_pk_bf16_f32 v120, v120, v121
  v_mfma_f32_16x16x32_bf16 a[12:15], a[236:239], v[64:67], a[12:15]
  v_exp_f32 v122, v122
  v_mfma_f32_16x16x32_bf16 a[44:47], a[236:239], v[72:75], a[44:47]
  ds_read_b64_tr_b16 a[252:253], v175 offset:49152
  ds_read_b64_tr_b16 a[254:255], v175 offset:53248
  v_mfma_f32_16x16x32_bf16 a[76:79], a[236:239], v[80:83], a[76:79]
  v_exp_f32 v123, v123
  v_mfma_f32_16x16x32_bf16 a[108:111], a[236:239], v[88:91], a[108:111]
  v_cvt_pk_bf16_f32 v121, v122, v123
  s_waitcnt lgkmcnt(4)
  v_mfma_f32_16x16x32_bf16 a[16:19], a[240:243], v[64:67], a[16:19]
  v_exp_f32 v124, v124
  v_mfma_f32_16x16x32_bf16 a[48:51], a[240:243], v[72:75], a[48:51]
  v_mfma_f32_16x16x32_bf16 a[80:83], a[240:243], v[80:83], a[80:83]
  v_exp_f32 v125, v125
  v_mfma_f32_16x16x32_bf16 a[112:115], a[240:243], v[88:91], a[112:115]
  v_cvt_pk_bf16_f32 v122, v124, v125
  v_mfma_f32_16x16x32_bf16 a[20:23], a[244:247], v[64:67], a[20:23]
  v_exp_f32 v126, v126
  v_mfma_f32_16x16x32_bf16 a[52:55], a[244:247], v[72:75], a[52:55]
  ds_read_b64_tr_b16 a[224:225], v168 offset:57344
  ds_read_b64_tr_b16 a[226:227], v168 offset:61440
  v_mfma_f32_16x16x32_bf16 a[84:87], a[244:247], v[80:83], a[84:87]
  v_exp_f32 v127, v127
  v_mfma_f32_16x16x32_bf16 a[116:119], a[244:247], v[88:91], a[116:119]
  v_cvt_pk_bf16_f32 v123, v126, v127
  s_waitcnt lgkmcnt(2)
  v_mfma_f32_16x16x32_bf16 a[24:27], a[248:251], v[64:67], a[24:27]
  v_mfma_f32_16x16x32_bf16 a[56:59], a[248:251], v[72:75], a[56:59]
  ds_read_b64_tr_b16 a[228:229], v169 offset:57344
  ds_read_b64_tr_b16 a[230:231], v169 offset:61440
  v_mfma_f32_16x16x32_bf16 a[88:91], a[248:251], v[80:83], a[88:91]
  v_mfma_f32_16x16x32_bf16 a[120:123], a[248:251], v[88:91], a[120:123]
  v_mfma_f32_16x16x32_bf16 a[28:31], a[252:255], v[64:67], a[28:31]
  s_waitcnt vmcnt(12)
  s_barrier
  v_mfma_f32_16x16x32_bf16 a[60:63], a[252:255], v[72:75], a[60:63]
  ds_read_b64_tr_b16 a[232:233], v170 offset:57344
  ds_read_b64_tr_b16 a[234:235], v170 offset:61440
  v_mfma_f32_16x16x32_bf16 a[92:95], a[252:255], v[80:83], a[92:95]
  s_add_u32 m0, s34, 65536
  v_mfma_f32_16x16x32_bf16 a[124:127], a[252:255], v[88:91], a[124:127]
  s_waitcnt lgkmcnt(4)
  v_mfma_f32_16x16x32_bf16 v[144:147], v[164:167], v[64:67], v[144:147]
  v_exp_f32 v0, v0
  v_mfma_f32_16x16x32_bf16 v[148:151], v[164:167], v[72:75], v[148:151]
  ds_read_b64_tr_b16 a[236:237], v171 offset:57344
  ds_read_b64_tr_b16 a[238:239], v171 offset:61440
  v_mfma_f32_16x16x32_bf16 v[152:155], v[164:167], v[80:83], v[152:155]
  v_exp_f32 v1, v1
  v_mfma_f32_16x16x32_bf16 v[156:159], v[164:167], v[88:91], v[156:159]
  v_cvt_pk_bf16_f32 v0, v0, v1
  v_mfma_f32_16x16x32_bf16 a[0:3], a[224:227], v[96:99], a[0:3]
  v_exp_f32 v2, v2
  v_mfma_f32_16x16x32_bf16 a[32:35], a[224:227], v[104:107], a[32:35]
  ds_read_b64_tr_b16 a[240:241], v172 offset:57344
  ds_read_b64_tr_b16 a[242:243], v172 offset:61440
  buffer_load_dwordx4 v180, s[8:11], s37 offen offset:0 lds
  v_mfma_f32_16x16x32_bf16 a[64:67], a[224:227], v[112:115], a[64:67]
  v_exp_f32 v3, v3
  v_mfma_f32_16x16x32_bf16 a[96:99], a[224:227], v[120:123], a[96:99]
  v_cvt_pk_bf16_f32 v1, v2, v3
  s_waitcnt lgkmcnt(4)
  v_mfma_f32_16x16x32_bf16 a[4:7], a[228:231], v[96:99], a[4:7]
  v_exp_f32 v4, v4
  v_mfma_f32_16x16x32_bf16 a[36:39], a[228:231], v[104:107], a[36:39]
  ds_read_b64_tr_b16 a[244:245], v173 offset:57344
  ds_read_b64_tr_b16 a[246:247], v173 offset:61440
  v_mfma_f32_16x16x32_bf16 a[68:71], a[228:231], v[112:115], a[68:71]
  v_exp_f32 v5, v5
  v_mfma_f32_16x16x32_bf16 a[100:103], a[228:231], v[120:123], a[100:103]
  v_cvt_pk_bf16_f32 v2, v4, v5
  v_mfma_f32_16x16x32_bf16 a[8:11], a[232:235], v[96:99], a[8:11]
  v_exp_f32 v6, v6
  v_mfma_f32_16x16x32_bf16 a[40:43], a[232:235], v[104:107], a[40:43]
  ds_read_b64_tr_b16 a[248:249], v174 offset:57344
  ds_read_b64_tr_b16 a[250:251], v174 offset:61440
  buffer_load_dwordx4 v181, s[8:11], s37 offen offset:1024 lds
  v_mfma_f32_16x16x32_bf16 a[72:75], a[232:235], v[112:115], a[72:75]
  v_exp_f32 v7, v7
  v_mfma_f32_16x16x32_bf16 a[104:107], a[232:235], v[120:123], a[104:107]
  v_cvt_pk_bf16_f32 v3, v6, v7
  s_waitcnt lgkmcnt(4)
  v_mfma_f32_16x16x32_bf16 a[12:15], a[236:239], v[96:99], a[12:15]
  v_exp_f32 v8, v8
  v_mfma_f32_16x16x32_bf16 a[44:47], a[236:239], v[104:107], a[44:47]
  ds_read_b64_tr_b16 a[252:253], v175 offset:57344
  ds_read_b64_tr_b16 a[254:255], v175 offset:61440
  v_mfma_f32_16x16x32_bf16 a[76:79], a[236:239], v[112:115], a[76:79]
  v_exp_f32 v9, v9
  v_mfma_f32_16x16x32_bf16 a[108:111], a[236:239], v[120:123], a[108:111]
  v_cvt_pk_bf16_f32 v8, v8, v9
  v_mfma_f32_16x16x32_bf16 a[16:19], a[240:243], v[96:99], a[16:19]
  v_exp_f32 v10, v10
  v_mfma_f32_16x16x32_bf16 a[48:51], a[240:243], v[104:107], a[48:51]
  ds_read_b128 a[192:195], v160 offset:49152
  buffer_load_dwordx4 v180, s[8:11], s37 offen offset:2048 lds
  v_mfma_f32_16x16x32_bf16 a[80:83], a[240:243], v[112:115], a[80:83]
  v_exp_f32 v11, v11
  v_mfma_f32_16x16x32_bf16 a[112:115], a[240:243], v[120:123], a[112:115]
  v_cvt_pk_bf16_f32 v9, v10, v11
  s_waitcnt lgkmcnt(3)
  v_mfma_f32_16x16x32_bf16 a[20:23], a[244:247], v[96:99], a[20:23]
  v_exp_f32 v12, v12
  v_mfma_f32_16x16x32_bf16 a[52:55], a[244:247], v[104:107], a[52:55]
  ds_read_b128 a[196:199], v161 offset:49152
  v_mfma_f32_16x16x32_bf16 a[84:87], a[244:247], v[112:115], a[84:87]
  v_exp_f32 v13, v13
  v_mfma_f32_16x16x32_bf16 a[116:119], a[244:247], v[120:123], a[116:119]
  v_cvt_pk_bf16_f32 v10, v12, v13
  v_mfma_f32_16x16x32_bf16 a[24:27], a[248:251], v[96:99], a[24:27]
  v_exp_f32 v14, v14
  v_mfma_f32_16x16x32_bf16 a[56:59], a[248:251], v[104:107], a[56:59]
  ds_read_b128 a[200:203], v162 offset:49152
  buffer_load_dwordx4 v181, s[8:11], s37 offen offset:3072 lds
  v_mfma_f32_16x16x32_bf16 a[88:91], a[248:251], v[112:115], a[88:91]
  v_exp_f32 v15, v15
  v_mfma_f32_16x16x32_bf16 a[120:123], a[248:251], v[120:123], a[120:123]
  v_cvt_pk_bf16_f32 v11, v14, v15
  s_add_u32 s37, s37, 16384
  s_waitcnt lgkmcnt(3)
  v_mfma_f32_16x16x32_bf16 a[28:31], a[252:255], v[96:99], a[28:31]
  v_exp_f32 v16, v16
  v_mfma_f32_16x16x32_bf16 a[60:63], a[252:255], v[104:107], a[60:63]
  ds_read_b128 a[204:207], v163 offset:49152
  v_mfma_f32_16x16x32_bf16 a[92:95], a[252:255], v[112:115], a[92:95]
  v_exp_f32 v17, v17
  v_mfma_f32_16x16x32_bf16 a[124:127], a[252:255], v[120:123], a[124:127]
  v_cvt_pk_bf16_f32 v16, v16, v17
  s_mov_b32 m0, s34
  v_mfma_f32_16x16x32_bf16 v[144:147], v[164:167], v[96:99], v[144:147]
  v_exp_f32 v18, v18
  v_mfma_f32_16x16x32_bf16 v[148:151], v[164:167], v[104:107], v[148:151]
  ds_read_b128 a[208:211], v160 offset:53248
  buffer_load_dwordx4 v176, s[4:7], s36 offen offset:0 lds
  v_mfma_f32_16x16x32_bf16 v[152:155], v[164:167], v[112:115], v[152:155]
  v_exp_f32 v19, v19
  v_mfma_f32_16x16x32_bf16 v[156:159], v[164:167], v[120:123], v[156:159]
  v_cvt_pk_bf16_f32 v17, v18, v19
  s_sub_u32 s38, s38, 1
  s_cmp_lg_u32 s38, 0
  s_cbranch_scc1 L_loop
  s_waitcnt lgkmcnt(1)
  v_mfma_f32_16x16x32_bf16 v[64:67], a[192:195], a[128:131], v[128:131]
  v_exp_f32 v20, v20
  v_mfma_f32_16x16x32_bf16 v[64:67], a[196:199], a[132:135], v[64:67]
  ds_read_b128 a[212:215], v161 offset:53248
  v_mfma_f32_16x16x32_bf16 v[64:67], a[200:203], a[136:139], v[64:67]
  v_exp_f32 v21, v21
  v_mfma_f32_16x16x32_bf16 v[64:67], a[204:207], a[140:143], v[64:67]
  v_cvt_pk_bf16_f32 v18, v20, v21
  v_mfma_f32_16x16x32_bf16 v[72:75], a[192:195], a[144:147], v[132:135]
  v_exp_f32 v22, v22
  v_mfma_f32_16x16x32_bf16 v[72:75], a[196:199], a[148:151], v[72:75]
  ds_read_b128 a[216:219], v162 offset:53248
  buffer_load_dwordx4 v177, s[4:7], s36 offen offset:1024 lds
  v_mfma_f32_16x16x32_bf16 v[72:75], a[200:203], a[152:155], v[72:75]
  v_exp_f32 v23, v23
  v_mfma_f32_16x16x32_bf16 v[72:75], a[204:207], a[156:159], v[72:75]
  v_cvt_pk_bf16_f32 v19, v22, v23
  v_mfma_f32_16x16x32_bf16 v[80:83], a[192:195], a[160:163], v[136:139]
  v_exp_f32 v24, v24
  v_mfma_f32_16x16x32_bf16 v[80:83], a[196:199], a[164:167], v[80:83]
  ds_read_b128 a[220:223], v163 offset:53248
  v_mfma_f32_16x16x32_bf16 v[80:83], a[200:203], a[168:171], v[80:83]
  v_exp_f32 v25, v25
  v_mfma_f32_16x16x32_bf16 v[80:83], a[204:207], a[172:175], v[80:83]
  v_cvt_pk_bf16_f32 v24, v24, v25
  v_mfma_f32_16x16x32_bf16 v[88:91], a[192:195], a[176:179], v[140:143]
  v_exp_f32 v26, v26
  v_mfma_f32_16x16x32_bf16 v[88:91], a[196:199], a[180:183], v[88:91]
  ds_read_b128 a[192:195], v160 offset:57344
  buffer_load_dwordx4 v178, s[4:7], s36 offen offset:2048 lds
  v_mfma_f32_16x16x32_bf16 v[88:91], a[200:203], a[184:187], v[88:91]
  v_exp_f32 v27, v27
  v_mfma_f32_16x16x32_bf16 v[88:91], a[204:207], a[188:191], v[88:91]
  v_cvt_pk_bf16_f32 v25, v26, v27
  s_waitcnt lgkmcnt(1)
  v_mfma_f32_16x16x32_bf16 v[68:71], a[208:211], a[128:131], v[128:131]
  v_exp_f32 v28, v28
  v_mfma_f32_16x16x32_bf16 v[68:71], a[212:215], a[132:135], v[68:71]
  ds_read_b128 a[196:199], v161 offset:57344
  v_mfma_f32_16x16x32_bf16 v[68:71], a[216:219], a[136:139], v[68:71]
  v_exp_f32 v29, v29
  v_mfma_f32_16x16x32_bf16 v[68:71], a[220:223], a[140:143], v[68:71]
  v_cvt_pk_bf16_f32 v26, v28, v29
  v_mfma_f32_16x16x32_bf16 v[76:79], a[208:211], a[144:147], v[132:135]
  v_exp_f32 v30, v30
  v_mfma_f32_16x16x32_bf16 v[76:79], a[212:215], a[148:151], v[76:79]
  ds_read_b128 a[200:203], v162 offset:57344
  buffer_load_dwordx4 v179, s[4:7], s36 offen offset:3072 lds
  v_mfma_f32_16x16x32_bf16 v[76:79], a[216:219], a[152:155], v[76:79]
  v_exp_f32 v31, v31
  v_mfma_f32_16x16x32_bf16 v[76:79], a[220:223], a[156:159], v[76:79]
  v_cvt_pk_bf16_f32 v27, v30, v31
  s_add_u32 s36, s36, 16384
  v_mfma_f32_16x16x32_bf16 v[84:87], a[208:211], a[160:163], v[136:139]
  v_exp_f32 v32, v32
  v_mfma_f32_16x16x32_bf16 v[84:87], a[212:215], a[164:167], v[84:87]
  ds_read_b128 a[204:207], v163 offset:57344
  v_mfma_f32_16x16x32_bf16 v[84:87], a[216:219], a[168:171], v[84:87]
  v_exp_f32 v33, v33
  v_mfma_f32_16x16x32_bf16 v[84:87], a[220:223], a[172:175], v[84:87]
  v_cvt_pk_bf16_f32 v32, v32, v33
  v_mfma_f32_16x16x32_bf16 v[92:95], a[208:211], a[176:179], v[140:143]
  v_exp_f32 v34, v34
  v_mfma_f32_16x16x32_bf16 v[92:95], a[212:215], a[180:183], v[92:95]
  ds_read_b128 a[208:211], v160 offset:61440
  v_mfma_f32_16x16x32_bf16 v[92:95], a[216:219], a[184:187], v[92:95]
  v_exp_f32 v35, v35
  v_mfma_f32_16x16x32_bf16 v[92:95], a[220:223], a[188:191], v[92:95]
  v_cvt_pk_bf16_f32 v33, v34, v35
  s_waitcnt lgkmcnt(1)
  v_mfma_f32_16x16x32_bf16 v[96:99], a[192:195], a[128:131], v[128:131]
  v_exp_f32 v36, v36
  v_mfma_f32_16x16x32_bf16 v[96:99], a[196:199], a[132:135], v[96:99]
  ds_read_b128 a[212:215], v161 offset:61440
  v_mfma_f32_16x16x32_bf16 v[96:99], a[200:203], a[136:139], v[96:99]
  v_exp_f32 v37, v37
  v_mfma_f32_16x16x32_bf16 v[96:99], a[204:207], a[140:143], v[96:99]
  v_cvt_pk_bf16_f32 v34, v36, v37
  v_mfma_f32_16x16x32_bf16 v[104:107], a[192:195], a[144:147], v[132:135]
  v_exp_f32 v38, v38
  v_mfma_f32_16x16x32_bf16 v[104:107], a[196:199], a[148:151], v[104:107]
  ds_read_b128 a[216:219], v162 offset:61440
  v_mfma_f32_16x16x32_bf16 v[104:107], a[200:203], a[152:155], v[104:107]
  v_exp_f32 v39, v39
  v_mfma_f32_16x16x32_bf16 v[104:107], a[204:207], a[156:159], v[104:107]
  v_cvt_pk_bf16_f32 v35, v38, v39
  v_mfma_f32_16x16x32_bf16 v[112:115], a[192:195], a[160:163], v[136:139]
  v_exp_f32 v40, v40
  v_mfma_f32_16x16x32_bf16 v[112:115], a[196:199], a[164:167], v[112:115]
  ds_read_b128 a[220:223], v163 offset:61440
  v_mfma_f32_16x16x32_bf16 v[112:115], a[200:203], a[168:171], v[112:115]
  v_exp_f32 v41, v41
  v_mfma_f32_16x16x32_bf16 v[112:115], a[204:207], a[172:175], v[112:115]
  v_cvt_pk_bf16_f32 v40, v40, v41
  v_mfma_f32_16x16x32_bf16 v[120:123], a[192:195], a[176:179], v[140:143]
  v_exp_f32 v42, v42
  v_mfma_f32_16x16x32_bf16 v[120:123], a[196:199], a[180:183], v[120:123]
  v_mfma_f32_16x16x32_bf16 v[120:123], a[200:203], a[184:187], v[120:123]
  v_exp_f32 v43, v43
  v_mfma_f32_16x16x32_bf16 v[120:123], a[204:207], a[188:191], v[120:123]
  v_cvt_pk_bf16_f32 v41, v42, v43
  s_waitcnt lgkmcnt(0)
  v_mfma_f32_16x16x32_bf16 v[100:103], a[208:211], a[128:131], v[128:131]
  v_exp_f32 v44, v44
  v_mfma_f32_16x16x32_bf16 v[100:103], a[212:215], a[132:135], v[100:103]
  ds_read_b64_tr_b16 a[224:225], v168 offset:0
  ds_read_b64_tr_b16 a[226:227], v168 offset:4096
  v_mfma_f32_16x16x32_bf16 v[100:103], a[216:219], a[136:139], v[100:103]
  v_exp_f32 v45, v45
  v_mfma_f32_16x16x32_bf16 v[100:103], a[220:223], a[140:143], v[100:103]
  v_cvt_pk_bf16_f32 v42, v44, v45
  v_mfma_f32_16x16x32_bf16 v[108:111], a[208:211], a[144:147], v[132:135]
  v_exp_f32 v46, v46
  v_mfma_f32_16x16x32_bf16 v[108:111], a[212:215], a[148:151], v[108:111]
  ds_read_b64_tr_b16 a[228:229], v169 offset:0
  ds_read_b64_tr_b16 a[230:231], v169 offset:4096
  v_mfma_f32_16x16x32_bf16 v[108:111], a[216:219], a[152:155], v[108:111]
  v_exp_f32 v47, v47
  v_mfma_f32_16x16x32_bf16 v[108:111], a[220:223], a[156:159], v[108:111]
  v_cvt_pk_bf16_f32 v43, v46, v47
  v_mfma_f32_16x16x32_bf16 v[116:119], a[208:211], a[160:163], v[136:139]
  v_exp_f32 v48, v48
  v_mfma_f32_16x16x32_bf16 v[116:119], a[212:215], a[164:167], v[116:119]
  ds_read_b64_tr_b16 a[232:233], v170 offset:0
  ds_read_b64_tr_b16 a[234:235], v170 offset:4096
  v_mfma_f32_16x16x32_bf16 v[116:119], a[216:219], a[168:171], v[116:119]
  v_exp_f32 v49, v49
  v_mfma_f32_16x16x32_bf16 v[116:119], a[220:223], a[172:175], v[116:119]
  v_cvt_pk_bf16_f32 v48, v48, v49
  v_mfma_f32_16x16x32_bf16 v[124:127], a[208:211], a[176:179], v[140:143]
  v_exp_f32 v50, v50
  v_mfma_f32_16x16x32_bf16 v[124:127], a[212:215], a[180:183], v[124:127]
  ds_read_b64_tr_b16 a[236:237], v171 offset:0
  ds_read_b64_tr_b16 a[238:239], v171 offset:4096
  v_mfma_f32_16x16x32_bf16 v[124:127], a[216:219], a[184:187], v[124:127]
  v_exp_f32 v51, v51
  v_mfma_f32_16x16x32_bf16 v[124:127], a[220:223], a[188:191], v[124:127]
  v_cvt_pk_bf16_f32 v49, v50, v51
  s_waitcnt lgkmcnt(4)
  v_mfma_f32_16x16x32_bf16 a[0:3], a[224:227], v[0:3], a[0:3]
  v_exp_f32 v52, v52
  v_mfma_f32_16x16x32_bf16 a[32:35], a[224:227], v[8:11], a[32:35]
  ds_read_b64_tr_b16 a[240:241], v172 offset:0
  ds_read_b64_tr_b16 a[242:243], v172 offset:4096
  v_mfma_f32_16x16x32_bf16 a[64:67], a[224:227], v[16:19], a[64:67]
  v_exp_f32 v53, v53
  v_mfma_f32_16x16x32_bf16 a[96:99], a[224:227], v[24:27], a[96:99]
  v_cvt_pk_bf16_f32 v50, v52, v53
  v_mfma_f32_16x16x32_bf16 a[4:7], a[228:231], v[0:3], a[4:7]
  v_exp_f32 v54, v54
  v_mfma_f32_16x16x32_bf16 a[36:39], a[228:231], v[8:11], a[36:39]
  ds_read_b64_tr_b16 a[244:245], v173 offset:0
  ds_read_b64_tr_b16 a[246:247], v173 offset:4096
  v_mfma_f32_16x16x32_bf16 a[68:71], a[228:231], v[16:19], a[68:71]
  v_exp_f32 v55, v55
  v_mfma_f32_16x16x32_bf16 a[100:103], a[228:231], v[24:27], a[100:103]
  v_cvt_pk_bf16_f32 v51, v54, v55
  s_waitcnt lgkmcnt(4)
  v_mfma_f32_16x16x32_bf16 a[8:11], a[232:235], v[0:3], a[8:11]
  v_exp_f32 v56, v56
  v_mfma_f32_16x16x32_bf16 a[40:43], a[232:235], v[8:11], a[40:43]
  ds_read_b64_tr_b16 a[248:249], v174 offset:0
  ds_read_b64_tr_b16 a[250:251], v174 offset:4096
  v_mfma_f32_16x16x32_bf16 a[72:75], a[232:235], v[16:19], a[72:75]
  v_exp_f32 v57, v57
  v_mfma_f32_16x16x32_bf16 a[104:107], a[232:235], v[24:27], a[104:107]
  v_cvt_pk_bf16_f32 v56, v56, v57
  v_mfma_f32_16x16x32_bf16 a[12:15], a[236:239], v[0:3], a[12:15]
  v_exp_f32 v58, v58
  v_mfma_f32_16x16x32_bf16 a[44:47], a[236:239], v[8:11], a[44:47]
  ds_read_b64_tr_b16 a[252:253], v175 offset:0
  ds_read_b64_tr_b16 a[254:255], v175 offset:4096
  v_mfma_f32_16x16x32_bf16 a[76:79], a[236:239], v[16:19], a[76:79]
  v_exp_f32 v59, v59
  v_mfma_f32_16x16x32_bf16 a[108:111], a[236:239], v[24:27], a[108:111]
  v_cvt_pk_bf16_f32 v57, v58, v59
  s_waitcnt lgkmcnt(4)
  v_mfma_f32_16x16x32_bf16 a[16:19], a[240:243], v[0:3], a[16:19]
  v_exp_f32 v60, v60
  v_mfma_f32_16x16x32_bf16 a[48:51], a[240:243], v[8:11], a[48:51]
  v_mfma_f32_16x16x32_bf16 a[80:83], a[240:243], v[16:19], a[80:83]
  v_exp_f32 v61, v61
  v_mfma_f32_16x16x32_bf16 a[112:115], a[240:243], v[24:27], a[112:115]
  v_cvt_pk_bf16_f32 v58, v60, v61
  v_mfma_f32_16x16x32_bf16 a[20:23], a[244:247], v[0:3], a[20:23]
  v_exp_f32 v62, v62
  v_mfma_f32_16x16x32_bf16 a[52:55], a[244:247], v[8:11], a[52:55]
  ds_read_b64_tr_b16 a[224:225], v168 offset:8192
  ds_read_b64_tr_b16 a[226:227], v168 offset:12288
  v_mfma_f32_16x16x32_bf16 a[84:87], a[244:247], v[16:19], a[84:87]
  v_exp_f32 v63, v63
  v_mfma_f32_16x16x32_bf16 a[116:119], a[244:247], v[24:27], a[116:119]
  v_cvt_pk_bf16_f32 v59, v62, v63
  s_waitcnt lgkmcnt(2)
  v_mfma_f32_16x16x32_bf16 a[24:27], a[248:251], v[0:3], a[24:27]
  v_mfma_f32_16x16x32_bf16 a[56:59], a[248:251], v[8:11], a[56:59]
  ds_read_b64_tr_b16 a[228:229], v169 offset:8192
  ds_read_b64_tr_b16 a[230:231], v169 offset:12288
  v_mfma_f32_16x16x32_bf16 a[88:91], a[248:251], v[16:19], a[88:91]
  v_mfma_f32_16x16x32_bf16 a[120:123], a[248:251], v[24:27], a[120:123]
  v_mfma_f32_16x16x32_bf16 a[28:31], a[252:255], v[0:3], a[28:31]
  s_waitcnt vmcnt(12)
  s_barrier
  v_mfma_f32_16x16x32_bf16 a[60:63], a[252:255], v[8:11], a[60:63]
  ds_read_b64_tr_b16 a[232:233], v170 offset:8192
  ds_read_b64_tr_b16 a[234:235], v170 offset:12288
  v_mfma_f32_16x16x32_bf16 a[92:95], a[252:255], v[16:19], a[92:95]
  s_add_u32 m0, s35, 65536
  v_mfma_f32_16x16x32_bf16 a[124:127], a[252:255], v[24:27], a[124:127]
  s_waitcnt lgkmcnt(4)
  v_mfma_f32_16x16x32_bf16 v[144:147], v[164:167], v[0:3], v[144:147]
  v_exp_f32 v64, v64
  v_mfma_f32_16x16x32_bf16 v[148:151], v[164:167], v[8:11], v[148:151]
  ds_read_b64_tr_b16 a[236:237], v171 offset:8192
  ds_read_b64_tr_b16 a[238:239], v171 offset:12288
  v_mfma_f32_16x16x32_bf16 v[152:155], v[164:167], v[16:19], v[152:155]
  v_exp_f32 v65, v65
  v_mfma_f32_16x16x32_bf16 v[156:159], v[164:167], v[24:27], v[156:159]
  v_cvt_pk_bf16_f32 v64, v64, v65
  v_mfma_f32_16x16x32_bf16 a[0:3], a[224:227], v[32:35], a[0:3]
  v_exp_f32 v66, v66
  v_mfma_f32_16x16x32_bf16 a[32:35], a[224:227], v[40:43], a[32:35]
  ds_read_b64_tr_b16 a[240:241], v172 offset:8192
  ds_read_b64_tr_b16 a[242:243], v172 offset:12288
  buffer_load_dwordx4 v180, s[8:11], s37 offen offset:0 lds
  v_mfma_f32_16x16x32_bf16 a[64:67], a[224:227], v[48:51], a[64:67]
  v_exp_f32 v67, v67
  v_mfma_f32_16x16x32_bf16 a[96:99], a[224:227], v[56:59], a[96:99]
  v_cvt_pk_bf16_f32 v65, v66, v67
  s_waitcnt lgkmcnt(4)
  v_mfma_f32_16x16x32_bf16 a[4:7], a[228:231], v[32:35], a[4:7]
  v_exp_f32 v68, v68
  v_mfma_f32_16x16x32_bf16 a[36:39], a[228:231], v[40:43], a[36:39]
  ds_read_b64_tr_b16 a[244:245], v173 offset:8192
  ds_read_b64_tr_b16 a[246:247], v173 offset:12288
  v_mfma_f32_16x16x32_bf16 a[68:71], a[228:231], v[48:51], a[68:71]
  v_exp_f32 v69, v69
  v_mfma_f32_16x16x32_bf16 a[100:103], a[228:231], v[56:59], a[100:103]
  v_cvt_pk_bf16_f32 v66, v68, v69
  v_mfma_f32_16x16x32_bf16 a[8:11], a[232:235], v[32:35], a[8:11]
  v_exp_f32 v70, v70
  v_mfma_f32_16x16x32_bf16 a[40:43], a[232:235], v[40:43], a[40:43]
  ds_read_b64_tr_b16 a[248:249], v174 offset:8192
  ds_read_b64_tr_b16 a[250:251], v174 offset:12288
  buffer_load_dwordx4 v181, s[8:11], s37 offen offset:1024 lds
  v_mfma_f32_16x16x32_bf16 a[72:75], a[232:235], v[48:51], a[72:75]
  v_exp_f32 v71, v71
  v_mfma_f32_16x16x32_bf16 a[104:107], a[232:235], v[56:59], a[104:107]
  v_cvt_pk_bf16_f32 v67, v70, v71
  s_waitcnt lgkmcnt(4)
  v_mfma_f32_16x16x32_bf16 a[12:15], a[236:239], v[32:35], a[12:15]
  v_exp_f32 v72, v72
  v_mfma_f32_16x16x32_bf16 a[44:47], a[236:239], v[40:43], a[44:47]
  ds_read_b64_tr_b16 a[252:253], v175 offset:8192
  ds_read_b64_tr_b16 a[254:255], v175 offset:12288
  v_mfma_f32_16x16x32_bf16 a[76:79], a[236:239], v[48:51], a[76:79]
  v_exp_f32 v73, v73
  v_mfma_f32_16x16x32_bf16 a[108:111], a[236:239], v[56:59], a[108:111]
  v_cvt_pk_bf16_f32 v72, v72, v73
  v_mfma_f32_16x16x32_bf16 a[16:19], a[240:243], v[32:35], a[16:19]
  v_exp_f32 v74, v74
  v_mfma_f32_16x16x32_bf16 a[48:51], a[240:243], v[40:43], a[48:51]
  ds_read_b128 a[192:195], v160 offset:0
  buffer_load_dwordx4 v180, s[8:11], s37 offen offset:2048 lds
  v_mfma_f32_16x16x32_bf16 a[80:83], a[240:243], v[48:51], a[80:83]
  v_exp_f32 v75, v75
  v_mfma_f32_16x16x32_bf16 a[112:115], a[240:243], v[56:59], a[112:115]
  v_cvt_pk_bf16_f32 v73, v74, v75
  s_waitcnt lgkmcnt(3)
  v_mfma_f32_16x16x32_bf16 a[20:23], a[244:247], v[32:35], a[20:23]
  v_exp_f32 v76, v76
  v_mfma_f32_16x16x32_bf16 a[52:55], a[244:247], v[40:43], a[52:55]
  ds_read_b128 a[196:199], v161 offset:0
  v_mfma_f32_16x16x32_bf16 a[84:87], a[244:247], v[48:51], a[84:87]
  v_exp_f32 v77, v77
  v_mfma_f32_16x16x32_bf16 a[116:119], a[244:247], v[56:59], a[116:119]
  v_cvt_pk_bf16_f32 v74, v76, v77
  v_mfma_f32_16x16x32_bf16 a[24:27], a[248:251], v[32:35], a[24:27]
  v_exp_f32 v78, v78
  v_mfma_f32_16x16x32_bf16 a[56:59], a[248:251], v[40:43], a[56:59]
  ds_read_b128 a[200:203], v162 offset:0
  buffer_load_dwordx4 v181, s[8:11], s37 offen offset:3072 lds
  v_mfma_f32_16x16x32_bf16 a[88:91], a[248:251], v[48:51], a[88:91]
  v_exp_f32 v79, v79
  v_mfma_f32_16x16x32_bf16 a[120:123], a[248:251], v[56:59], a[120:123]
  v_cvt_pk_bf16_f32 v75, v78, v79
  s_add_u32 s37, s37, 16384
  s_waitcnt lgkmcnt(3)
  v_mfma_f32_16x16x32_bf16 a[28:31], a[252:255], v[32:35], a[28:31]
  v_exp_f32 v80, v80
  v_mfma_f32_16x16x32_bf16 a[60:63], a[252:255], v[40:43], a[60:63]
  ds_read_b128 a[204:207], v163 offset:0
  v_mfma_f32_16x16x32_bf16 a[92:95], a[252:255], v[48:51], a[92:95]
  v_exp_f32 v81, v81
  v_mfma_f32_16x16x32_bf16 a[124:127], a[252:255], v[56:59], a[124:127]
  v_cvt_pk_bf16_f32 v80, v80, v81
  s_mov_b32 m0, s35
  v_mfma_f32_16x16x32_bf16 v[144:147], v[164:167], v[32:35], v[144:147]
  v_exp_f32 v82, v82
  v_mfma_f32_16x16x32_bf16 v[148:151], v[164:167], v[40:43], v[148:151]
  ds_read_b128 a[208:211], v160 offset:4096
  buffer_load_dwordx4 v176, s[4:7], s36 offen offset:0 lds
  v_mfma_f32_16x16x32_bf16 v[152:155], v[164:167], v[48:51], v[152:155]
  v_exp_f32 v83, v83
  v_mfma_f32_16x16x32_bf16 v[156:159], v[164:167], v[56:59], v[156:159]
  v_cvt_pk_bf16_f32 v81, v82, v83
  s_waitcnt lgkmcnt(1)
  v_mfma_f32_16x16x32_bf16 v[0:3], a[192:195], a[128:131], v[128:131]
  v_exp_f32 v84, v84
  v_mfma_f32_16x16x32_bf16 v[0:3], a[196:199], a[132:135], v[0:3]
  ds_read_b128 a[212:215], v161 offset:4096
  v_mfma_f32_16x16x32_bf16 v[0:3], a[200:203], a[136:139], v[0:3]
  v_exp_f32 v85, v85
  v_mfma_f32_16x16x32_bf16 v[0:3], a[204:207], a[140:143], v[0:3]
  v_cvt_pk_bf16_f32 v82, v84, v85
  v_mfma_f32_16x16x32_bf16 v[8:11], a[192:195], a[144:147], v[132:135]
  v_exp_f32 v86, v86
  v_mfma_f32_16x16x32_bf16 v[8:11], a[196:199], a[148:151], v[8:11]
  ds_read_b128 a[216:219], v162 offset:4096
  buffer_load_dwordx4 v177, s[4:7], s36 offen offset:1024 lds
  v_mfma_f32_16x16x32_bf16 v[8:11], a[200:203], a[152:155], v[8:11]
  v_exp_f32 v87, v87
  v_mfma_f32_16x16x32_bf16 v[8:11], a[204:207], a[156:159], v[8:11]
  v_cvt_pk_bf16_f32 v83, v86, v87
  v_mfma_f32_16x16x32_bf16 v[16:19], a[192:195], a[160:163], v[136:139]
  v_exp_f32 v88, v88
  v_mfma_f32_16x16x32_bf16 v[16:19], a[196:199], a[164:167], v[16:19]
  ds_read_b128 a[220:223], v163 offset:4096
  v_mfma_f32_16x16x32_bf16 v[16:19], a[200:203], a[168:171], v[16:19]
  v_exp_f32 v89, v89
  v_mfma_f32_16x16x32_bf16 v[16:19], a[204:207], a[172:175], v[16:19]
  v_cvt_pk_bf16_f32 v88, v88, v89
  v_mfma_f32_16x16x32_bf16 v[24:27], a[192:195], a[176:179], v[140:143]
  v_exp_f32 v90, v90
  v_mfma_f32_16x16x32_bf16 v[24:27], a[196:199], a[180:183], v[24:27]
  ds_read_b128 a[192:195], v160 offset:8192
  buffer_load_dwordx4 v178, s[4:7], s36 offen offset:2048 lds
  v_mfma_f32_16x16x32_bf16 v[24:27], a[200:203], a[184:187], v[24:27]
  v_exp_f32 v91, v91
  v_mfma_f32_16x16x32_bf16 v[24:27], a[204:207], a[188:191], v[24:27]
  v_cvt_pk_bf16_f32 v89, v90, v91
  s_waitcnt lgkmcnt(1)
  v_mfma_f32_16x16x32_bf16 v[4:7], a[208:211], a[128:131], v[128:131]
  v_exp_f32 v92, v92
  v_mfma_f32_16x16x32_bf16 v[4:7], a[212:215], a[132:135], v[4:7]
  ds_read_b128 a[196:199], v161 offset:8192
  v_mfma_f32_16x16x32_bf16 v[4:7], a[216:219], a[136:139], v[4:7]
  v_exp_f32 v93, v93
  v_mfma_f32_16x16x32_bf16 v[4:7], a[220:223], a[140:143], v[4:7]
  v_cvt_pk_bf16_f32 v90, v92, v93
  v_mfma_f32_16x16x32_bf16 v[12:15], a[208:211], a[144:147], v[132:135]
  v_exp_f32 v94, v94
  v_mfma_f32_16x16x32_bf16 v[12:15], a[212:215], a[148:151], v[12:15]
  ds_read_b128 a[200:203], v162 offset:8192
  buffer_load_dwordx4 v179, s[4:7], s36 offen offset:3072 lds
  v_mfma_f32_16x16x32_bf16 v[12:15], a[216:219], a[152:155], v[12:15]
  v_exp_f32 v95, v95
  v_mfma_f32_16x16x32_bf16 v[12:15], a[220:223], a[156:159], v[12:15]
  v_cvt_pk_bf16_f32 v91, v94, v95
  s_add_u32 s36, s36, 16384
  v_mfma_f32_16x16x32_bf16 v[20:23], a[208:211], a[160:163], v[136:139]
  v_exp_f32 v96, v96
  v_mfma_f32_16x16x32_bf16 v[20:23], a[212:215], a[164:167], v[20:23]
  ds_read_b128 a[204:207], v163 offset:8192
  v_mfma_f32_16x16x32_bf16 v[20:23], a[216:219], a[168:171], v[20:23]
  v_exp_f32 v97, v97
  v_mfma_f32_16x16x32_bf16 v[20:23], a[220:223], a[172:175], v[20:23]
  v_cvt_pk_bf16_f32 v96, v96, v97
  v_mfma_f32_16x16x32_bf16 v[28:31], a[208:211], a[176:179], v[140:143]
  v_exp_f32 v98, v98
  v_mfma_f32_16x16x32_bf16 v[28:31], a[212:215], a[180:183], v[28:31]
  ds_read_b128 a[208:211], v160 offset:12288
  v_mfma_f32_16x16x32_bf16 v[28:31], a[216:219], a[184:187], v[28:31]
  v_exp_f32 v99, v99
  v_mfma_f32_16x16x32_bf16 v[28:31], a[220:223], a[188:191], v[28:31]
  v_cvt_pk_bf16_f32 v97, v98, v99
  s_waitcnt lgkmcnt(1)
  v_mfma_f32_16x16x32_bf16 v[32:35], a[192:195], a[128:131], v[128:131]
  v_exp_f32 v100, v100
  v_mfma_f32_16x16x32_bf16 v[32:35], a[196:199], a[132:135], v[32:35]
  ds_read_b128 a[212:215], v161 offset:12288
  v_mfma_f32_16x16x32_bf16 v[32:35], a[200:203], a[136:139], v[32:35]
  v_exp_f32 v101, v101
  v_mfma_f32_16x16x32_bf16 v[32:35], a[204:207], a[140:143], v[32:35]
  v_cvt_pk_bf16_f32 v98, v100, v101
  v_mfma_f32_16x16x32_bf16 v[40:43], a[192:195], a[144:147], v[132:135]
  v_exp_f32 v102, v102
  v_mfma_f32_16x16x32_bf16 v[40:43], a[196:199], a[148:151], v[40:43]
  ds_read_b128 a[216:219], v162 offset:12288
  v_mfma_f32_16x16x32_bf16 v[40:43], a[200:203], a[152:155], v[40:43]
  v_exp_f32 v103, v103
  v_mfma_f32_16x16x32_bf16 v[40:43], a[204:207], a[156:159], v[40:43]
  v_cvt_pk_bf16_f32 v99, v102, v103
  v_mfma_f32_16x16x32_bf16 v[48:51], a[192:195], a[160:163], v[136:139]
  v_exp_f32 v104, v104
  v_mfma_f32_16x16x32_bf16 v[48:51], a[196:199], a[164:167], v[48:51]
  ds_read_b128 a[220:223], v163 offset:12288
  v_mfma_f32_16x16x32_bf16 v[48:51], a[200:203], a[168:171], v[48:51]
  v_exp_f32 v105, v105
  v_mfma_f32_16x16x32_bf16 v[48:51], a[204:207], a[172:175], v[48:51]
  v_cvt_pk_bf16_f32 v104, v104, v105
  v_mfma_f32_16x16x32_bf16 v[56:59], a[192:195], a[176:179], v[140:143]
  v_exp_f32 v106, v106
  v_mfma_f32_16x16x32_bf16 v[56:59], a[196:199], a[180:183], v[56:59]
  v_mfma_f32_16x16x32_bf16 v[56:59], a[200:203], a[184:187], v[56:59]
  v_exp_f32 v107, v107
  v_mfma_f32_16x16x32_bf16 v[56:59], a[204:207], a[188:191], v[56:59]
  v_cvt_pk_bf16_f32 v105, v106, v107
  s_waitcnt lgkmcnt(0)
  v_mfma_f32_16x16x32_bf16 v[36:39], a[208:211], a[128:131], v[128:131]
  v_exp_f32 v108, v108
  v_mfma_f32_16x16x32_bf16 v[36:39], a[212:215], a[132:135], v[36:39]
  ds_read_b64_tr_b16 a[224:225], v168 offset:16384
  ds_read_b64_tr_b16 a[226:227], v168 offset:20480
  v_mfma_f32_16x16x32_bf16 v[36:39], a[216:219], a[136:139], v[36:39]
  v_exp_f32 v109, v109
  v_mfma_f32_16x16x32_bf16 v[36:39], a[220:223], a[140:143], v[36:39]
  v_cvt_pk_bf16_f32 v106, v108, v109
  v_mfma_f32_16x16x32_bf16 v[44:47], a[208:211], a[144:147], v[132:135]
  v_exp_f32 v110, v110
  v_mfma_f32_16x16x32_bf16 v[44:47], a[212:215], a[148:151], v[44:47]
  ds_read_b64_tr_b16 a[228:229], v169 offset:16384
  ds_read_b64_tr_b16 a[230:231], v169 offset:20480
  v_mfma_f32_16x16x32_bf16 v[44:47], a[216:219], a[152:155], v[44:47]
  v_exp_f32 v111, v111
  v_mfma_f32_16x16x32_bf16 v[44:47], a[220:223], a[156:159], v[44:47]
  v_cvt_pk_bf16_f32 v107, v110, v111
  v_mfma_f32_16x16x32_bf16 v[52:55], a[208:211], a[160:163], v[136:139]
  v_exp_f32 v112, v112
  v_mfma_f32_16x16x32_bf16 v[52:55], a[212:215], a[164:167], v[52:55]
  ds_read_b64_tr_b16 a[232:233], v170 offset:16384
  ds_read_b64_tr_b16 a[234:235], v170 offset:20480
  v_mfma_f32_16x16x32_bf16 v[52:55], a[216:219], a[168:171], v[52:55]
  v_exp_f32 v113, v113
  v_mfma_f32_16x16x32_bf16 v[52:55], a[220:223], a[172:175], v[52:55]
  v_cvt_pk_bf16_f32 v112, v112, v113
  v_mfma_f32_16x16x32_bf16 v[60:63], a[208:211], a[176:179], v[140:143]
  v_exp_f32 v114, v114
  v_mfma_f32_16x16x32_bf16 v[60:63], a[212:215], a[180:183], v[60:63]
  ds_read_b64_tr_b16 a[236:237], v171 offset:16384
  ds_read_b64_tr_b16 a[238:239], v171 offset:20480
  v_mfma_f32_16x16x32_bf16 v[60:63], a[216:219], a[184:187], v[60:63]
  v_exp_f32 v115, v115
  v_mfma_f32_16x16x32_bf16 v[60:63], a[220:223], a[188:191], v[60:63]
  v_cvt_pk_bf16_f32 v113, v114, v115
  s_waitcnt lgkmcnt(4)
  v_mfma_f32_16x16x32_bf16 a[0:3], a[224:227], v[64:67], a[0:3]
  v_exp_f32 v116, v116
  v_mfma_f32_16x16x32_bf16 a[32:35], a[224:227], v[72:75], a[32:35]
  ds_read_b64_tr_b16 a[240:241], v172 offset:16384
  ds_read_b64_tr_b16 a[242:243], v172 offset:20480
  v_mfma_f32_16x16x32_bf16 a[64:67], a[224:227], v[80:83], a[64:67]
  v_exp_f32 v117, v117
  v_mfma_f32_16x16x32_bf16 a[96:99], a[224:227], v[88:91], a[96:99]
  v_cvt_pk_bf16_f32 v114, v116, v117
  v_mfma_f32_16x16x32_bf16 a[4:7], a[228:231], v[64:67], a[4:7]
  v_exp_f32 v118, v118
  v_mfma_f32_16x16x32_bf16 a[36:39], a[228:231], v[72:75], a[36:39]
  ds_read_b64_tr_b16 a[244:245], v173 offset:16384
  ds_read_b64_tr_b16 a[246:247], v173 offset:20480
  v_mfma_f32_16x16x32_bf16 a[68:71], a[228:231], v[80:83], a[68:71]
  v_exp_f32 v119, v119
  v_mfma_f32_16x16x32_bf16 a[100:103], a[228:231], v[88:91], a[100:103]
  v_cvt_pk_bf16_f32 v115, v118, v119
  s_waitcnt lgkmcnt(4)
  v_mfma_f32_16x16x32_bf16 a[8:11], a[232:235], v[64:67], a[8:11]
  v_exp_f32 v120, v120
  v_mfma_f32_16x16x32_bf16 a[40:43], a[232:235], v[72:75], a[40:43]
  ds_read_b64_tr_b16 a[248:249], v174 offset:16384
  ds_read_b64_tr_b16 a[250:251], v174 offset:20480
  v_mfma_f32_16x16x32_bf16 a[72:75], a[232:235], v[80:83], a[72:75]
  v_exp_f32 v121, v121
  v_mfma_f32_16x16x32_bf16 a[104:107], a[232:235], v[88:91], a[104:107]
  v_cvt_pk_bf16_f32 v120, v120, v121
  v_mfma_f32_16x16x32_bf16 a[12:15], a[236:239], v[64:67], a[12:15]
  v_exp_f32 v122, v122
  v_mfma_f32_16x16x32_bf16 a[44:47], a[236:239], v[72:75], a[44:47]
  ds_read_b64_tr_b16 a[252:253], v175 offset:16384
  ds_read_b64_tr_b16 a[254:255], v175 offset:20480
  v_mfma_f32_16x16x32_bf16 a[76:79], a[236:239], v[80:83], a[76:79]
  v_exp_f32 v123, v123
  v_mfma_f32_16x16x32_bf16 a[108:111], a[236:239], v[88:91], a[108:111]
  v_cvt_pk_bf16_f32 v121, v122, v123
  s_waitcnt lgkmcnt(4)
  v_mfma_f32_16x16x32_bf16 a[16:19], a[240:243], v[64:67], a[16:19]
  v_exp_f32 v124, v124
  v_mfma_f32_16x16x32_bf16 a[48:51], a[240:243], v[72:75], a[48:51]
  v_mfma_f32_16x16x32_bf16 a[80:83], a[240:243], v[80:83], a[80:83]
  v_exp_f32 v125, v125
  v_mfma_f32_16x16x32_bf16 a[112:115], a[240:243], v[88:91], a[112:115]
  v_cvt_pk_bf16_f32 v122, v124, v125
  v_mfma_f32_16x16x32_bf16 a[20:23], a[244:247], v[64:67], a[20:23]
  v_exp_f32 v126, v126
  v_mfma_f32_16x16x32_bf16 a[52:55], a[244:247], v[72:75], a[52:55]
  ds_read_b64_tr_b16 a[224:225], v168 offset:24576
  ds_read_b64_tr_b16 a[226:227], v168 offset:28672
  v_mfma_f32_16x16x32_bf16 a[84:87], a[244:247], v[80:83], a[84:87]
  v_exp_f32 v127, v127
  v_mfma_f32_16x16x32_bf16 a[116:119], a[244:247], v[88:91], a[116:119]
  v_cvt_pk_bf16_f32 v123, v126, v127
  s_waitcnt lgkmcnt(2)
  v_mfma_f32_16x16x32_bf16 a[24:27], a[248:251], v[64:67], a[24:27]
  v_mfma_f32_16x16x32_bf16 a[56:59], a[248:251], v[72:75], a[56:59]
  ds_read_b64_tr_b16 a[228:229], v169 offset:24576
  ds_read_b64_tr_b16 a[230:231], v169 offset:28672
  v_mfma_f32_16x16x32_bf16 a[88:91], a[248:251], v[80:83], a[88:91]
  v_mfma_f32_16x16x32_bf16 a[120:123], a[248:251], v[88:91], a[120:123]
  v_mfma_f32_16x16x32_bf16 a[28:31], a[252:255], v[64:67], a[28:31]
  s_waitcnt vmcnt(12)
  s_barrier
  v_mfma_f32_16x16x32_bf16 a[60:63], a[252:255], v[72:75], a[60:63]
  ds_read_b64_tr_b16 a[232:233], v170 offset:24576
  ds_read_b64_tr_b16 a[234:235], v170 offset:28672
  v_mfma_f32_16x16x32_bf16 a[92:95], a[252:255], v[80:83], a[92:95]
  s_add_u32 m0, s32, 65536
  v_mfma_f32_16x16x32_bf16 a[124:127], a[252:255], v[88:91], a[124:127]
  s_waitcnt lgkmcnt(4)
  v_mfma_f32_16x16x32_bf16 v[144:147], v[164:167], v[64:67], v[144:147]
  v_exp_f32 v0, v0
  v_mfma_f32_16x16x32_bf16 v[148:151], v[164:167], v[72:75], v[148:151]
  ds_read_b64_tr_b16 a[236:237], v171 offset:24576
  ds_read_b64_tr_b16 a[238:239], v171 offset:28672
  v_mfma_f32_16x16x32_bf16 v[152:155], v[164:167], v[80:83], v[152:155]
  v_exp_f32 v1, v1
  v_mfma_f32_16x16x32_bf16 v[156:159], v[164:167], v[88:91], v[156:159]
  v_cvt_pk_bf16_f32 v0, v0, v1
  v_mfma_f32_16x16x32_bf16 a[0:3], a[224:227], v[96:99], a[0:3]
  v_exp_f32 v2, v2
  v_mfma_f32_16x16x32_bf16 a[32:35], a[224:227], v[104:107], a[32:35]
  ds_read_b64_tr_b16 a[240:241], v172 offset:24576
  ds_read_b64_tr_b16 a[242:243], v172 offset:28672
  buffer_load_dwordx4 v180, s[8:11], s37 offen offset:0 lds
  v_mfma_f32_16x16x32_bf16 a[64:67], a[224:227], v[112:115], a[64:67]
  v_exp_f32 v3, v3
  v_mfma_f32_16x16x32_bf16 a[96:99], a[224:227], v[120:123], a[96:99]
  v_cvt_pk_bf16_f32 v1, v2, v3
  s_waitcnt lgkmcnt(4)
  v_mfma_f32_16x16x32_bf16 a[4:7], a[228:231], v[96:99], a[4:7]
  v_exp_f32 v4, v4
  v_mfma_f32_16x16x32_bf16 a[36:39], a[228:231], v[104:107], a[36:39]
  ds_read_b64_tr_b16 a[244:245], v173 offset:24576
  ds_read_b64_tr_b16 a[246:247], v173 offset:28672
  v_mfma_f32_16x16x32_bf16 a[68:71], a[228:231], v[112:115], a[68:71]
  v_exp_f32 v5, v5
  v_mfma_f32_16x16x32_bf16 a[100:103], a[228:231], v[120:123], a[100:103]
  v_cvt_pk_bf16_f32 v2, v4, v5
  v_mfma_f32_16x16x32_bf16 a[8:11], a[232:235], v[96:99], a[8:11]
  v_exp_f32 v6, v6
  v_mfma_f32_16x16x32_bf16 a[40:43], a[232:235], v[104:107], a[40:43]
  ds_read_b64_tr_b16 a[248:249], v174 offset:24576
  ds_read_b64_tr_b16 a[250:251], v174 offset:28672
  buffer_load_dwordx4 v181, s[8:11], s37 offen offset:1024 lds
  v_mfma_f32_16x16x32_bf16 a[72:75], a[232:235], v[112:115], a[72:75]
  v_exp_f32 v7, v7
  v_mfma_f32_16x16x32_bf16 a[104:107], a[232:235], v[120:123], a[104:107]
  v_cvt_pk_bf16_f32 v3, v6, v7
  s_waitcnt lgkmcnt(4)
  v_mfma_f32_16x16x32_bf16 a[12:15], a[236:239], v[96:99], a[12:15]
  v_exp_f32 v8, v8
  v_mfma_f32_16x16x32_bf16 a[44:47], a[236:239], v[104:107], a[44:47]
  ds_read_b64_tr_b16 a[252:253], v175 offset:24576
  ds_read_b64_tr_b16 a[254:255], v175 offset:28672
  v_mfma_f32_16x16x32_bf16 a[76:79], a[236:239], v[112:115], a[76:79]
  v_exp_f32 v9, v9
  v_mfma_f32_16x16x32_bf16 a[108:111], a[236:239], v[120:123], a[108:111]
  v_cvt_pk_bf16_f32 v8, v8, v9
  v_mfma_f32_16x16x32_bf16 a[16:19], a[240:243], v[96:99], a[16:19]
  v_exp_f32 v10, v10
  v_mfma_f32_16x16x32_bf16 a[48:51], a[240:243], v[104:107], a[48:51]
  ds_read_b128 a[192:195], v160 offset:16384
  buffer_load_dwordx4 v180, s[8:11], s37 offen offset:2048 lds
  v_mfma_f32_16x16x32_bf16 a[80:83], a[240:243], v[112:115], a[80:83]
  v_exp_f32 v11, v11
  v_mfma_f32_16x16x32_bf16 a[112:115], a[240:243], v[120:123], a[112:115]
  v_cvt_pk_bf16_f32 v9, v10, v11
  s_waitcnt lgkmcnt(3)
  v_mfma_f32_16x16x32_bf16 a[20:23], a[244:247], v[96:99], a[20:23]
  v_exp_f32 v12, v12
  v_mfma_f32_16x16x32_bf16 a[52:55], a[244:247], v[104:107], a[52:55]
  ds_read_b128 a[196:199], v161 offset:16384
  v_mfma_f32_16x16x32_bf16 a[84:87], a[244:247], v[112:115], a[84:87]
  v_exp_f32 v13, v13
  v_mfma_f32_16x16x32_bf16 a[116:119], a[244:247], v[120:123], a[116:119]
  v_cvt_pk_bf16_f32 v10, v12, v13
  v_mfma_f32_16x16x32_bf16 a[24:27], a[248:251], v[96:99], a[24:27]
  v_exp_f32 v14, v14
  v_mfma_f32_16x16x32_bf16 a[56:59], a[248:251], v[104:107], a[56:59]
  ds_read_b128 a[200:203], v162 offset:16384
  buffer_load_dwordx4 v181, s[8:11], s37 offen offset:3072 lds
  v_mfma_f32_16x16x32_bf16 a[88:91], a[248:251], v[112:115], a[88:91]
  v_exp_f32 v15, v15
  v_mfma_f32_16x16x32_bf16 a[120:123], a[248:251], v[120:123], a[120:123]
  v_cvt_pk_bf16_f32 v11, v14, v15
  s_add_u32 s37, s37, 16384
  s_waitcnt lgkmcnt(3)
  v_mfma_f32_16x16x32_bf16 a[28:31], a[252:255], v[96:99], a[28:31]
  v_exp_f32 v16, v16
  v_mfma_f32_16x16x32_bf16 a[60:63], a[252:255], v[104:107], a[60:63]
  ds_read_b128 a[204:207], v163 offset:16384
  v_mfma_f32_16x16x32_bf16 a[92:95], a[252:255], v[112:115], a[92:95]
  v_exp_f32 v17, v17
  v_mfma_f32_16x16x32_bf16 a[124:127], a[252:255], v[120:123], a[124:127]
  v_cvt_pk_bf16_f32 v16, v16, v17
  s_mov_b32 m0, s32
  v_mfma_f32_16x16x32_bf16 v[144:147], v[164:167], v[96:99], v[144:147]
  v_exp_f32 v18, v18
  v_mfma_f32_16x16x32_bf16 v[148:151], v[164:167], v[104:107], v[148:151]
  ds_read_b128 a[208:211], v160 offset:20480
  buffer_load_dwordx4 v176, s[4:7], s36 offen offset:0 lds
  v_mfma_f32_16x16x32_bf16 v[152:155], v[164:167], v[112:115], v[152:155]
  v_exp_f32 v19, v19
  v_mfma_f32_16x16x32_bf16 v[156:159], v[164:167], v[120:123], v[156:159]
  v_cvt_pk_bf16_f32 v17, v18, v19
  s_waitcnt lgkmcnt(1)
  v_mfma_f32_16x16x32_bf16 v[64:67], a[192:195], a[128:131], v[128:131]
  v_exp_f32 v20, v20
  v_mfma_f32_16x16x32_bf16 v[64:67], a[196:199], a[132:135], v[64:67]
  ds_read_b128 a[212:215], v161 offset:20480
  v_mfma_f32_16x16x32_bf16 v[64:67], a[200:203], a[136:139], v[64:67]
  v_exp_f32 v21, v21
  v_mfma_f32_16x16x32_bf16 v[64:67], a[204:207], a[140:143], v[64:67]
  v_cvt_pk_bf16_f32 v18, v20, v21
  v_mfma_f32_16x16x32_bf16 v[72:75], a[192:195], a[144:147], v[132:135]
  v_exp_f32 v22, v22
  v_mfma_f32_16x16x32_bf16 v[72:75], a[196:199], a[148:151], v[72:75]
  ds_read_b128 a[216:219], v162 offset:20480
  buffer_load_dwordx4 v177, s[4:7], s36 offen offset:1024 lds
  v_mfma_f32_16x16x32_bf16 v[72:75], a[200:203], a[152:155], v[72:75]
  v_exp_f32 v23, v23
  v_mfma_f32_16x16x32_bf16 v[72:75], a[204:207], a[156:159], v[72:75]
  v_cvt_pk_bf16_f32 v19, v22, v23
  v_mfma_f32_16x16x32_bf16 v[80:83], a[192:195], a[160:163], v[136:139]
  v_exp_f32 v24, v24
  v_mfma_f32_16x16x32_bf16 v[80:83], a[196:199], a[164:167], v[80:83]
  ds_read_b128 a[220:223], v163 offset:20480
  v_mfma_f32_16x16x32_bf16 v[80:83], a[200:203], a[168:171], v[80:83]
  v_exp_f32 v25, v25
  v_mfma_f32_16x16x32_bf16 v[80:83], a[204:207], a[172:175], v[80:83]
  v_cvt_pk_bf16_f32 v24, v24, v25
  v_mfma_f32_16x16x32_bf16 v[88:91], a[192:195], a[176:179], v[140:143]
  v_exp_f32 v26, v26
  v_mfma_f32_16x16x32_bf16 v[88:91], a[196:199], a[180:183], v[88:91]
  ds_read_b128 a[192:195], v160 offset:24576
  buffer_load_dwordx4 v178, s[4:7], s36 offen offset:2048 lds
  v_mfma_f32_16x16x32_bf16 v[88:91], a[200:203], a[184:187], v[88:91]
  v_exp_f32 v27, v27
  v_mfma_f32_16x16x32_bf16 v[88:91], a[204:207], a[188:191], v[88:91]
  v_cvt_pk_bf16_f32 v25, v26, v27
  s_waitcnt lgkmcnt(1)
  v_mfma_f32_16x16x32_bf16 v[68:71], a[208:211], a[128:131], v[128:131]
  v_exp_f32 v28, v28
  v_mfma_f32_16x16x32_bf16 v[68:71], a[212:215], a[132:135], v[68:71]
  ds_read_b128 a[196:199], v161 offset:24576
  v_mfma_f32_16x16x32_bf16 v[68:71], a[216:219], a[136:139], v[68:71]
  v_exp_f32 v29, v29
  v_mfma_f32_16x16x32_bf16 v[68:71], a[220:223], a[140:143], v[68:71]
  v_cvt_pk_bf16_f32 v26, v28, v29
  v_mfma_f32_16x16x32_bf16 v[76:79], a[208:211], a[144:147], v[132:135]
  v_exp_f32 v30, v30
  v_mfma_f32_16x16x32_bf16 v[76:79], a[212:215], a[148:151], v[76:79]
  ds_read_b128 a[200:203], v162 offset:24576
  buffer_load_dwordx4 v179, s[4:7], s36 offen offset:3072 lds
  v_mfma_f32_16x16x32_bf16 v[76:79], a[216:219], a[152:155], v[76:79]
  v_exp_f32 v31, v31
  v_mfma_f32_16x16x32_bf16 v[76:79], a[220:223], a[156:159], v[76:79]
  v_cvt_pk_bf16_f32 v27, v30, v31
  s_add_u32 s36, s36, 16384
  v_mfma_f32_16x16x32_bf16 v[84:87], a[208:211], a[160:163], v[136:139]
  v_exp_f32 v32, v32
  v_mfma_f32_16x16x32_bf16 v[84:87], a[212:215], a[164:167], v[84:87]
  ds_read_b128 a[204:207], v163 offset:24576
  v_mfma_f32_16x16x32_bf16 v[84:87], a[216:219], a[168:171], v[84:87]
  v_exp_f32 v33, v33
  v_mfma_f32_16x16x32_bf16 v[84:87], a[220:223], a[172:175], v[84:87]
  v_cvt_pk_bf16_f32 v32, v32, v33
  v_mfma_f32_16x16x32_bf16 v[92:95], a[208:211], a[176:179], v[140:143]
  v_exp_f32 v34, v34
  v_mfma_f32_16x16x32_bf16 v[92:95], a[212:215], a[180:183], v[92:95]
  ds_read_b128 a[208:211], v160 offset:28672
  v_mfma_f32_16x16x32_bf16 v[92:95], a[216:219], a[184:187], v[92:95]
  v_exp_f32 v35, v35
  v_mfma_f32_16x16x32_bf16 v[92:95], a[220:223], a[188:191], v[92:95]
  v_cvt_pk_bf16_f32 v33, v34, v35
  s_waitcnt lgkmcnt(1)
  v_mfma_f32_16x16x32_bf16 v[96:99], a[192:195], a[128:131], v[128:131]
  v_exp_f32 v36, v36
  v_mfma_f32_16x16x32_bf16 v[96:99], a[196:199], a[132:135], v[96:99]
  ds_read_b128 a[212:215], v161 offset:28672
  v_mfma_f32_16x16x32_bf16 v[96:99], a[200:203], a[136:139], v[96:99]
  v_exp_f32 v37, v37
  v_mfma_f32_16x16x32_bf16 v[96:99], a[204:207], a[140:143], v[96:99]
  v_cvt_pk_bf16_f32 v34, v36, v37
  v_mfma_f32_16x16x32_bf16 v[104:107], a[192:195], a[144:147], v[132:135]
  v_exp_f32 v38, v38
  v_mfma_f32_16x16x32_bf16 v[104:107], a[196:199], a[148:151], v[104:107]
  ds_read_b128 a[216:219], v162 offset:28672
  v_mfma_f32_16x16x32_bf16 v[104:107], a[200:203], a[152:155], v[104:107]
  v_exp_f32 v39, v39
  v_mfma_f32_16x16x32_bf16 v[104:107], a[204:207], a[156:159], v[104:107]
  v_cvt_pk_bf16_f32 v35, v38, v39
  v_mfma_f32_16x16x32_bf16 v[112:115], a[192:195], a[160:163], v[136:139]
  v_exp_f32 v40, v40
  v_mfma_f32_16x16x32_bf16 v[112:115], a[196:199], a[164:167], v[112:115]
  ds_read_b128 a[220:223], v163 offset:28672
  v_mfma_f32_16x16x32_bf16 v[112:115], a[200:203], a[168:171], v[112:115]
  v_exp_f32 v41, v41
  v_mfma_f32_16x16x32_bf16 v[112:115], a[204:207], a[172:175], v[112:115]
  v_cvt_pk_bf16_f32 v40, v40, v41
  v_mfma_f32_16x16x32_bf16 v[120:123], a[192:195], a[176:179], v[140:143]
  v_exp_f32 v42, v42
  v_mfma_f32_16x16x32_bf16 v[120:123], a[196:199], a[180:183], v[120:123]
  v_mfma_f32_16x16x32_bf16 v[120:123], a[200:203], a[184:187], v[120:123]
  v_exp_f32 v43, v43
  v_mfma_f32_16x16x32_bf16 v[120:123], a[204:207], a[188:191], v[120:123]
  v_cvt_pk_bf16_f32 v41, v42, v43
  s_waitcnt lgkmcnt(0)
  v_mfma_f32_16x16x32_bf16 v[100:103], a[208:211], a[128:131], v[128:131]
  v_exp_f32 v44, v44
  v_mfma_f32_16x16x32_bf16 v[100:103], a[212:215], a[132:135], v[100:103]
  ds_read_b64_tr_b16 a[224:225], v168 offset:32768
  ds_read_b64_tr_b16 a[226:227], v168 offset:36864
  v_mfma_f32_16x16x32_bf16 v[100:103], a[216:219], a[136:139], v[100:103]
  v_exp_f32 v45, v45
  v_mfma_f32_16x16x32_bf16 v[100:103], a[220:223], a[140:143], v[100:103]
  v_cvt_pk_bf16_f32 v42, v44, v45
  v_mfma_f32_16x16x32_bf16 v[108:111], a[208:211], a[144:147], v[132:135]
  v_exp_f32 v46, v46
  v_mfma_f32_16x16x32_bf16 v[108:111], a[212:215], a[148:151], v[108:111]
  ds_read_b64_tr_b16 a[228:229], v169 offset:32768
  ds_read_b64_tr_b16 a[230:231], v169 offset:36864
  v_mfma_f32_16x16x32_bf16 v[108:111], a[216:219], a[152:155], v[108:111]
  v_exp_f32 v47, v47
  v_mfma_f32_16x16x32_bf16 v[108:111], a[220:223], a[156:159], v[108:111]
  v_cvt_pk_bf16_f32 v43, v46, v47
  v_mfma_f32_16x16x32_bf16 v[116:119], a[208:211], a[160:163], v[136:139]
  v_exp_f32 v48, v48
  v_mfma_f32_16x16x32_bf16 v[116:119], a[212:215], a[164:167], v[116:119]
  ds_read_b64_tr_b16 a[232:233], v170 offset:32768
  ds_read_b64_tr_b16 a[234:235], v170 offset:36864
  v_mfma_f32_16x16x32_bf16 v[116:119], a[216:219], a[168:171], v[116:119]
  v_exp_f32 v49, v49
  v_mfma_f32_16x16x32_bf16 v[116:119], a[220:223], a[172:175], v[116:119]
  v_cvt_pk_bf16_f32 v48, v48, v49
  v_mfma_f32_16x16x32_bf16 v[124:127], a[208:211], a[176:179], v[140:143]
  v_exp_f32 v50, v50
  v_mfma_f32_16x16x32_bf16 v[124:127], a[212:215], a[180:183], v[124:127]
  ds_read_b64_tr_b16 a[236:237], v171 offset:32768
  ds_read_b64_tr_b16 a[238:239], v171 offset:36864
  v_mfma_f32_16x16x32_bf16 v[124:127], a[216:219], a[184:187], v[124:127]
  v_exp_f32 v51, v51
  v_mfma_f32_16x16x32_bf16 v[124:127], a[220:223], a[188:191], v[124:127]
  v_cvt_pk_bf16_f32 v49, v50, v51
  s_waitcnt lgkmcnt(4)
  v_mfma_f32_16x16x32_bf16 a[0:3], a[224:227], v[0:3], a[0:3]
  v_exp_f32 v52, v52
  v_mfma_f32_16x16x32_bf16 a[32:35], a[224:227], v[8:11], a[32:35]
  ds_read_b64_tr_b16 a[240:241], v172 offset:32768
  ds_read_b64_tr_b16 a[242:243], v172 offset:36864
  v_mfma_f32_16x16x32_bf16 a[64:67], a[224:227], v[16:19], a[64:67]
  v_exp_f32 v53, v53
  v_mfma_f32_16x16x32_bf16 a[96:99], a[224:227], v[24:27], a[96:99]
  v_cvt_pk_bf16_f32 v50, v52, v53
  v_mfma_f32_16x16x32_bf16 a[4:7], a[228:231], v[0:3], a[4:7]
  v_exp_f32 v54, v54
  v_mfma_f32_16x16x32_bf16 a[36:39], a[228:231], v[8:11], a[36:39]
  ds_read_b64_tr_b16 a[244:245], v173 offset:32768
  ds_read_b64_tr_b16 a[246:247], v173 offset:36864
  v_mfma_f32_16x16x32_bf16 a[68:71], a[228:231], v[16:19], a[68:71]
  v_exp_f32 v55, v55
  v_mfma_f32_16x16x32_bf16 a[100:103], a[228:231], v[24:27], a[100:103]
  v_cvt_pk_bf16_f32 v51, v54, v55
  s_waitcnt lgkmcnt(4)
  v_mfma_f32_16x16x32_bf16 a[8:11], a[232:235], v[0:3], a[8:11]
  v_exp_f32 v56, v56
  v_mfma_f32_16x16x32_bf16 a[40:43], a[232:235], v[8:11], a[40:43]
  ds_read_b64_tr_b16 a[248:249], v174 offset:32768
  ds_read_b64_tr_b16 a[250:251], v174 offset:36864
  v_mfma_f32_16x16x32_bf16 a[72:75], a[232:235], v[16:19], a[72:75]
  v_exp_f32 v57, v57
  v_mfma_f32_16x16x32_bf16 a[104:107], a[232:235], v[24:27], a[104:107]
  v_cvt_pk_bf16_f32 v56, v56, v57
  v_mfma_f32_16x16x32_bf16 a[12:15], a[236:239], v[0:3], a[12:15]
  v_exp_f32 v58, v58
  v_mfma_f32_16x16x32_bf16 a[44:47], a[236:239], v[8:11], a[44:47]
  ds_read_b64_tr_b16 a[252:253], v175 offset:32768
  ds_read_b64_tr_b16 a[254:255], v175 offset:36864
  v_mfma_f32_16x16x32_bf16 a[76:79], a[236:239], v[16:19], a[76:79]
  v_exp_f32 v59, v59
  v_mfma_f32_16x16x32_bf16 a[108:111], a[236:239], v[24:27], a[108:111]
  v_cvt_pk_bf16_f32 v57, v58, v59
  s_waitcnt lgkmcnt(4)
  v_mfma_f32_16x16x32_bf16 a[16:19], a[240:243], v[0:3], a[16:19]
  v_exp_f32 v60, v60
  v_mfma_f32_16x16x32_bf16 a[48:51], a[240:243], v[8:11], a[48:51]
  v_mfma_f32_16x16x32_bf16 a[80:83], a[240:243], v[16:19], a[80:83]
  v_exp_f32 v61, v61
  v_mfma_f32_16x16x32_bf16 a[112:115], a[240:243], v[24:27], a[112:115]
  v_cvt_pk_bf16_f32 v58, v60, v61
  v_mfma_f32_16x16x32_bf16 a[20:23], a[244:247], v[0:3], a[20:23]
  v_exp_f32 v62, v62
  v_mfma_f32_16x16x32_bf16 a[52:55], a[244:247], v[8:11], a[52:55]
  ds_read_b64_tr_b16 a[224:225], v168 offset:40960
  ds_read_b64_tr_b16 a[226:227], v168 offset:45056
  v_mfma_f32_16x16x32_bf16 a[84:87], a[244:247], v[16:19], a[84:87]
  v_exp_f32 v63, v63
  v_mfma_f32_16x16x32_bf16 a[116:119], a[244:247], v[24:27], a[116:119]
  v_cvt_pk_bf16_f32 v59, v62, v63
  s_waitcnt lgkmcnt(2)
  v_mfma_f32_16x16x32_bf16 a[24:27], a[248:251], v[0:3], a[24:27]
  v_mfma_f32_16x16x32_bf16 a[56:59], a[248:251], v[8:11], a[56:59]
  ds_read_b64_tr_b16 a[228:229], v169 offset:40960
  ds_read_b64_tr_b16 a[230:231], v169 offset:45056
  v_mfma_f32_16x16x32_bf16 a[88:91], a[248:251], v[16:19], a[88:91]
  v_mfma_f32_16x16x32_bf16 a[120:123], a[248:251], v[24:27], a[120:123]
  v_mfma_f32_16x16x32_bf16 a[28:31], a[252:255], v[0:3], a[28:31]
  s_waitcnt vmcnt(12)
  s_barrier
  v_mfma_f32_16x16x32_bf16 a[60:63], a[252:255], v[8:11], a[60:63]
  ds_read_b64_tr_b16 a[232:233], v170 offset:40960
  ds_read_b64_tr_b16 a[234:235], v170 offset:45056
  v_mfma_f32_16x16x32_bf16 a[92:95], a[252:255], v[16:19], a[92:95]
  v_mfma_f32_16x16x32_bf16 a[124:127], a[252:255], v[24:27], a[124:127]
  s_waitcnt lgkmcnt(4)
  v_mfma_f32_16x16x32_bf16 v[144:147], v[164:167], v[0:3], v[144:147]
  v_exp_f32 v64, v64
  v_mfma_f32_16x16x32_bf16 v[148:151], v[164:167], v[8:11], v[148:151]
  ds_read_b64_tr_b16 a[236:237], v171 offset:40960
  ds_read_b64_tr_b16 a[238:239], v171 offset:45056
  v_mfma_f32_16x16x32_bf16 v[152:155], v[164:167], v[16:19], v[152:155]
  v_exp_f32 v65, v65
  v_mfma_f32_16x16x32_bf16 v[156:159], v[164:167], v[24:27], v[156:159]
  v_cvt_pk_bf16_f32 v64, v64, v65
  v_mfma_f32_16x16x32_bf16 a[0:3], a[224:227], v[32:35], a[0:3]
  v_exp_f32 v66, v66
  v_mfma_f32_16x16x32_bf16 a[32:35], a[224:227], v[40:43], a[32:35]
  ds_read_b64_tr_b16 a[240:241], v172 offset:40960
  ds_read_b64_tr_b16 a[242:243], v172 offset:45056
  v_mfma_f32_16x16x32_bf16 a[64:67], a[224:227], v[48:51], a[64:67]
  v_exp_f32 v67, v67
  v_mfma_f32_16x16x32_bf16 a[96:99], a[224:227], v[56:59], a[96:99]
  v_cvt_pk_bf16_f32 v65, v66, v67
  s_waitcnt lgkmcnt(4)
  v_mfma_f32_16x16x32_bf16 a[4:7], a[228:231], v[32:35], a[4:7]
  v_exp_f32 v68, v68
  v_mfma_f32_16x16x32_bf16 a[36:39], a[228:231], v[40:43], a[36:39]
  ds_read_b64_tr_b16 a[244:245], v173 offset:40960
  ds_read_b64_tr_b16 a[246:247], v173 offset:45056
  v_mfma_f32_16x16x32_bf16 a[68:71], a[228:231], v[48:51], a[68:71]
  v_exp_f32 v69, v69
  v_mfma_f32_16x16x32_bf16 a[100:103], a[228:231], v[56:59], a[100:103]
  v_cvt_pk_bf16_f32 v66, v68, v69
  v_mfma_f32_16x16x32_bf16 a[8:11], a[232:235], v[32:35], a[8:11]
  v_exp_f32 v70, v70
  v_mfma_f32_16x16x32_bf16 a[40:43], a[232:235], v[40:43], a[40:43]
  ds_read_b64_tr_b16 a[248:249], v174 offset:40960
  ds_read_b64_tr_b16 a[250:251], v174 offset:45056
  v_mfma_f32_16x16x32_bf16 a[72:75], a[232:235], v[48:51], a[72:75]
  v_exp_f32 v71, v71
  v_mfma_f32_16x16x32_bf16 a[104:107], a[232:235], v[56:59], a[104:107]
  v_cvt_pk_bf16_f32 v67, v70, v71
  s_waitcnt lgkmcnt(4)
  v_mfma_f32_16x16x32_bf16 a[12:15], a[236:239], v[32:35], a[12:15]
  v_exp_f32 v72, v72
  v_mfma_f32_16x16x32_bf16 a[44:47], a[236:239], v[40:43], a[44:47]
  ds_read_b64_tr_b16 a[252:253], v175 offset:40960
  ds_read_b64_tr_b16 a[254:255], v175 offset:45056
  v_mfma_f32_16x16x32_bf16 a[76:79], a[236:239], v[48:51], a[76:79]
  v_exp_f32 v73, v73
  v_mfma_f32_16x16x32_bf16 a[108:111], a[236:239], v[56:59], a[108:111]
  v_cvt_pk_bf16_f32 v72, v72, v73
  v_mfma_f32_16x16x32_bf16 a[16:19], a[240:243], v[32:35], a[16:19]
  v_exp_f32 v74, v74
  v_mfma_f32_16x16x32_bf16 a[48:51], a[240:243], v[40:43], a[48:51]
  v_mfma_f32_16x16x32_bf16 a[80:83], a[240:243], v[48:51], a[80:83]
  v_exp_f32 v75, v75
  v_mfma_f32_16x16x32_bf16 a[112:115], a[240:243], v[56:59], a[112:115]
  v_cvt_pk_bf16_f32 v73, v74, v75
  s_waitcnt lgkmcnt(2)
  v_mfma_f32_16x16x32_bf16 a[20:23], a[244:247], v[32:35], a[20:23]
  v_exp_f32 v76, v76
  v_mfma_f32_16x16x32_bf16 a[52:55], a[244:247], v[40:43], a[52:55]
  v_mfma_f32_16x16x32_bf16 a[84:87], a[244:247], v[48:51], a[84:87]
  v_exp_f32 v77, v77
  v_mfma_f32_16x16x32_bf16 a[116:119], a[244:247], v[56:59], a[116:119]
  v_cvt_pk_bf16_f32 v74, v76, v77
  v_mfma_f32_16x16x32_bf16 a[24:27], a[248:251], v[32:35], a[24:27]
  v_exp_f32 v78, v78
  v_mfma_f32_16x16x32_bf16 a[56:59], a[248:251], v[40:43], a[56:59]
  v_mfma_f32_16x16x32_bf16 a[88:91], a[248:251], v[48:51], a[88:91]
  v_exp_f32 v79, v79
  v_mfma_f32_16x16x32_bf16 a[120:123], a[248:251], v[56:59], a[120:123]
  v_cvt_pk_bf16_f32 v75, v78, v79
  s_waitcnt lgkmcnt(0)
  v_mfma_f32_16x16x32_bf16 a[28:31], a[252:255], v[32:35], a[28:31]
  v_exp_f32 v80, v80
  v_mfma_f32_16x16x32_bf16 a[60:63], a[252:255], v[40:43], a[60:63]
  v_mfma_f32_16x16x32_bf16 a[92:95], a[252:255], v[48:51], a[92:95]
  v_exp_f32 v81, v81
  v_mfma_f32_16x16x32_bf16 a[124:127], a[252:255], v[56:59], a[124:127]
  v_cvt_pk_bf16_f32 v80, v80, v81
  v_mfma_f32_16x16x32_bf16 v[144:147], v[164:167], v[32:35], v[144:147]
  v_exp_f32 v82, v82
  v_mfma_f32_16x16x32_bf16 v[148:151], v[164:167], v[40:43], v[148:151]
  v_mfma_f32_16x16x32_bf16 v[152:155], v[164:167], v[48:51], v[152:155]
  v_exp_f32 v83, v83
  v_mfma_f32_16x16x32_bf16 v[156:159], v[164:167], v[56:59], v[156:159]
  v_cvt_pk_bf16_f32 v81, v82, v83
  v_exp_f32 v84, v84
  v_exp_f32 v85, v85
  s_nop 0
  v_cvt_pk_bf16_f32 v82, v84, v85
  v_exp_f32 v86, v86
  v_exp_f32 v87, v87
  s_nop 0
  v_cvt_pk_bf16_f32 v83, v86, v87
  v_exp_f32 v88, v88
  v_exp_f32 v89, v89
  s_nop 0
  v_cvt_pk_bf16_f32 v88, v88, v89
  v_exp_f32 v90, v90
  v_exp_f32 v91, v91
  s_nop 0
  v_cvt_pk_bf16_f32 v89, v90, v91
  v_exp_f32 v92, v92
  v_exp_f32 v93, v93
  s_nop 0
  v_cvt_pk_bf16_f32 v90, v92, v93
  v_exp_f32 v94, v94
  v_exp_f32 v95, v95
  s_nop 0
  v_cvt_pk_bf16_f32 v91, v94, v95
  ds_read_b64_tr_b16 a[224:225], v168 offset:49152
  ds_read_b64_tr_b16 a[226:227], v168 offset:53248
  ds_read_b64_tr_b16 a[228:229], v169 offset:49152
  ds_read_b64_tr_b16 a[230:231], v169 offset:53248
  ds_read_b64_tr_b16 a[232:233], v170 offset:49152
  ds_read_b64_tr_b16 a[234:235], v170 offset:53248
  ds_read_b64_tr_b16 a[236:237], v171 offset:49152
  ds_read_b64_tr_b16 a[238:239], v171 offset:53248
  s_waitcnt lgkmcnt(4)
  v_mfma_f32_16x16x32_bf16 a[0:3], a[224:227], v[64:67], a[0:3]
  v_exp_f32 v96, v96
  v_mfma_f32_16x16x32_bf16 a[32:35], a[224:227], v[72:75], a[32:35]
  v_exp_f32 v97, v97
  ds_read_b64_tr_b16 a[240:241], v172 offset:49152
  ds_read_b64_tr_b16 a[242:243], v172 offset:53248
  v_mfma_f32_16x16x32_bf16 a[64:67], a[224:227], v[80:83], a[64:67]
  v_cvt_pk_bf16_f32 v96, v96, v97
  v_exp_f32 v98, v98
  v_mfma_f32_16x16x32_bf16 a[96:99], a[224:227], v[88:91], a[96:99]
  v_exp_f32 v99, v99
  v_mfma_f32_16x16x32_bf16 a[4:7], a[228:231], v[64:67], a[4:7]
  v_cvt_pk_bf16_f32 v97, v98, v99
  v_exp_f32 v100, v100
  v_mfma_f32_16x16x32_bf16 a[36:39], a[228:231], v[72:75], a[36:39]
  v_exp_f32 v101, v101
  ds_read_b64_tr_b16 a[244:245], v173 offset:49152
  ds_read_b64_tr_b16 a[246:247], v173 offset:53248
  v_mfma_f32_16x16x32_bf16 a[68:71], a[228:231], v[80:83], a[68:71]
  v_cvt_pk_bf16_f32 v98, v100, v101
  v_exp_f32 v102, v102
  v_mfma_f32_16x16x32_bf16 a[100:103], a[228:231], v[88:91], a[100:103]
  v_exp_f32 v103, v103
  s_waitcnt lgkmcnt(4)
  v_mfma_f32_16x16x32_bf16 a[8:11], a[232:235], v[64:67], a[8:11]
  v_cvt_pk_bf16_f32 v99, v102, v103
  v_mfma_f32_16x16x32_bf16 a[40:43], a[232:235], v[72:75], a[40:43]
  v_exp_f32 v104, v104
  ds_read_b64_tr_b16 a[248:249], v174 offset:49152
  ds_read_b64_tr_b16 a[250:251], v174 offset:53248
  v_mfma_f32_16x16x32_bf16 a[72:75], a[232:235], v[80:83], a[72:75]
  v_exp_f32 v105, v105
  v_mfma_f32_16x16x32_bf16 a[104:107], a[232:235], v[88:91], a[104:107]
  v_cvt_pk_bf16_f32 v104, v104, v105
  v_exp_f32 v106, v106
  v_mfma_f32_16x16x32_bf16 a[12:15], a[236:239], v[64:67], a[12:15]
  v_exp_f32 v107, v107
  v_mfma_f32_16x16x32_bf16 a[44:47], a[236:239], v[72:75], a[44:47]
  v_cvt_pk_bf16_f32 v105, v106, v107
  v_exp_f32 v108, v108
  ds_read_b64_tr_b16 a[252:253], v175 offset:49152
  ds_read_b64_tr_b16 a[254:255], v175 offset:53248
  v_mfma_f32_16x16x32_bf16 a[76:79], a[236:239], v[80:83], a[76:79]
  v_exp_f32 v109, v109
  v_mfma_f32_16x16x32_bf16 a[108:111], a[236:239], v[88:91], a[108:111]
  v_cvt_pk_bf16_f32 v106, v108, v109
  v_exp_f32 v110, v110
  s_waitcnt lgkmcnt(4)
  v_mfma_f32_16x16x32_bf16 a[16:19], a[240:243], v[64:67], a[16:19]
  v_exp_f32 v111, v111
  v_mfma_f32_16x16x32_bf16 a[48:51], a[240:243], v[72:75], a[48:51]
  v_cvt_pk_bf16_f32 v107, v110, v111
  v_mfma_f32_16x16x32_bf16 a[80:83], a[240:243], v[80:83], a[80:83]
  v_exp_f32 v112, v112
  v_mfma_f32_16x16x32_bf16 a[112:115], a[240:243], v[88:91], a[112:115]
  v_exp_f32 v113, v113
  v_mfma_f32_16x16x32_bf16 a[20:23], a[244:247], v[64:67], a[20:23]
  v_cvt_pk_bf16_f32 v112, v112, v113
  v_exp_f32 v114, v114
  v_mfma_f32_16x16x32_bf16 a[52:55], a[244:247], v[72:75], a[52:55]
  v_exp_f32 v115, v115
  ds_read_b64_tr_b16 a[224:225], v168 offset:57344
  ds_read_b64_tr_b16 a[226:227], v168 offset:61440
  v_mfma_f32_16x16x32_bf16 a[84:87], a[244:247], v[80:83], a[84:87]
  v_cvt_pk_bf16_f32 v113, v114, v115
  v_exp_f32 v116, v116
  v_mfma_f32_16x16x32_bf16 a[116:119], a[244:247], v[88:91], a[116:119]
  v_exp_f32 v117, v117
  s_waitcnt lgkmcnt(2)
  v_mfma_f32_16x16x32_bf16 a[24:27], a[248:251], v[64:67], a[24:27]
  v_cvt_pk_bf16_f32 v114, v116, v117
  v_exp_f32 v118, v118
  v_mfma_f32_16x16x32_bf16 a[56:59], a[248:251], v[72:75], a[56:59]
  v_exp_f32 v119, v119
  ds_read_b64_tr_b16 a[228:229], v169 offset:57344
  ds_read_b64_tr_b16 a[230:231], v169 offset:61440
  v_mfma_f32_16x16x32_bf16 a[88:91], a[248:251], v[80:83], a[88:91]
  v_cvt_pk_bf16_f32 v115, v118, v119
  v_mfma_f32_16x16x32_bf16 a[120:123], a[248:251], v[88:91], a[120:123]
  v_exp_f32 v120, v120
  v_mfma_f32_16x16x32_bf16 a[28:31], a[252:255], v[64:67], a[28:31]
  v_exp_f32 v121, v121
  v_mfma_f32_16x16x32_bf16 a[60:63], a[252:255], v[72:75], a[60:63]
  v_cvt_pk_bf16_f32 v120, v120, v121
  v_exp_f32 v122, v122
  ds_read_b64_tr_b16 a[232:233], v170 offset:57344
  ds_read_b64_tr_b16 a[234:235], v170 offset:61440
  v_mfma_f32_16x16x32_bf16 a[92:95], a[252:255], v[80:83], a[92:95]
  v_exp_f32 v123, v123
  v_mfma_f32_16x16x32_bf16 a[124:127], a[252:255], v[88:91], a[124:127]
  v_cvt_pk_bf16_f32 v121, v122, v123
  v_exp_f32 v124, v124
  s_waitcnt lgkmcnt(4)
  v_mfma_f32_16x16x32_bf16 v[144:147], v[164:167], v[64:67], v[144:147]
  v_exp_f32 v125, v125
  v_mfma_f32_16x16x32_bf16 v[148:151], v[164:167], v[72:75], v[148:151]
  v_cvt_pk_bf16_f32 v122, v124, v125
  v_exp_f32 v126, v126
  ds_read_b64_tr_b16 a[236:237], v171 offset:57344
  ds_read_b64_tr_b16 a[238:239], v171 offset:61440
  v_mfma_f32_16x16x32_bf16 v[152:155], v[164:167], v[80:83], v[152:155]
  v_exp_f32 v127, v127
  v_mfma_f32_16x16x32_bf16 v[156:159], v[164:167], v[88:91], v[156:159]
  v_cvt_pk_bf16_f32 v123, v126, v127
  v_mfma_f32_16x16x32_bf16 a[0:3], a[224:227], v[96:99], a[0:3]
  v_mfma_f32_16x16x32_bf16 a[32:35], a[224:227], v[104:107], a[32:35]
  ds_read_b64_tr_b16 a[240:241], v172 offset:57344
  ds_read_b64_tr_b16 a[242:243], v172 offset:61440
  v_mfma_f32_16x16x32_bf16 a[64:67], a[224:227], v[112:115], a[64:67]
  v_mfma_f32_16x16x32_bf16 a[96:99], a[224:227], v[120:123], a[96:99]
  s_waitcnt lgkmcnt(4)
  v_mfma_f32_16x16x32_bf16 a[4:7], a[228:231], v[96:99], a[4:7]
  v_mfma_f32_16x16x32_bf16 a[36:39], a[228:231], v[104:107], a[36:39]
  ds_read_b64_tr_b16 a[244:245], v173 offset:57344
  ds_read_b64_tr_b16 a[246:247], v173 offset:61440
  v_mfma_f32_16x16x32_bf16 a[68:71], a[228:231], v[112:115], a[68:71]
  v_mfma_f32_16x16x32_bf16 a[100:103], a[228:231], v[120:123], a[100:103]
  v_mfma_f32_16x16x32_bf16 a[8:11], a[232:235], v[96:99], a[8:11]
  v_mfma_f32_16x16x32_bf16 a[40:43], a[232:235], v[104:107], a[40:43]
  ds_read_b64_tr_b16 a[248:249], v174 offset:57344
  ds_read_b64_tr_b16 a[250:251], v174 offset:61440
  v_mfma_f32_16x16x32_bf16 a[72:75], a[232:235], v[112:115], a[72:75]
  v_mfma_f32_16x16x32_bf16 a[104:107], a[232:235], v[120:123], a[104:107]
  s_waitcnt lgkmcnt(4)
  v_mfma_f32_16x16x32_bf16 a[12:15], a[236:239], v[96:99], a[12:15]
  v_mfma_f32_16x16x32_bf16 a[44:47], a[236:239], v[104:107], a[44:47]
  ds_read_b64_tr_b16 a[252:253], v175 offset:57344
  ds_read_b64_tr_b16 a[254:255], v175 offset:61440
  v_mfma_f32_16x16x32_bf16 a[76:79], a[236:239], v[112:115], a[76:79]
  v_mfma_f32_16x16x32_bf16 a[108:111], a[236:239], v[120:123], a[108:111]
  v_mfma_f32_16x16x32_bf16 a[16:19], a[240:243], v[96:99], a[16:19]
  v_mfma_f32_16x16x32_bf16 a[48:51], a[240:243], v[104:107], a[48:51]
  v_mfma_f32_16x16x32_bf16 a[80:83], a[240:243], v[112:115], a[80:83]
  v_mfma_f32_16x16x32_bf16 a[112:115], a[240:243], v[120:123], a[112:115]
  s_waitcnt lgkmcnt(2)
  v_mfma_f32_16x16x32_bf16 a[20:23], a[244:247], v[96:99], a[20:23]
  v_mfma_f32_16x16x32_bf16 a[52:55], a[244:247], v[104:107], a[52:55]
  v_mfma_f32_16x16x32_bf16 a[84:87], a[244:247], v[112:115], a[84:87]
  v_mfma_f32_16x16x32_bf16 a[116:119], a[244:247], v[120:123], a[116:119]
  v_mfma_f32_16x16x32_bf16 a[24:27], a[248:251], v[96:99], a[24:27]
  v_mfma_f32_16x16x32_bf16 a[56:59], a[248:251], v[104:107], a[56:59]
  v_mfma_f32_16x16x32_bf16 a[88:91], a[248:251], v[112:115], a[88:91]
  v_mfma_f32_16x16x32_bf16 a[120:123], a[248:251], v[120:123], a[120:123]
  s_waitcnt lgkmcnt(0)
  v_mfma_f32_16x16x32_bf16 a[28:31], a[252:255], v[96:99], a[28:31]
  v_mfma_f32_16x16x32_bf16 a[60:63], a[252:255], v[104:107], a[60:63]
  v_mfma_f32_16x16x32_bf16 a[92:95], a[252:255], v[112:115], a[92:95]
  v_mfma_f32_16x16x32_bf16 a[124:127], a[252:255], v[120:123], a[124:127]
  v_mfma_f32_16x16x32_bf16 v[144:147], v[164:167], v[96:99], v[144:147]
  v_mfma_f32_16x16x32_bf16 v[148:151], v[164:167], v[104:107], v[148:151]
  v_mfma_f32_16x16x32_bf16 v[152:155], v[164:167], v[112:115], v[152:155]
  v_mfma_f32_16x16x32_bf16 v[156:159], v[164:167], v[120:123], v[156:159]
  s_waitcnt vmcnt(0) lgkmcnt(0)
  s_nop 7
  v_rcp_f32 v144, v144
  v_rcp_f32 v145, v145
  v_mov_b32 v190, 0
  v_rcp_f32 v148, v148
  v_rcp_f32 v149, v149
  v_mov_b32 v191, 0
  v_rcp_f32 v152, v152
  v_rcp_f32 v153, v153
  v_mov_b32 v192, 0
  v_rcp_f32 v156, v156
  v_rcp_f32 v157, v157
  v_mov_b32 v193, 0
  s_lshl_b32 s47, s29, 12
  s_add_u32 s47, s47, 0
  v_accvgpr_read_b32 v0, a0
  v_accvgpr_read_b32 v1, a1
  v_accvgpr_read_b32 v2, a2
  v_accvgpr_read_b32 v3, a3
  v_accvgpr_read_b32 v4, a4
  v_accvgpr_read_b32 v5, a5
  v_accvgpr_read_b32 v6, a6
  v_accvgpr_read_b32 v7, a7
  v_max3_f32 v190, |v0|, |v1|, v190
  v_max3_f32 v190, |v2|, |v3|, v190
  v_max3_f32 v190, |v4|, |v5|, v190
  v_max3_f32 v190, |v6|, |v7|, v190
  v_pk_mul_f32 v[0:1], v[0:1], v[144:145]
  v_pk_mul_f32 v[2:3], v[2:3], v[144:145]
  v_pk_mul_f32 v[4:5], v[4:5], v[144:145]
  v_pk_mul_f32 v[6:7], v[6:7], v[144:145]
  v_cvt_pk_bf16_f32 v8, v0, v1
  v_cvt_pk_bf16_f32 v9, v2, v3
  v_cvt_pk_bf16_f32 v10, v4, v5
  v_cvt_pk_bf16_f32 v11, v6, v7
  buffer_store_dwordx4 v[8:11], v201, s[24:27], s47 offen offset:0
  v_accvgpr_read_b32 v16, a8
  v_accvgpr_read_b32 v17, a9
  v_accvgpr_read_b32 v18, a10
  v_accvgpr_read_b32 v19, a11
  v_accvgpr_read_b32 v20, a12
  v_accvgpr_read_b32 v21, a13
  v_accvgpr_read_b32 v22, a14
  v_accvgpr_read_b32 v23, a15
  v_max3_f32 v190, |v16|, |v17|, v190
  v_max3_f32 v190, |v18|, |v19|, v190
  v_max3_f32 v190, |v20|, |v21|, v190
  v_max3_f32 v190, |v22|, |v23|, v190
  v_pk_mul_f32 v[16:17], v[16:17], v[144:145]
  v_pk_mul_f32 v[18:19], v[18:19], v[144:145]
  v_pk_mul_f32 v[20:21], v[20:21], v[144:145]
  v_pk_mul_f32 v[22:23], v[22:23], v[144:145]
  v_cvt_pk_bf16_f32 v24, v16, v17
  v_cvt_pk_bf16_f32 v25, v18, v19
  v_cvt_pk_bf16_f32 v26, v20, v21
  v_cvt_pk_bf16_f32 v27, v22, v23
  buffer_store_dwordx4 v[24:27], v201, s[24:27], s47 offen offset:1024
  v_accvgpr_read_b32 v32, a16
  v_accvgpr_read_b32 v33, a17
  v_accvgpr_read_b32 v34, a18
  v_accvgpr_read_b32 v35, a19
  v_accvgpr_read_b32 v36, a20
  v_accvgpr_read_b32 v37, a21
  v_accvgpr_read_b32 v38, a22
  v_accvgpr_read_b32 v39, a23
  v_max3_f32 v190, |v32|, |v33|, v190
  v_max3_f32 v190, |v34|, |v35|, v190
  v_max3_f32 v190, |v36|, |v37|, v190
  v_max3_f32 v190, |v38|, |v39|, v190
  v_pk_mul_f32 v[32:33], v[32:33], v[144:145]
  v_pk_mul_f32 v[34:35], v[34:35], v[144:145]
  v_pk_mul_f32 v[36:37], v[36:37], v[144:145]
  v_pk_mul_f32 v[38:39], v[38:39], v[144:145]
  v_cvt_pk_bf16_f32 v40, v32, v33
  v_cvt_pk_bf16_f32 v41, v34, v35
  v_cvt_pk_bf16_f32 v42, v36, v37
  v_cvt_pk_bf16_f32 v43, v38, v39
  buffer_store_dwordx4 v[40:43], v201, s[24:27], s47 offen offset:2048
  v_accvgpr_read_b32 v48, a24
  v_accvgpr_read_b32 v49, a25
  v_accvgpr_read_b32 v50, a26
  v_accvgpr_read_b32 v51, a27
  v_accvgpr_read_b32 v52, a28
  v_accvgpr_read_b32 v53, a29
  v_accvgpr_read_b32 v54, a30
  v_accvgpr_read_b32 v55, a31
  v_max3_f32 v190, |v48|, |v49|, v190
  v_max3_f32 v190, |v50|, |v51|, v190
  v_max3_f32 v190, |v52|, |v53|, v190
  v_max3_f32 v190, |v54|, |v55|, v190
  v_pk_mul_f32 v[48:49], v[48:49], v[144:145]
  v_pk_mul_f32 v[50:51], v[50:51], v[144:145]
  v_pk_mul_f32 v[52:53], v[52:53], v[144:145]
  v_pk_mul_f32 v[54:55], v[54:55], v[144:145]
  v_cvt_pk_bf16_f32 v56, v48, v49
  v_cvt_pk_bf16_f32 v57, v50, v51
  v_cvt_pk_bf16_f32 v58, v52, v53
  v_cvt_pk_bf16_f32 v59, v54, v55
  buffer_store_dwordx4 v[56:59], v201, s[24:27], s47 offen offset:3072
  s_lshl_b32 s47, s29, 12
  s_add_u32 s47, s47, 186368
  v_accvgpr_read_b32 v0, a32
  v_accvgpr_read_b32 v1, a33
  v_accvgpr_read_b32 v2, a34
  v_accvgpr_read_b32 v3, a35
  v_accvgpr_read_b32 v4, a36
  v_accvgpr_read_b32 v5, a37
  v_accvgpr_read_b32 v6, a38
  v_accvgpr_read_b32 v7, a39
  v_max3_f32 v191, |v0|, |v1|, v191
  v_max3_f32 v191, |v2|, |v3|, v191
  v_max3_f32 v191, |v4|, |v5|, v191
  v_max3_f32 v191, |v6|, |v7|, v191
  v_pk_mul_f32 v[0:1], v[0:1], v[148:149]
  v_pk_mul_f32 v[2:3], v[2:3], v[148:149]
  v_pk_mul_f32 v[4:5], v[4:5], v[148:149]
  v_pk_mul_f32 v[6:7], v[6:7], v[148:149]
  v_cvt_pk_bf16_f32 v8, v0, v1
  v_cvt_pk_bf16_f32 v9, v2, v3
  v_cvt_pk_bf16_f32 v10, v4, v5
  v_cvt_pk_bf16_f32 v11, v6, v7
  buffer_store_dwordx4 v[8:11], v201, s[24:27], s47 offen offset:0
  v_accvgpr_read_b32 v16, a40
  v_accvgpr_read_b32 v17, a41
  v_accvgpr_read_b32 v18, a42
  v_accvgpr_read_b32 v19, a43
  v_accvgpr_read_b32 v20, a44
  v_accvgpr_read_b32 v21, a45
  v_accvgpr_read_b32 v22, a46
  v_accvgpr_read_b32 v23, a47
  v_max3_f32 v191, |v16|, |v17|, v191
  v_max3_f32 v191, |v18|, |v19|, v191
  v_max3_f32 v191, |v20|, |v21|, v191
  v_max3_f32 v191, |v22|, |v23|, v191
  v_pk_mul_f32 v[16:17], v[16:17], v[148:149]
  v_pk_mul_f32 v[18:19], v[18:19], v[148:149]
  v_pk_mul_f32 v[20:21], v[20:21], v[148:149]
  v_pk_mul_f32 v[22:23], v[22:23], v[148:149]
  v_cvt_pk_bf16_f32 v24, v16, v17
  v_cvt_pk_bf16_f32 v25, v18, v19
  v_cvt_pk_bf16_f32 v26, v20, v21
  v_cvt_pk_bf16_f32 v27, v22, v23
  buffer_store_dwordx4 v[24:27], v201, s[24:27], s47 offen offset:1024
  v_accvgpr_read_b32 v32, a48
  v_accvgpr_read_b32 v33, a49
  v_accvgpr_read_b32 v34, a50
  v_accvgpr_read_b32 v35, a51
  v_accvgpr_read_b32 v36, a52
  v_accvgpr_read_b32 v37, a53
  v_accvgpr_read_b32 v38, a54
  v_accvgpr_read_b32 v39, a55
  v_max3_f32 v191, |v32|, |v33|, v191
  v_max3_f32 v191, |v34|, |v35|, v191
  v_max3_f32 v191, |v36|, |v37|, v191
  v_max3_f32 v191, |v38|, |v39|, v191
  v_pk_mul_f32 v[32:33], v[32:33], v[148:149]
  v_pk_mul_f32 v[34:35], v[34:35], v[148:149]
  v_pk_mul_f32 v[36:37], v[36:37], v[148:149]
  v_pk_mul_f32 v[38:39], v[38:39], v[148:149]
  v_cvt_pk_bf16_f32 v40, v32, v33
  v_cvt_pk_bf16_f32 v41, v34, v35
  v_cvt_pk_bf16_f32 v42, v36, v37
  v_cvt_pk_bf16_f32 v43, v38, v39
  buffer_store_dwordx4 v[40:43], v201, s[24:27], s47 offen offset:2048
  v_accvgpr_read_b32 v48, a56
  v_accvgpr_read_b32 v49, a57
  v_accvgpr_read_b32 v50, a58
  v_accvgpr_read_b32 v51, a59
  v_accvgpr_read_b32 v52, a60
  v_accvgpr_read_b32 v53, a61
  v_accvgpr_read_b32 v54, a62
  v_accvgpr_read_b32 v55, a63
  v_max3_f32 v191, |v48|, |v49|, v191
  v_max3_f32 v191, |v50|, |v51|, v191
  v_max3_f32 v191, |v52|, |v53|, v191
  v_max3_f32 v191, |v54|, |v55|, v191
  v_pk_mul_f32 v[48:49], v[48:49], v[148:149]
  v_pk_mul_f32 v[50:51], v[50:51], v[148:149]
  v_pk_mul_f32 v[52:53], v[52:53], v[148:149]
  v_pk_mul_f32 v[54:55], v[54:55], v[148:149]
  v_cvt_pk_bf16_f32 v56, v48, v49
  v_cvt_pk_bf16_f32 v57, v50, v51
  v_cvt_pk_bf16_f32 v58, v52, v53
  v_cvt_pk_bf16_f32 v59, v54, v55
  buffer_store_dwordx4 v[56:59], v201, s[24:27], s47 offen offset:3072
  s_lshl_b32 s47, s29, 12
  s_add_u32 s47, s47, 372736
  v_accvgpr_read_b32 v0, a64
  v_accvgpr_read_b32 v1, a65
  v_accvgpr_read_b32 v2, a66
  v_accvgpr_read_b32 v3, a67
  v_accvgpr_read_b32 v4, a68
  v_accvgpr_read_b32 v5, a69
  v_accvgpr_read_b32 v6, a70
  v_accvgpr_read_b32 v7, a71
  v_max3_f32 v192, |v0|, |v1|, v192
  v_max3_f32 v192, |v2|, |v3|, v192
  v_max3_f32 v192, |v4|, |v5|, v192
  v_max3_f32 v192, |v6|, |v7|, v192
  v_pk_mul_f32 v[0:1], v[0:1], v[152:153]
  v_pk_mul_f32 v[2:3], v[2:3], v[152:153]
  v_pk_mul_f32 v[4:5], v[4:5], v[152:153]
  v_pk_mul_f32 v[6:7], v[6:7], v[152:153]
  v_cvt_pk_bf16_f32 v8, v0, v1
  v_cvt_pk_bf16_f32 v9, v2, v3
  v_cvt_pk_bf16_f32 v10, v4, v5
  v_cvt_pk_bf16_f32 v11, v6, v7
  buffer_store_dwordx4 v[8:11], v201, s[24:27], s47 offen offset:0
  v_accvgpr_read_b32 v16, a72
  v_accvgpr_read_b32 v17, a73
  v_accvgpr_read_b32 v18, a74
  v_accvgpr_read_b32 v19, a75
  v_accvgpr_read_b32 v20, a76
  v_accvgpr_read_b32 v21, a77
  v_accvgpr_read_b32 v22, a78
  v_accvgpr_read_b32 v23, a79
  v_max3_f32 v192, |v16|, |v17|, v192
  v_max3_f32 v192, |v18|, |v19|, v192
  v_max3_f32 v192, |v20|, |v21|, v192
  v_max3_f32 v192, |v22|, |v23|, v192
  v_pk_mul_f32 v[16:17], v[16:17], v[152:153]
  v_pk_mul_f32 v[18:19], v[18:19], v[152:153]
  v_pk_mul_f32 v[20:21], v[20:21], v[152:153]
  v_pk_mul_f32 v[22:23], v[22:23], v[152:153]
  v_cvt_pk_bf16_f32 v24, v16, v17
  v_cvt_pk_bf16_f32 v25, v18, v19
  v_cvt_pk_bf16_f32 v26, v20, v21
  v_cvt_pk_bf16_f32 v27, v22, v23
  buffer_store_dwordx4 v[24:27], v201, s[24:27], s47 offen offset:1024
  v_accvgpr_read_b32 v32, a80
  v_accvgpr_read_b32 v33, a81
  v_accvgpr_read_b32 v34, a82
  v_accvgpr_read_b32 v35, a83
  v_accvgpr_read_b32 v36, a84
  v_accvgpr_read_b32 v37, a85
  v_accvgpr_read_b32 v38, a86
  v_accvgpr_read_b32 v39, a87
  v_max3_f32 v192, |v32|, |v33|, v192
  v_max3_f32 v192, |v34|, |v35|, v192
  v_max3_f32 v192, |v36|, |v37|, v192
  v_max3_f32 v192, |v38|, |v39|, v192
  v_pk_mul_f32 v[32:33], v[32:33], v[152:153]
  v_pk_mul_f32 v[34:35], v[34:35], v[152:153]
  v_pk_mul_f32 v[36:37], v[36:37], v[152:153]
  v_pk_mul_f32 v[38:39], v[38:39], v[152:153]
  v_cvt_pk_bf16_f32 v40, v32, v33
  v_cvt_pk_bf16_f32 v41, v34, v35
  v_cvt_pk_bf16_f32 v42, v36, v37
  v_cvt_pk_bf16_f32 v43, v38, v39
  buffer_store_dwordx4 v[40:43], v201, s[24:27], s47 offen offset:2048
  v_accvgpr_read_b32 v48, a88
  v_accvgpr_read_b32 v49, a89
  v_accvgpr_read_b32 v50, a90
  v_accvgpr_read_b32 v51, a91
  v_accvgpr_read_b32 v52, a92
  v_accvgpr_read_b32 v53, a93
  v_accvgpr_read_b32 v54, a94
  v_accvgpr_read_b32 v55, a95
  v_max3_f32 v192, |v48|, |v49|, v192
  v_max3_f32 v192, |v50|, |v51|, v192
  v_max3_f32 v192, |v52|, |v53|, v192
  v_max3_f32 v192, |v54|, |v55|, v192
  v_pk_mul_f32 v[48:49], v[48:49], v[152:153]
  v_pk_mul_f32 v[50:51], v[50:51], v[152:153]
  v_pk_mul_f32 v[52:53], v[52:53], v[152:153]
  v_pk_mul_f32 v[54:55], v[54:55], v[152:153]
  v_cvt_pk_bf16_f32 v56, v48, v49
  v_cvt_pk_bf16_f32 v57, v50, v51
  v_cvt_pk_bf16_f32 v58, v52, v53
  v_cvt_pk_bf16_f32 v59, v54, v55
  buffer_store_dwordx4 v[56:59], v201, s[24:27], s47 offen offset:3072
  s_lshl_b32 s47, s29, 12
  s_add_u32 s47, s47, 559104
  v_accvgpr_read_b32 v0, a96
  v_accvgpr_read_b32 v1, a97
  v_accvgpr_read_b32 v2, a98
  v_accvgpr_read_b32 v3, a99
  v_accvgpr_read_b32 v4, a100
  v_accvgpr_read_b32 v5, a101
  v_accvgpr_read_b32 v6, a102
  v_accvgpr_read_b32 v7, a103
  v_max3_f32 v193, |v0|, |v1|, v193
  v_max3_f32 v193, |v2|, |v3|, v193
  v_max3_f32 v193, |v4|, |v5|, v193
  v_max3_f32 v193, |v6|, |v7|, v193
  v_pk_mul_f32 v[0:1], v[0:1], v[156:157]
  v_pk_mul_f32 v[2:3], v[2:3], v[156:157]
  v_pk_mul_f32 v[4:5], v[4:5], v[156:157]
  v_pk_mul_f32 v[6:7], v[6:7], v[156:157]
  v_cvt_pk_bf16_f32 v8, v0, v1
  v_cvt_pk_bf16_f32 v9, v2, v3
  v_cvt_pk_bf16_f32 v10, v4, v5
  v_cvt_pk_bf16_f32 v11, v6, v7
  buffer_store_dwordx4 v[8:11], v201, s[24:27], s47 offen offset:0
  v_accvgpr_read_b32 v16, a104
  v_accvgpr_read_b32 v17, a105
  v_accvgpr_read_b32 v18, a106
  v_accvgpr_read_b32 v19, a107
  v_accvgpr_read_b32 v20, a108
  v_accvgpr_read_b32 v21, a109
  v_accvgpr_read_b32 v22, a110
  v_accvgpr_read_b32 v23, a111
  v_max3_f32 v193, |v16|, |v17|, v193
  v_max3_f32 v193, |v18|, |v19|, v193
  v_max3_f32 v193, |v20|, |v21|, v193
  v_max3_f32 v193, |v22|, |v23|, v193
  v_pk_mul_f32 v[16:17], v[16:17], v[156:157]
  v_pk_mul_f32 v[18:19], v[18:19], v[156:157]
  v_pk_mul_f32 v[20:21], v[20:21], v[156:157]
  v_pk_mul_f32 v[22:23], v[22:23], v[156:157]
  v_cvt_pk_bf16_f32 v24, v16, v17
  v_cvt_pk_bf16_f32 v25, v18, v19
  v_cvt_pk_bf16_f32 v26, v20, v21
  v_cvt_pk_bf16_f32 v27, v22, v23
  buffer_store_dwordx4 v[24:27], v201, s[24:27], s47 offen offset:1024
  v_accvgpr_read_b32 v32, a112
  v_accvgpr_read_b32 v33, a113
  v_accvgpr_read_b32 v34, a114
  v_accvgpr_read_b32 v35, a115
  v_accvgpr_read_b32 v36, a116
  v_accvgpr_read_b32 v37, a117
  v_accvgpr_read_b32 v38, a118
  v_accvgpr_read_b32 v39, a119
  v_max3_f32 v193, |v32|, |v33|, v193
  v_max3_f32 v193, |v34|, |v35|, v193
  v_max3_f32 v193, |v36|, |v37|, v193
  v_max3_f32 v193, |v38|, |v39|, v193
  v_pk_mul_f32 v[32:33], v[32:33], v[156:157]
  v_pk_mul_f32 v[34:35], v[34:35], v[156:157]
  v_pk_mul_f32 v[36:37], v[36:37], v[156:157]
  v_pk_mul_f32 v[38:39], v[38:39], v[156:157]
  v_cvt_pk_bf16_f32 v40, v32, v33
  v_cvt_pk_bf16_f32 v41, v34, v35
  v_cvt_pk_bf16_f32 v42, v36, v37
  v_cvt_pk_bf16_f32 v43, v38, v39
  buffer_store_dwordx4 v[40:43], v201, s[24:27], s47 offen offset:2048
  v_accvgpr_read_b32 v48, a120
  v_accvgpr_read_b32 v49, a121
  v_accvgpr_read_b32 v50, a122
  v_accvgpr_read_b32 v51, a123
  v_accvgpr_read_b32 v52, a124
  v_accvgpr_read_b32 v53, a125
  v_accvgpr_read_b32 v54, a126
  v_accvgpr_read_b32 v55, a127
  v_max3_f32 v193, |v48|, |v49|, v193
  v_max3_f32 v193, |v50|, |v51|, v193
  v_max3_f32 v193, |v52|, |v53|, v193
  v_max3_f32 v193, |v54|, |v55|, v193
  v_pk_mul_f32 v[48:49], v[48:49], v[156:157]
  v_pk_mul_f32 v[50:51], v[50:51], v[156:157]
  v_pk_mul_f32 v[52:53], v[52:53], v[156:157]
  v_pk_mul_f32 v[54:55], v[54:55], v[156:157]
  v_cvt_pk_bf16_f32 v56, v48, v49
  v_cvt_pk_bf16_f32 v57, v50, v51
  v_cvt_pk_bf16_f32 v58, v52, v53
  v_cvt_pk_bf16_f32 v59, v54, v55
  buffer_store_dwordx4 v[56:59], v201, s[24:27], s47 offen offset:3072
  s_cmp_eq_u32 s40, 1
  s_cbranch_scc1 L_final
  v_mov_b32 v182, 0x4a800000
  v_mov_b32 v183, 0x4800000
  s_mov_b64 s[44:45], 0
  v_cmp_nlt_f32 vcc, v146, v182
  s_nop 3
  s_or_b64 s[44:45], s[44:45], vcc
  v_cmp_nge_f32 vcc, v190, v183
  s_nop 3
  s_or_b64 s[44:45], s[44:45], vcc
  v_cmp_nlt_f32 vcc, v150, v182
  s_nop 3
  s_or_b64 s[44:45], s[44:45], vcc
  v_cmp_nge_f32 vcc, v191, v183
  s_nop 3
  s_or_b64 s[44:45], s[44:45], vcc
  v_cmp_nlt_f32 vcc, v154, v182
  s_nop 3
  s_or_b64 s[44:45], s[44:45], vcc
  v_cmp_nge_f32 vcc, v192, v183
  s_nop 3
  s_or_b64 s[44:45], s[44:45], vcc
  v_cmp_nlt_f32 vcc, v158, v182
  s_nop 3
  s_or_b64 s[44:45], s[44:45], vcc
  v_cmp_nge_f32 vcc, v193, v183
  s_nop 3
  s_or_b64 s[44:45], s[44:45], vcc
  s_cmp_lg_u64 s[44:45], 0
  s_cselect_b32 s44, 1, 0
  v_mov_b32 v182, s44
  s_lshl_b32 s45, s28, 2
  s_add_u32 s45, s45, 0x24000
  v_mov_b32 v183, s45
  ds_write_b32 v183, v182
  s_waitcnt lgkmcnt(0)
  s_barrier
  v_mov_b32 v183, 0x24000
  ds_read_b128 v[184:187], v183
  s_waitcnt lgkmcnt(0)
  v_or_b32 v184, v184, v185
  v_or3_b32 v184, v184, v186, v187
  s_nop 0
  v_readfirstlane_b32 s44, v184
  s_nop 3
  s_cmp_lg_u32 s44, 0
  s_cbranch_scc1 L_fallback
L_final:
  s_endpgm
L_fallback:
  s_mov_b32 s40, 1
  s_mov_b32 s31, 0
  s_waitcnt vmcnt(0)
  s_mov_b32 s36, 0
  s_mov_b32 s38, 32
L_fb_loop:
  s_barrier
  s_mov_b32 m0, s34
  s_nop 0
  buffer_load_dwordx4 v176, s[4:7], s36 offen offset:0 lds
  buffer_load_dwordx4 v177, s[4:7], s36 offen offset:1024 lds
  buffer_load_dwordx4 v178, s[4:7], s36 offen offset:2048 lds
  buffer_load_dwordx4 v179, s[4:7], s36 offen offset:3072 lds
  s_add_u32 s36, s36, 16384
  s_waitcnt vmcnt(0)
  s_barrier
  ds_read_b128 a[192:195], v160 offset:32768
  ds_read_b128 a[196:199], v161 offset:32768
  ds_read_b128 a[200:203], v162 offset:32768
  ds_read_b128 a[204:207], v163 offset:32768
  ds_read_b128 a[208:211], v160 offset:36864
  s_waitcnt lgkmcnt(1)
  v_mfma_f32_16x16x32_bf16 v[0:3], a[192:195], a[128:131], 0
  ds_read_b128 a[212:215], v161 offset:36864
  v_mfma_f32_16x16x32_bf16 v[0:3], a[196:199], a[132:135], v[0:3]
  v_mfma_f32_16x16x32_bf16 v[0:3], a[200:203], a[136:139], v[0:3]
  v_mfma_f32_16x16x32_bf16 v[0:3], a[204:207], a[140:143], v[0:3]
  v_mfma_f32_16x16x32_bf16 v[8:11], a[192:195], a[144:147], 0
  ds_read_b128 a[216:219], v162 offset:36864
  v_mfma_f32_16x16x32_bf16 v[8:11], a[196:199], a[148:151], v[8:11]
  v_mfma_f32_16x16x32_bf16 v[8:11], a[200:203], a[152:155], v[8:11]
  v_mfma_f32_16x16x32_bf16 v[8:11], a[204:207], a[156:159], v[8:11]
  v_mfma_f32_16x16x32_bf16 v[16:19], a[192:195], a[160:163], 0
  ds_read_b128 a[220:223], v163 offset:36864
  v_mfma_f32_16x16x32_bf16 v[16:19], a[196:199], a[164:167], v[16:19]
  v_mfma_f32_16x16x32_bf16 v[16:19], a[200:203], a[168:171], v[16:19]
  v_mfma_f32_16x16x32_bf16 v[16:19], a[204:207], a[172:175], v[16:19]
  v_mfma_f32_16x16x32_bf16 v[24:27], a[192:195], a[176:179], 0
  ds_read_b128 a[192:195], v160 offset:40960
  v_mfma_f32_16x16x32_bf16 v[24:27], a[196:199], a[180:183], v[24:27]
  v_mfma_f32_16x16x32_bf16 v[24:27], a[200:203], a[184:187], v[24:27]
  v_mfma_f32_16x16x32_bf16 v[24:27], a[204:207], a[188:191], v[24:27]
  s_waitcnt lgkmcnt(1)
  v_mfma_f32_16x16x32_bf16 v[4:7], a[208:211], a[128:131], 0
  ds_read_b128 a[196:199], v161 offset:40960
  v_mfma_f32_16x16x32_bf16 v[4:7], a[212:215], a[132:135], v[4:7]
  v_mfma_f32_16x16x32_bf16 v[4:7], a[216:219], a[136:139], v[4:7]
  v_mfma_f32_16x16x32_bf16 v[4:7], a[220:223], a[140:143], v[4:7]
  v_mfma_f32_16x16x32_bf16 v[12:15], a[208:211], a[144:147], 0
  ds_read_b128 a[200:203], v162 offset:40960
  v_mfma_f32_16x16x32_bf16 v[12:15], a[212:215], a[148:151], v[12:15]
  v_mfma_f32_16x16x32_bf16 v[12:15], a[216:219], a[152:155], v[12:15]
  v_mfma_f32_16x16x32_bf16 v[12:15], a[220:223], a[156:159], v[12:15]
  v_mfma_f32_16x16x32_bf16 v[20:23], a[208:211], a[160:163], 0
  ds_read_b128 a[204:207], v163 offset:40960
  v_mfma_f32_16x16x32_bf16 v[20:23], a[212:215], a[164:167], v[20:23]
  v_mfma_f32_16x16x32_bf16 v[20:23], a[216:219], a[168:171], v[20:23]
  v_mfma_f32_16x16x32_bf16 v[20:23], a[220:223], a[172:175], v[20:23]
  v_mfma_f32_16x16x32_bf16 v[28:31], a[208:211], a[176:179], 0
  ds_read_b128 a[208:211], v160 offset:45056
  v_mfma_f32_16x16x32_bf16 v[28:31], a[212:215], a[180:183], v[28:31]
  v_mfma_f32_16x16x32_bf16 v[28:31], a[216:219], a[184:187], v[28:31]
  v_mfma_f32_16x16x32_bf16 v[28:31], a[220:223], a[188:191], v[28:31]
  s_waitcnt lgkmcnt(1)
  v_mfma_f32_16x16x32_bf16 v[32:35], a[192:195], a[128:131], 0
  ds_read_b128 a[212:215], v161 offset:45056
  v_mfma_f32_16x16x32_bf16 v[32:35], a[196:199], a[132:135], v[32:35]
  v_mfma_f32_16x16x32_bf16 v[32:35], a[200:203], a[136:139], v[32:35]
  v_mfma_f32_16x16x32_bf16 v[32:35], a[204:207], a[140:143], v[32:35]
  v_mfma_f32_16x16x32_bf16 v[40:43], a[192:195], a[144:147], 0
  ds_read_b128 a[216:219], v162 offset:45056
  v_mfma_f32_16x16x32_bf16 v[40:43], a[196:199], a[148:151], v[40:43]
  v_mfma_f32_16x16x32_bf16 v[40:43], a[200:203], a[152:155], v[40:43]
  v_mfma_f32_16x16x32_bf16 v[40:43], a[204:207], a[156:159], v[40:43]
  v_mfma_f32_16x16x32_bf16 v[48:51], a[192:195], a[160:163], 0
  ds_read_b128 a[220:223], v163 offset:45056
  v_mfma_f32_16x16x32_bf16 v[48:51], a[196:199], a[164:167], v[48:51]
  v_mfma_f32_16x16x32_bf16 v[48:51], a[200:203], a[168:171], v[48:51]
  v_mfma_f32_16x16x32_bf16 v[48:51], a[204:207], a[172:175], v[48:51]
  v_mfma_f32_16x16x32_bf16 v[56:59], a[192:195], a[176:179], 0
  v_mfma_f32_16x16x32_bf16 v[56:59], a[196:199], a[180:183], v[56:59]
  v_mfma_f32_16x16x32_bf16 v[56:59], a[200:203], a[184:187], v[56:59]
  v_mfma_f32_16x16x32_bf16 v[56:59], a[204:207], a[188:191], v[56:59]
  s_waitcnt lgkmcnt(0)
  v_mfma_f32_16x16x32_bf16 v[36:39], a[208:211], a[128:131], 0
  v_mfma_f32_16x16x32_bf16 v[36:39], a[212:215], a[132:135], v[36:39]
  v_mfma_f32_16x16x32_bf16 v[36:39], a[216:219], a[136:139], v[36:39]
  v_mfma_f32_16x16x32_bf16 v[36:39], a[220:223], a[140:143], v[36:39]
  v_mfma_f32_16x16x32_bf16 v[44:47], a[208:211], a[144:147], 0
  v_mfma_f32_16x16x32_bf16 v[44:47], a[212:215], a[148:151], v[44:47]
  v_mfma_f32_16x16x32_bf16 v[44:47], a[216:219], a[152:155], v[44:47]
  v_mfma_f32_16x16x32_bf16 v[44:47], a[220:223], a[156:159], v[44:47]
  v_mfma_f32_16x16x32_bf16 v[52:55], a[208:211], a[160:163], 0
  v_mfma_f32_16x16x32_bf16 v[52:55], a[212:215], a[164:167], v[52:55]
  v_mfma_f32_16x16x32_bf16 v[52:55], a[216:219], a[168:171], v[52:55]
  v_mfma_f32_16x16x32_bf16 v[52:55], a[220:223], a[172:175], v[52:55]
  v_mfma_f32_16x16x32_bf16 v[60:63], a[208:211], a[176:179], 0
  v_mfma_f32_16x16x32_bf16 v[60:63], a[212:215], a[180:183], v[60:63]
  v_mfma_f32_16x16x32_bf16 v[60:63], a[216:219], a[184:187], v[60:63]
  v_mfma_f32_16x16x32_bf16 v[60:63], a[220:223], a[188:191], v[60:63]
  s_nop 7
  s_nop 3
  v_max3_f32 v232, v0, v1, v232
  v_max3_f32 v232, v2, v3, v232
  v_max3_f32 v232, v4, v5, v232
  v_max3_f32 v232, v6, v7, v232
  v_max3_f32 v232, v32, v33, v232
  v_max3_f32 v232, v34, v35, v232
  v_max3_f32 v232, v36, v37, v232
  v_max3_f32 v232, v38, v39, v232
  v_max3_f32 v233, v8, v9, v233
  v_max3_f32 v233, v10, v11, v233
  v_max3_f32 v233, v12, v13, v233
  v_max3_f32 v233, v14, v15, v233
  v_max3_f32 v233, v40, v41, v233
  v_max3_f32 v233, v42, v43, v233
  v_max3_f32 v233, v44, v45, v233
  v_max3_f32 v233, v46, v47, v233
  v_max3_f32 v234, v16, v17, v234
  v_max3_f32 v234, v18, v19, v234
  v_max3_f32 v234, v20, v21, v234
  v_max3_f32 v234, v22, v23, v234
  v_max3_f32 v234, v48, v49, v234
  v_max3_f32 v234, v50, v51, v234
  v_max3_f32 v234, v52, v53, v234
  v_max3_f32 v234, v54, v55, v234
  v_max3_f32 v235, v24, v25, v235
  v_max3_f32 v235, v26, v27, v235
  v_max3_f32 v235, v28, v29, v235
  v_max3_f32 v235, v30, v31, v235
  v_max3_f32 v235, v56, v57, v235
  v_max3_f32 v235, v58, v59, v235
  v_max3_f32 v235, v60, v61, v235
  v_max3_f32 v235, v62, v63, v235
  s_sub_u32 s38, s38, 1
  s_cmp_lg_u32 s38, 0
  s_cbranch_scc1 L_fb_loop
  v_mov_b32 v182, v232
  s_nop 1
  v_permlane16_swap_b32 v232, v182
  s_nop 1
  v_max_f32 v232, v232, v182
  v_mov_b32 v182, v232
  s_nop 1
  v_permlane32_swap_b32 v232, v182
  s_nop 1
  v_max_f32 v232, v232, v182
  v_mov_b32 v182, v233
  s_nop 1
  v_permlane16_swap_b32 v233, v182
  s_nop 1
  v_max_f32 v233, v233, v182
  v_mov_b32 v182, v233
  s_nop 1
  v_permlane32_swap_b32 v233, v182
  s_nop 1
  v_max_f32 v233, v233, v182
  v_mov_b32 v182, v234
  s_nop 1
  v_permlane16_swap_b32 v234, v182
  s_nop 1
  v_max_f32 v234, v234, v182
  v_mov_b32 v182, v234
  s_nop 1
  v_permlane32_swap_b32 v234, v182
  s_nop 1
  v_max_f32 v234, v234, v182
  v_mov_b32 v182, v235
  s_nop 1
  v_permlane16_swap_b32 v235, v182
  s_nop 1
  v_max_f32 v235, v235, v182
  v_mov_b32 v182, v235
  s_nop 1
  v_permlane32_swap_b32 v235, v182
  s_nop 1
  v_max_f32 v235, v235, v182
  s_barrier
  s_mov_b32 s36, 0
  s_mov_b32 s37, 0
  s_add_u32 m0, s32, 65536
  s_nop 0
  buffer_load_dwordx4 v180, s[8:11], s37 offen offset:0 lds
  buffer_load_dwordx4 v181, s[8:11], s37 offen offset:1024 lds
  buffer_load_dwordx4 v180, s[8:11], s37 offen offset:2048 lds
  buffer_load_dwordx4 v181, s[8:11], s37 offen offset:3072 lds
  s_add_u32 s37, s37, 16384
  s_add_u32 m0, s33, 65536
  s_nop 0
  buffer_load_dwordx4 v180, s[8:11], s37 offen offset:0 lds
  buffer_load_dwordx4 v181, s[8:11], s37 offen offset:1024 lds
  buffer_load_dwordx4 v180, s[8:11], s37 offen offset:2048 lds
  buffer_load_dwordx4 v181, s[8:11], s37 offen offset:3072 lds
  s_add_u32 s37, s37, 16384
  s_mov_b32 m0, s34
  s_nop 0
  buffer_load_dwordx4 v176, s[4:7], s36 offen offset:0 lds
  buffer_load_dwordx4 v177, s[4:7], s36 offen offset:1024 lds
  buffer_load_dwordx4 v178, s[4:7], s36 offen offset:2048 lds
  buffer_load_dwordx4 v179, s[4:7], s36 offen offset:3072 lds
  s_add_u32 s36, s36, 16384
  s_mov_b32 m0, s35
  s_nop 0
  buffer_load_dwordx4 v176, s[4:7], s36 offen offset:0 lds
  buffer_load_dwordx4 v177, s[4:7], s36 offen offset:1024 lds
  buffer_load_dwordx4 v178, s[4:7], s36 offen offset:2048 lds
  buffer_load_dwordx4 v179, s[4:7], s36 offen offset:3072 lds
  s_add_u32 s36, s36, 16384
  s_mov_b32 m0, s32
  s_nop 0
  buffer_load_dwordx4 v176, s[4:7], s36 offen offset:0 lds
  buffer_load_dwordx4 v177, s[4:7], s36 offen offset:1024 lds
  buffer_load_dwordx4 v178, s[4:7], s36 offen offset:2048 lds
  buffer_load_dwordx4 v179, s[4:7], s36 offen offset:3072 lds
  s_add_u32 s36, s36, 16384
  s_mov_b32 m0, s33
  s_nop 0
  buffer_load_dwordx4 v176, s[4:7], s36 offen offset:0 lds
  buffer_load_dwordx4 v177, s[4:7], s36 offen offset:1024 lds
  buffer_load_dwordx4 v178, s[4:7], s36 offen offset:2048 lds
  buffer_load_dwordx4 v179, s[4:7], s36 offen offset:3072 lds
  s_add_u32 s36, s36, 16384
  s_waitcnt vmcnt(0)
  s_barrier
  s_branch L_qk0
L_k2_done:
  s_endpgm
.text
.globl out_kernel
.p2align 8
.type out_kernel,@function
out_kernel:
  s_cmp_ge_u32 s2, 256
  s_cbranch_scc1 L_k3_done
  s_load_dwordx2 s[48:49], s[0:1], 0
  s_load_dwordx2 s[54:55], s[0:1], 64
  s_load_dwordx2 s[56:57], s[0:1], 80
  v_lshrrev_b32 v1, 6, v0
  v_and_b32 v0, 63, v0
  s_nop 0
  v_readfirstlane_b32 s28, v1
  s_and_b32 s44, s2, 7
  s_lshr_b32 s45, s2, 3
  s_and_b32 s46, s45, 7
  s_lshr_b32 s47, s44, 1
  s_lshl_b32 s47, s47, 3
  s_add_u32 s29, s47, s46
  s_and_b32 s44, s44, 1
  s_lshl_b32 s44, s44, 2
  s_lshr_b32 s45, s45, 3
  s_add_u32 s30, s44, s45
  s_add_u32 s44, s28, 0
  s_and_b32 s44, s44, 3
  s_lshl_b32 s45, s29, 2
  s_add_u32 s44, s44, s45
  s_mul_i32 s44, s44, 186368
  v_lshl_add_u32 v180, v0, 4, s44
  s_add_u32 s44, s28, 1
  s_and_b32 s44, s44, 3
  s_lshl_b32 s45, s29, 2
  s_add_u32 s44, s44, s45
  s_mul_i32 s44, s44, 186368
  v_lshl_add_u32 v181, v0, 4, s44
  s_add_u32 s44, s28, 2
  s_and_b32 s44, s44, 3
  s_lshl_b32 s45, s29, 2
  s_add_u32 s44, s44, s45
  s_mul_i32 s44, s44, 186368
  v_lshl_add_u32 v182, v0, 4, s44
  s_add_u32 s44, s28, 3
  s_and_b32 s44, s44, 3
  s_lshl_b32 s45, s29, 2
  s_add_u32 s44, s44, s45
  s_mul_i32 s44, s44, 186368
  v_lshl_add_u32 v183, v0, 4, s44
  s_mul_i32 s44, s30, 931840
  v_lshl_add_u32 v184, v0, 4, s44
  s_mul_i32 s46, s30, 160
  s_lshl_b32 s44, s29, 6
  s_lshl_b32 s45, s28, 4
  s_add_u32 s44, s44, s45
  v_and_b32 v240, 15, v0
  v_add_u32 v240, s44, v240
  v_mul_u32_u24 v240, 1280, v240
  v_lshrrev_b32 v241, 4, v0
  v_lshl_add_u32 v240, v241, 3, v240
  v_add_u32 v185, s46, v240
  s_add_u32 s44, s28, 1
  s_and_b32 s44, s44, 3
  s_mul_i32 s44, s44, 30720
  s_add_u32 s44, s44, 0
  v_lshl_add_u32 v186, v0, 4, s44
  s_add_u32 s44, s28, 2
  s_and_b32 s44, s44, 3
  s_mul_i32 s44, s44, 30720
  s_add_u32 s44, s44, 5120
  v_lshl_add_u32 v187, v0, 4, s44
  s_add_u32 s44, s28, 3
  s_and_b32 s44, s44, 3
  s_mul_i32 s44, s44, 30720
  s_add_u32 s44, s44, 10240
  v_lshl_add_u32 v188, v0, 4, s44
  s_mul_i32 s44, s28, 30720
  v_lshl_add_u32 v189, v0, 4, s44
  s_waitcnt lgkmcnt(0)
  s_mov_b32 s16, s48
  s_and_b32 s17, s49, 0xffff
  s_mov_b32 s18, 2621440
  s_mov_b32 s19, 0x20000
  s_mov_b32 s20, s54
  s_and_b32 s21, s55, 0xffff
  s_mov_b32 s22, 2621440
  s_mov_b32 s23, 0x20000
  s_add_u32 s58, s56, 33554432
  s_addc_u32 s59, s57, 0
  s_mov_b32 s8, s58
  s_and_b32 s9, s59, 0xffff
  s_mov_b32 s10, 7454720
  s_mov_b32 s11, 0x20000
  s_add_u32 s56, s56, 3145728
  s_addc_u32 s57, s57, 0
  s_mov_b32 s4, s56
  s_and_b32 s5, s57, 0xffff
  s_mov_b32 s6, 23855104
  s_mov_b32 s7, 0x20000
  s_lshl_b32 s35, s28, 15
  s_mul_i32 s34, s28, 14
  s_add_u32 s32, s34, 128
  s_lshl_b32 s32, s32, 10
  s_cmp_eq_u32 s28, 3
  s_cselect_b32 s36, 0x40000000, 0
  buffer_load_dwordx4 v[16:19], v184, s[8:11], s32 offen
  buffer_load_dwordx4 v[0:3], v180, s[4:7], s32 offen
  s_add_u32 s33, s32, 186368
  buffer_load_dwordx4 v[20:23], v184, s[8:11], s33 offen
  buffer_load_dwordx4 v[4:7], v181, s[4:7], s32 offen
  s_add_u32 s33, s32, 372736
  buffer_load_dwordx4 v[24:27], v184, s[8:11], s33 offen
  buffer_load_dwordx4 v[8:11], v182, s[4:7], s32 offen
  s_add_u32 s33, s32, 559104
  buffer_load_dwordx4 v[28:31], v184, s[8:11], s33 offen
  buffer_load_dwordx4 v[12:15], v183, s[4:7], s32 offen
  s_add_u32 s33, s32, 745472
  buffer_load_dwordx4 v[32:35], v184, s[8:11], s33 offen
  s_add_u32 s32, s32, 1024
  buffer_load_dwordx4 v[52:55], v184, s[8:11], s32 offen
  buffer_load_dwordx4 v[36:39], v180, s[4:7], s32 offen
  s_add_u32 s33, s32, 186368
  buffer_load_dwordx4 v[56:59], v184, s[8:11], s33 offen
  buffer_load_dwordx4 v[40:43], v181, s[4:7], s32 offen
  s_add_u32 s33, s32, 372736
  buffer_load_dwordx4 v[60:63], v184, s[8:11], s33 offen
  buffer_load_dwordx4 v[44:47], v182, s[4:7], s32 offen
  s_add_u32 s33, s32, 559104
  buffer_load_dwordx4 v[64:67], v184, s[8:11], s33 offen
  buffer_load_dwordx4 v[48:51], v183, s[4:7], s32 offen
  s_add_u32 s33, s32, 745472
  buffer_load_dwordx4 v[68:71], v184, s[8:11], s33 offen
  s_add_u32 s32, s32, 1024
  buffer_load_dwordx4 v[88:91], v184, s[8:11], s32 offen
  buffer_load_dwordx4 v[72:75], v180, s[4:7], s32 offen
  s_add_u32 s33, s32, 186368
  buffer_load_dwordx4 v[92:95], v184, s[8:11], s33 offen
  buffer_load_dwordx4 v[76:79], v181, s[4:7], s32 offen
  s_add_u32 s33, s32, 372736
  buffer_load_dwordx4 v[96:99], v184, s[8:11], s33 offen
  buffer_load_dwordx4 v[80:83], v182, s[4:7], s32 offen
  s_add_u32 s33, s32, 559104
  buffer_load_dwordx4 v[100:103], v184, s[8:11], s33 offen
  buffer_load_dwordx4 v[84:87], v183, s[4:7], s32 offen
  s_add_u32 s33, s32, 745472
  buffer_load_dwordx4 v[104:107], v184, s[8:11], s33 offen
  s_add_u32 s32, s32, 1024
  buffer_load_dwordx4 v[124:127], v184, s[8:11], s32 offen
  buffer_load_dwordx4 v[108:111], v180, s[4:7], s32 offen
  s_add_u32 s33, s32, 186368
  buffer_load_dwordx4 v[128:131], v184, s[8:11], s33 offen
  buffer_load_dwordx4 v[112:115], v181, s[4:7], s32 offen
  s_add_u32 s33, s32, 372736
  buffer_load_dwordx4 v[132:135], v184, s[8:11], s33 offen
  buffer_load_dwordx4 v[116:119], v182, s[4:7], s32 offen
  s_add_u32 s33, s32, 559104
  buffer_load_dwordx4 v[136:139], v184, s[8:11], s33 offen
  buffer_load_dwordx4 v[120:123], v183, s[4:7], s32 offen
  s_add_u32 s33, s32, 745472
  buffer_load_dwordx4 v[140:143], v184, s[8:11], s33 offen
  s_add_u32 s32, s32, 1024
  buffer_load_dwordx2 v[190:191], v185, s[16:19], 0 offen offset:0
  buffer_load_dwordx2 v[192:193], v185, s[16:19], 0 offen offset:32
  buffer_load_dwordx2 v[194:195], v185, s[16:19], 0 offen offset:64
  buffer_load_dwordx2 v[196:197], v185, s[16:19], 0 offen offset:96
  buffer_load_dwordx2 v[198:199], v185, s[16:19], 0 offen offset:128
  s_waitcnt vmcnt(32)
  v_mfma_f32_16x16x32_bf16 a[80:83], v[16:19], v[0:3], 0
  buffer_load_dwordx4 v[160:163], v184, s[8:11], s32 offen
  v_mfma_f32_16x16x32_bf16 a[100:103], v[16:19], v[4:7], 0
  v_mfma_f32_16x16x32_bf16 a[120:123], v[16:19], v[8:11], 0
  buffer_load_dwordx4 v[144:147], v180, s[4:7], s32 offen
  v_mfma_f32_16x16x32_bf16 a[140:143], v[16:19], v[12:15], 0
  v_mfma_f32_16x16x32_bf16 a[84:87], v[20:23], v[0:3], 0
  s_add_u32 s33, s32, 186368
  buffer_load_dwordx4 v[164:167], v184, s[8:11], s33 offen
  v_mfma_f32_16x16x32_bf16 a[104:107], v[20:23], v[4:7], 0
  v_mfma_f32_16x16x32_bf16 a[124:127], v[20:23], v[8:11], 0
  buffer_load_dwordx4 v[148:151], v181, s[4:7], s32 offen
  v_mfma_f32_16x16x32_bf16 a[144:147], v[20:23], v[12:15], 0
  v_mfma_f32_16x16x32_bf16 a[88:91], v[24:27], v[0:3], 0
  s_add_u32 s33, s32, 372736
  buffer_load_dwordx4 v[168:171], v184, s[8:11], s33 offen
  v_mfma_f32_16x16x32_bf16 a[108:111], v[24:27], v[4:7], 0
  v_mfma_f32_16x16x32_bf16 a[128:131], v[24:27], v[8:11], 0
  buffer_load_dwordx4 v[152:155], v182, s[4:7], s32 offen
  v_mfma_f32_16x16x32_bf16 a[148:151], v[24:27], v[12:15], 0
  v_mfma_f32_16x16x32_bf16 a[92:95], v[28:31], v[0:3], 0
  s_add_u32 s33, s32, 559104
  buffer_load_dwordx4 v[172:175], v184, s[8:11], s33 offen
  v_mfma_f32_16x16x32_bf16 a[112:115], v[28:31], v[4:7], 0
  v_mfma_f32_16x16x32_bf16 a[132:135], v[28:31], v[8:11], 0
  buffer_load_dwordx4 v[156:159], v183, s[4:7], s32 offen
  v_mfma_f32_16x16x32_bf16 a[152:155], v[28:31], v[12:15], 0
  v_mfma_f32_16x16x32_bf16 a[96:99], v[32:35], v[0:3], 0
  s_add_u32 s33, s32, 745472
  buffer_load_dwordx4 v[176:179], v184, s[8:11], s33 offen
  v_mfma_f32_16x16x32_bf16 a[116:119], v[32:35], v[4:7], 0
  v_mfma_f32_16x16x32_bf16 a[136:139], v[32:35], v[8:11], 0
  s_add_u32 s32, s32, 1024
  v_mfma_f32_16x16x32_bf16 a[156:159], v[32:35], v[12:15], 0
  s_waitcnt vmcnt(32)
  v_mfma_f32_16x16x32_bf16 a[80:83], v[52:55], v[36:39], a[80:83]
  buffer_load_dwordx4 v[16:19], v184, s[8:11], s32 offen
  v_mfma_f32_16x16x32_bf16 a[100:103], v[52:55], v[40:43], a[100:103]
  v_mfma_f32_16x16x32_bf16 a[120:123], v[52:55], v[44:47], a[120:123]
  buffer_load_dwordx4 v[0:3], v180, s[4:7], s32 offen
  v_mfma_f32_16x16x32_bf16 a[140:143], v[52:55], v[48:51], a[140:143]
  v_mfma_f32_16x16x32_bf16 a[84:87], v[56:59], v[36:39], a[84:87]
  s_add_u32 s33, s32, 186368
  buffer_load_dwordx4 v[20:23], v184, s[8:11], s33 offen
  v_mfma_f32_16x16x32_bf16 a[104:107], v[56:59], v[40:43], a[104:107]
  v_mfma_f32_16x16x32_bf16 a[124:127], v[56:59], v[44:47], a[124:127]
  buffer_load_dwordx4 v[4:7], v181, s[4:7], s32 offen
  v_mfma_f32_16x16x32_bf16 a[144:147], v[56:59], v[48:51], a[144:147]
  v_mfma_f32_16x16x32_bf16 a[88:91], v[60:63], v[36:39], a[88:91]
  s_add_u32 s33, s32, 372736
  buffer_load_dwordx4 v[24:27], v184, s[8:11], s33 offen
  v_mfma_f32_16x16x32_bf16 a[108:111], v[60:63], v[40:43], a[108:111]
  v_mfma_f32_16x16x32_bf16 a[128:131], v[60:63], v[44:47], a[128:131]
  buffer_load_dwordx4 v[8:11], v182, s[4:7], s32 offen
  v_mfma_f32_16x16x32_bf16 a[148:151], v[60:63], v[48:51], a[148:151]
  v_mfma_f32_16x16x32_bf16 a[92:95], v[64:67], v[36:39], a[92:95]
  s_add_u32 s33, s32, 559104
  buffer_load_dwordx4 v[28:31], v184, s[8:11], s33 offen
  v_mfma_f32_16x16x32_bf16 a[112:115], v[64:67], v[40:43], a[112:115]
  v_mfma_f32_16x16x32_bf16 a[132:135], v[64:67], v[44:47], a[132:135]
  buffer_load_dwordx4 v[12:15], v183, s[4:7], s32 offen
  v_mfma_f32_16x16x32_bf16 a[152:155], v[64:67], v[48:51], a[152:155]
  v_mfma_f32_16x16x32_bf16 a[96:99], v[68:71], v[36:39], a[96:99]
  s_add_u32 s33, s32, 745472
  buffer_load_dwordx4 v[32:35], v184, s[8:11], s33 offen
  v_mfma_f32_16x16x32_bf16 a[116:119], v[68:71], v[40:43], a[116:119]
  v_mfma_f32_16x16x32_bf16 a[136:139], v[68:71], v[44:47], a[136:139]
  s_add_u32 s32, s32, 1024
  v_mfma_f32_16x16x32_bf16 a[156:159], v[68:71], v[48:51], a[156:159]
  s_waitcnt vmcnt(32)
  v_mfma_f32_16x16x32_bf16 a[80:83], v[88:91], v[72:75], a[80:83]
  buffer_load_dwordx4 v[52:55], v184, s[8:11], s32 offen
  v_mfma_f32_16x16x32_bf16 a[100:103], v[88:91], v[76:79], a[100:103]
  v_mfma_f32_16x16x32_bf16 a[120:123], v[88:91], v[80:83], a[120:123]
  buffer_load_dwordx4 v[36:39], v180, s[4:7], s32 offen
  v_mfma_f32_16x16x32_bf16 a[140:143], v[88:91], v[84:87], a[140:143]
  v_mfma_f32_16x16x32_bf16 a[84:87], v[92:95], v[72:75], a[84:87]
  s_add_u32 s33, s32, 186368
  buffer_load_dwordx4 v[56:59], v184, s[8:11], s33 offen
  v_mfma_f32_16x16x32_bf16 a[104:107], v[92:95], v[76:79], a[104:107]
  v_mfma_f32_16x16x32_bf16 a[124:127], v[92:95], v[80:83], a[124:127]
  buffer_load_dwordx4 v[40:43], v181, s[4:7], s32 offen
  v_mfma_f32_16x16x32_bf16 a[144:147], v[92:95], v[84:87], a[144:147]
  v_mfma_f32_16x16x32_bf16 a[88:91], v[96:99], v[72:75], a[88:91]
  s_add_u32 s33, s32, 372736
  buffer_load_dwordx4 v[60:63], v184, s[8:11], s33 offen
  v_mfma_f32_16x16x32_bf16 a[108:111], v[96:99], v[76:79], a[108:111]
  v_mfma_f32_16x16x32_bf16 a[128:131], v[96:99], v[80:83], a[128:131]
  buffer_load_dwordx4 v[44:47], v182, s[4:7], s32 offen
  v_mfma_f32_16x16x32_bf16 a[148:151], v[96:99], v[84:87], a[148:151]
  v_mfma_f32_16x16x32_bf16 a[92:95], v[100:103], v[72:75], a[92:95]
  s_add_u32 s33, s32, 559104
  buffer_load_dwordx4 v[64:67], v184, s[8:11], s33 offen
  v_mfma_f32_16x16x32_bf16 a[112:115], v[100:103], v[76:79], a[112:115]
  v_mfma_f32_16x16x32_bf16 a[132:135], v[100:103], v[80:83], a[132:135]
  buffer_load_dwordx4 v[48:51], v183, s[4:7], s32 offen
  v_mfma_f32_16x16x32_bf16 a[152:155], v[100:103], v[84:87], a[152:155]
  v_mfma_f32_16x16x32_bf16 a[96:99], v[104:107], v[72:75], a[96:99]
  s_add_u32 s33, s32, 745472
  buffer_load_dwordx4 v[68:71], v184, s[8:11], s33 offen
  v_mfma_f32_16x16x32_bf16 a[116:119], v[104:107], v[76:79], a[116:119]
  v_mfma_f32_16x16x32_bf16 a[136:139], v[104:107], v[80:83], a[136:139]
  s_add_u32 s32, s32, 1024
  v_mfma_f32_16x16x32_bf16 a[156:159], v[104:107], v[84:87], a[156:159]
  s_waitcnt vmcnt(32)
  v_mfma_f32_16x16x32_bf16 a[80:83], v[124:127], v[108:111], a[80:83]
  buffer_load_dwordx4 v[88:91], v184, s[8:11], s32 offen
  v_mfma_f32_16x16x32_bf16 a[100:103], v[124:127], v[112:115], a[100:103]
  v_mfma_f32_16x16x32_bf16 a[120:123], v[124:127], v[116:119], a[120:123]
  buffer_load_dwordx4 v[72:75], v180, s[4:7], s32 offen
  v_mfma_f32_16x16x32_bf16 a[140:143], v[124:127], v[120:123], a[140:143]
  v_mfma_f32_16x16x32_bf16 a[84:87], v[128:131], v[108:111], a[84:87]
  s_add_u32 s33, s32, 186368
  buffer_load_dwordx4 v[92:95], v184, s[8:11], s33 offen
  v_mfma_f32_16x16x32_bf16 a[104:107], v[128:131], v[112:115], a[104:107]
  v_mfma_f32_16x16x32_bf16 a[124:127], v[128:131], v[116:119], a[124:127]
  buffer_load_dwordx4 v[76:79], v181, s[4:7], s32 offen
  v_mfma_f32_16x16x32_bf16 a[144:147], v[128:131], v[120:123], a[144:147]
  v_mfma_f32_16x16x32_bf16 a[88:91], v[132:135], v[108:111], a[88:91]
  s_add_u32 s33, s32, 372736
  buffer_load_dwordx4 v[96:99], v184, s[8:11], s33 offen
  v_mfma_f32_16x16x32_bf16 a[108:111], v[132:135], v[112:115], a[108:111]
  v_mfma_f32_16x16x32_bf16 a[128:131], v[132:135], v[116:119], a[128:131]
  buffer_load_dwordx4 v[80:83], v182, s[4:7], s32 offen
  v_mfma_f32_16x16x32_bf16 a[148:151], v[132:135], v[120:123], a[148:151]
  v_mfma_f32_16x16x32_bf16 a[92:95], v[136:139], v[108:111], a[92:95]
  s_add_u32 s33, s32, 559104
  buffer_load_dwordx4 v[100:103], v184, s[8:11], s33 offen
  v_mfma_f32_16x16x32_bf16 a[112:115], v[136:139], v[112:115], a[112:115]
  v_mfma_f32_16x16x32_bf16 a[132:135], v[136:139], v[116:119], a[132:135]
  buffer_load_dwordx4 v[84:87], v183, s[4:7], s32 offen
  v_mfma_f32_16x16x32_bf16 a[152:155], v[136:139], v[120:123], a[152:155]
  v_mfma_f32_16x16x32_bf16 a[96:99], v[140:143], v[108:111], a[96:99]
  s_add_u32 s33, s32, 745472
  buffer_load_dwordx4 v[104:107], v184, s[8:11], s33 offen
  v_mfma_f32_16x16x32_bf16 a[116:119], v[140:143], v[112:115], a[116:119]
  v_mfma_f32_16x16x32_bf16 a[136:139], v[140:143], v[116:119], a[136:139]
  s_add_u32 s32, s32, 1024
  v_mfma_f32_16x16x32_bf16 a[156:159], v[140:143], v[120:123], a[156:159]
  s_waitcnt vmcnt(27)
  v_mfma_f32_16x16x32_bf16 a[80:83], v[160:163], v[144:147], a[80:83]
  buffer_load_dwordx4 v[124:127], v184, s[8:11], s32 offen
  v_mfma_f32_16x16x32_bf16 a[100:103], v[160:163], v[148:151], a[100:103]
  v_mfma_f32_16x16x32_bf16 a[120:123], v[160:163], v[152:155], a[120:123]
  buffer_load_dwordx4 v[108:111], v180, s[4:7], s32 offen
  v_mfma_f32_16x16x32_bf16 a[140:143], v[160:163], v[156:159], a[140:143]
  v_mfma_f32_16x16x32_bf16 a[84:87], v[164:167], v[144:147], a[84:87]
  s_add_u32 s33, s32, 186368
  buffer_load_dwordx4 v[128:131], v184, s[8:11], s33 offen
  v_mfma_f32_16x16x32_bf16 a[104:107], v[164:167], v[148:151], a[104:107]
  v_mfma_f32_16x16x32_bf16 a[124:127], v[164:167], v[152:155], a[124:127]
  buffer_load_dwordx4 v[112:115], v181, s[4:7], s32 offen
  v_mfma_f32_16x16x32_bf16 a[144:147], v[164:167], v[156:159], a[144:147]
  v_mfma_f32_16x16x32_bf16 a[88:91], v[168:171], v[144:147], a[88:91]
  s_add_u32 s33, s32, 372736
  buffer_load_dwordx4 v[132:135], v184, s[8:11], s33 offen
  v_mfma_f32_16x16x32_bf16 a[108:111], v[168:171], v[148:151], a[108:111]
  v_mfma_f32_16x16x32_bf16 a[128:131], v[168:171], v[152:155], a[128:131]
  buffer_load_dwordx4 v[116:119], v182, s[4:7], s32 offen
  v_mfma_f32_16x16x32_bf16 a[148:151], v[168:171], v[156:159], a[148:151]
  v_mfma_f32_16x16x32_bf16 a[92:95], v[172:175], v[144:147], a[92:95]
  s_add_u32 s33, s32, 559104
  buffer_load_dwordx4 v[136:139], v184, s[8:11], s33 offen
  v_mfma_f32_16x16x32_bf16 a[112:115], v[172:175], v[148:151], a[112:115]
  v_mfma_f32_16x16x32_bf16 a[132:135], v[172:175], v[152:155], a[132:135]
  buffer_load_dwordx4 v[120:123], v183, s[4:7], s32 offen
  v_mfma_f32_16x16x32_bf16 a[152:155], v[172:175], v[156:159], a[152:155]
  v_mfma_f32_16x16x32_bf16 a[96:99], v[176:179], v[144:147], a[96:99]
  s_add_u32 s33, s32, 745472
  buffer_load_dwordx4 v[140:143], v184, s[8:11], s33 offen
  v_mfma_f32_16x16x32_bf16 a[116:119], v[176:179], v[148:151], a[116:119]
  v_mfma_f32_16x16x32_bf16 a[136:139], v[176:179], v[152:155], a[136:139]
  s_add_u32 s32, s32, 1024
  v_mfma_f32_16x16x32_bf16 a[156:159], v[176:179], v[156:159], a[156:159]
  s_waitcnt vmcnt(27)
  v_mfma_f32_16x16x32_bf16 a[80:83], v[16:19], v[0:3], a[80:83]
  buffer_load_dwordx4 v[160:163], v184, s[8:11], s32 offen
  v_mfma_f32_16x16x32_bf16 a[100:103], v[16:19], v[4:7], a[100:103]
  v_mfma_f32_16x16x32_bf16 a[120:123], v[16:19], v[8:11], a[120:123]
  buffer_load_dwordx4 v[144:147], v180, s[4:7], s32 offen
  v_mfma_f32_16x16x32_bf16 a[140:143], v[16:19], v[12:15], a[140:143]
  v_mfma_f32_16x16x32_bf16 a[84:87], v[20:23], v[0:3], a[84:87]
  s_add_u32 s33, s32, 186368
  buffer_load_dwordx4 v[164:167], v184, s[8:11], s33 offen
  v_mfma_f32_16x16x32_bf16 a[104:107], v[20:23], v[4:7], a[104:107]
  v_mfma_f32_16x16x32_bf16 a[124:127], v[20:23], v[8:11], a[124:127]
  buffer_load_dwordx4 v[148:151], v181, s[4:7], s32 offen
  v_mfma_f32_16x16x32_bf16 a[144:147], v[20:23], v[12:15], a[144:147]
  v_mfma_f32_16x16x32_bf16 a[88:91], v[24:27], v[0:3], a[88:91]
  s_add_u32 s33, s32, 372736
  buffer_load_dwordx4 v[168:171], v184, s[8:11], s33 offen
  v_mfma_f32_16x16x32_bf16 a[108:111], v[24:27], v[4:7], a[108:111]
  v_mfma_f32_16x16x32_bf16 a[128:131], v[24:27], v[8:11], a[128:131]
  buffer_load_dwordx4 v[152:155], v182, s[4:7], s32 offen
  v_mfma_f32_16x16x32_bf16 a[148:151], v[24:27], v[12:15], a[148:151]
  v_mfma_f32_16x16x32_bf16 a[92:95], v[28:31], v[0:3], a[92:95]
  s_add_u32 s33, s32, 559104
  buffer_load_dwordx4 v[172:175], v184, s[8:11], s33 offen
  v_mfma_f32_16x16x32_bf16 a[112:115], v[28:31], v[4:7], a[112:115]
  v_mfma_f32_16x16x32_bf16 a[132:135], v[28:31], v[8:11], a[132:135]
  buffer_load_dwordx4 v[156:159], v183, s[4:7], s32 offen
  v_mfma_f32_16x16x32_bf16 a[152:155], v[28:31], v[12:15], a[152:155]
  v_mfma_f32_16x16x32_bf16 a[96:99], v[32:35], v[0:3], a[96:99]
  s_add_u32 s33, s32, 745472
  buffer_load_dwordx4 v[176:179], v184, s[8:11], s33 offen
  v_mfma_f32_16x16x32_bf16 a[116:119], v[32:35], v[4:7], a[116:119]
  v_mfma_f32_16x16x32_bf16 a[136:139], v[32:35], v[8:11], a[136:139]
  s_add_u32 s32, s32, 1024
  v_mfma_f32_16x16x32_bf16 a[156:159], v[32:35], v[12:15], a[156:159]
  s_waitcnt vmcnt(27)
  v_mfma_f32_16x16x32_bf16 a[80:83], v[52:55], v[36:39], a[80:83]
  buffer_load_dwordx4 v[16:19], v184, s[8:11], s32 offen
  v_mfma_f32_16x16x32_bf16 a[100:103], v[52:55], v[40:43], a[100:103]
  v_mfma_f32_16x16x32_bf16 a[120:123], v[52:55], v[44:47], a[120:123]
  buffer_load_dwordx4 v[0:3], v180, s[4:7], s32 offen
  v_mfma_f32_16x16x32_bf16 a[140:143], v[52:55], v[48:51], a[140:143]
  v_mfma_f32_16x16x32_bf16 a[84:87], v[56:59], v[36:39], a[84:87]
  s_add_u32 s33, s32, 186368
  buffer_load_dwordx4 v[20:23], v184, s[8:11], s33 offen
  v_mfma_f32_16x16x32_bf16 a[104:107], v[56:59], v[40:43], a[104:107]
  v_mfma_f32_16x16x32_bf16 a[124:127], v[56:59], v[44:47], a[124:127]
  buffer_load_dwordx4 v[4:7], v181, s[4:7], s32 offen
  v_mfma_f32_16x16x32_bf16 a[144:147], v[56:59], v[48:51], a[144:147]
  v_mfma_f32_16x16x32_bf16 a[88:91], v[60:63], v[36:39], a[88:91]
  s_add_u32 s33, s32, 372736
  buffer_load_dwordx4 v[24:27], v184, s[8:11], s33 offen
  v_mfma_f32_16x16x32_bf16 a[108:111], v[60:63], v[40:43], a[108:111]
  v_mfma_f32_16x16x32_bf16 a[128:131], v[60:63], v[44:47], a[128:131]
  buffer_load_dwordx4 v[8:11], v182, s[4:7], s32 offen
  v_mfma_f32_16x16x32_bf16 a[148:151], v[60:63], v[48:51], a[148:151]
  v_mfma_f32_16x16x32_bf16 a[92:95], v[64:67], v[36:39], a[92:95]
  s_add_u32 s33, s32, 559104
  buffer_load_dwordx4 v[28:31], v184, s[8:11], s33 offen
  v_mfma_f32_16x16x32_bf16 a[112:115], v[64:67], v[40:43], a[112:115]
  v_mfma_f32_16x16x32_bf16 a[132:135], v[64:67], v[44:47], a[132:135]
  buffer_load_dwordx4 v[12:15], v183, s[4:7], s32 offen
  v_mfma_f32_16x16x32_bf16 a[152:155], v[64:67], v[48:51], a[152:155]
  v_mfma_f32_16x16x32_bf16 a[96:99], v[68:71], v[36:39], a[96:99]
  s_add_u32 s33, s32, 745472
  buffer_load_dwordx4 v[32:35], v184, s[8:11], s33 offen
  v_mfma_f32_16x16x32_bf16 a[116:119], v[68:71], v[40:43], a[116:119]
  v_mfma_f32_16x16x32_bf16 a[136:139], v[68:71], v[44:47], a[136:139]
  s_add_u32 s32, s32, 1024
  v_mfma_f32_16x16x32_bf16 a[156:159], v[68:71], v[48:51], a[156:159]
  s_waitcnt vmcnt(27)
  v_mfma_f32_16x16x32_bf16 a[80:83], v[88:91], v[72:75], a[80:83]
  buffer_load_dwordx4 v[52:55], v184, s[8:11], s32 offen
  v_mfma_f32_16x16x32_bf16 a[100:103], v[88:91], v[76:79], a[100:103]
  v_mfma_f32_16x16x32_bf16 a[120:123], v[88:91], v[80:83], a[120:123]
  buffer_load_dwordx4 v[36:39], v180, s[4:7], s32 offen
  v_mfma_f32_16x16x32_bf16 a[140:143], v[88:91], v[84:87], a[140:143]
  v_mfma_f32_16x16x32_bf16 a[84:87], v[92:95], v[72:75], a[84:87]
  s_add_u32 s33, s32, 186368
  buffer_load_dwordx4 v[56:59], v184, s[8:11], s33 offen
  v_mfma_f32_16x16x32_bf16 a[104:107], v[92:95], v[76:79], a[104:107]
  v_mfma_f32_16x16x32_bf16 a[124:127], v[92:95], v[80:83], a[124:127]
  buffer_load_dwordx4 v[40:43], v181, s[4:7], s32 offen
  v_mfma_f32_16x16x32_bf16 a[144:147], v[92:95], v[84:87], a[144:147]
  v_mfma_f32_16x16x32_bf16 a[88:91], v[96:99], v[72:75], a[88:91]
  s_add_u32 s33, s32, 372736
  buffer_load_dwordx4 v[60:63], v184, s[8:11], s33 offen
  v_mfma_f32_16x16x32_bf16 a[108:111], v[96:99], v[76:79], a[108:111]
  v_mfma_f32_16x16x32_bf16 a[128:131], v[96:99], v[80:83], a[128:131]
  buffer_load_dwordx4 v[44:47], v182, s[4:7], s32 offen
  v_mfma_f32_16x16x32_bf16 a[148:151], v[96:99], v[84:87], a[148:151]
  v_mfma_f32_16x16x32_bf16 a[92:95], v[100:103], v[72:75], a[92:95]
  s_add_u32 s33, s32, 559104
  buffer_load_dwordx4 v[64:67], v184, s[8:11], s33 offen
  v_mfma_f32_16x16x32_bf16 a[112:115], v[100:103], v[76:79], a[112:115]
  v_mfma_f32_16x16x32_bf16 a[132:135], v[100:103], v[80:83], a[132:135]
  buffer_load_dwordx4 v[48:51], v183, s[4:7], s32 offen
  v_mfma_f32_16x16x32_bf16 a[152:155], v[100:103], v[84:87], a[152:155]
  v_mfma_f32_16x16x32_bf16 a[96:99], v[104:107], v[72:75], a[96:99]
  s_add_u32 s33, s32, 745472
  buffer_load_dwordx4 v[68:71], v184, s[8:11], s33 offen
  v_mfma_f32_16x16x32_bf16 a[116:119], v[104:107], v[76:79], a[116:119]
  v_mfma_f32_16x16x32_bf16 a[136:139], v[104:107], v[80:83], a[136:139]
  s_add_u32 s32, s32, 1024
  v_mfma_f32_16x16x32_bf16 a[156:159], v[104:107], v[84:87], a[156:159]
  s_waitcnt vmcnt(27)
  v_mfma_f32_16x16x32_bf16 a[80:83], v[124:127], v[108:111], a[80:83]
  s_add_u32 s32, s32, s36
  buffer_load_dwordx4 v[88:91], v184, s[8:11], s32 offen
  v_mfma_f32_16x16x32_bf16 a[100:103], v[124:127], v[112:115], a[100:103]
  v_mfma_f32_16x16x32_bf16 a[120:123], v[124:127], v[116:119], a[120:123]
  buffer_load_dwordx4 v[72:75], v180, s[4:7], s32 offen
  v_mfma_f32_16x16x32_bf16 a[140:143], v[124:127], v[120:123], a[140:143]
  v_mfma_f32_16x16x32_bf16 a[84:87], v[128:131], v[108:111], a[84:87]
  s_add_u32 s33, s32, 186368
  buffer_load_dwordx4 v[92:95], v184, s[8:11], s33 offen
  v_mfma_f32_16x16x32_bf16 a[104:107], v[128:131], v[112:115], a[104:107]
  v_mfma_f32_16x16x32_bf16 a[124:127], v[128:131], v[116:119], a[124:127]
  buffer_load_dwordx4 v[76:79], v181, s[4:7], s32 offen
  v_mfma_f32_16x16x32_bf16 a[144:147], v[128:131], v[120:123], a[144:147]
  v_mfma_f32_16x16x32_bf16 a[88:91], v[132:135], v[108:111], a[88:91]
  s_add_u32 s33, s32, 372736
  buffer_load_dwordx4 v[96:99], v184, s[8:11], s33 offen
  v_mfma_f32_16x16x32_bf16 a[108:111], v[132:135], v[112:115], a[108:111]
  v_mfma_f32_16x16x32_bf16 a[128:131], v[132:135], v[116:119], a[128:131]
  buffer_load_dwordx4 v[80:83], v182, s[4:7], s32 offen
  v_mfma_f32_16x16x32_bf16 a[148:151], v[132:135], v[120:123], a[148:151]
  v_mfma_f32_16x16x32_bf16 a[92:95], v[136:139], v[108:111], a[92:95]
  s_add_u32 s33, s32, 559104
  buffer_load_dwordx4 v[100:103], v184, s[8:11], s33 offen
  v_mfma_f32_16x16x32_bf16 a[112:115], v[136:139], v[112:115], a[112:115]
  v_mfma_f32_16x16x32_bf16 a[132:135], v[136:139], v[116:119], a[132:135]
  buffer_load_dwordx4 v[84:87], v183, s[4:7], s32 offen
  v_mfma_f32_16x16x32_bf16 a[152:155], v[136:139], v[120:123], a[152:155]
  v_mfma_f32_16x16x32_bf16 a[96:99], v[140:143], v[108:111], a[96:99]
  s_add_u32 s33, s32, 745472
  buffer_load_dwordx4 v[104:107], v184, s[8:11], s33 offen
  v_mfma_f32_16x16x32_bf16 a[116:119], v[140:143], v[112:115], a[116:119]
  v_mfma_f32_16x16x32_bf16 a[136:139], v[140:143], v[116:119], a[136:139]
  s_add_u32 s32, s32, 1024
  v_mfma_f32_16x16x32_bf16 a[156:159], v[140:143], v[120:123], a[156:159]
  s_waitcnt vmcnt(27)
  v_mfma_f32_16x16x32_bf16 a[80:83], v[160:163], v[144:147], a[80:83]
  buffer_load_dwordx4 v[124:127], v184, s[8:11], s32 offen
  v_mfma_f32_16x16x32_bf16 a[100:103], v[160:163], v[148:151], a[100:103]
  v_mfma_f32_16x16x32_bf16 a[120:123], v[160:163], v[152:155], a[120:123]
  buffer_load_dwordx4 v[108:111], v180, s[4:7], s32 offen
  v_mfma_f32_16x16x32_bf16 a[140:143], v[160:163], v[156:159], a[140:143]
  v_mfma_f32_16x16x32_bf16 a[84:87], v[164:167], v[144:147], a[84:87]
  s_add_u32 s33, s32, 186368
  buffer_load_dwordx4 v[128:131], v184, s[8:11], s33 offen
  v_mfma_f32_16x16x32_bf16 a[104:107], v[164:167], v[148:151], a[104:107]
  v_mfma_f32_16x16x32_bf16 a[124:127], v[164:167], v[152:155], a[124:127]
  buffer_load_dwordx4 v[112:115], v181, s[4:7], s32 offen
  v_mfma_f32_16x16x32_bf16 a[144:147], v[164:167], v[156:159], a[144:147]
  v_mfma_f32_16x16x32_bf16 a[88:91], v[168:171], v[144:147], a[88:91]
  s_add_u32 s33, s32, 372736
  buffer_load_dwordx4 v[132:135], v184, s[8:11], s33 offen
  v_mfma_f32_16x16x32_bf16 a[108:111], v[168:171], v[148:151], a[108:111]
  v_mfma_f32_16x16x32_bf16 a[128:131], v[168:171], v[152:155], a[128:131]
  buffer_load_dwordx4 v[116:119], v182, s[4:7], s32 offen
  v_mfma_f32_16x16x32_bf16 a[148:151], v[168:171], v[156:159], a[148:151]
  v_mfma_f32_16x16x32_bf16 a[92:95], v[172:175], v[144:147], a[92:95]
  s_add_u32 s33, s32, 559104
  buffer_load_dwordx4 v[136:139], v184, s[8:11], s33 offen
  v_mfma_f32_16x16x32_bf16 a[112:115], v[172:175], v[148:151], a[112:115]
  v_mfma_f32_16x16x32_bf16 a[132:135], v[172:175], v[152:155], a[132:135]
  buffer_load_dwordx4 v[120:123], v183, s[4:7], s32 offen
  v_mfma_f32_16x16x32_bf16 a[152:155], v[172:175], v[156:159], a[152:155]
  v_mfma_f32_16x16x32_bf16 a[96:99], v[176:179], v[144:147], a[96:99]
  s_add_u32 s33, s32, 745472
  buffer_load_dwordx4 v[140:143], v184, s[8:11], s33 offen
  v_mfma_f32_16x16x32_bf16 a[116:119], v[176:179], v[148:151], a[116:119]
  v_mfma_f32_16x16x32_bf16 a[136:139], v[176:179], v[152:155], a[136:139]
  s_add_u32 s32, s32, 1024
  v_mfma_f32_16x16x32_bf16 a[156:159], v[176:179], v[156:159], a[156:159]
  s_waitcnt vmcnt(27)
  v_mfma_f32_16x16x32_bf16 a[80:83], v[16:19], v[0:3], a[80:83]
  s_mov_b32 s32, s35
  buffer_load_dwordx4 v[160:163], v184, s[8:11], s32 offen
  v_mfma_f32_16x16x32_bf16 a[100:103], v[16:19], v[4:7], a[100:103]
  v_mfma_f32_16x16x32_bf16 a[120:123], v[16:19], v[8:11], a[120:123]
  buffer_load_dwordx4 v[144:147], v180, s[4:7], s32 offen
  v_mfma_f32_16x16x32_bf16 a[140:143], v[16:19], v[12:15], a[140:143]
  v_mfma_f32_16x16x32_bf16 a[84:87], v[20:23], v[0:3], a[84:87]
  s_add_u32 s33, s32, 186368
  buffer_load_dwordx4 v[164:167], v184, s[8:11], s33 offen
  v_mfma_f32_16x16x32_bf16 a[104:107], v[20:23], v[4:7], a[104:107]
  v_mfma_f32_16x16x32_bf16 a[124:127], v[20:23], v[8:11], a[124:127]
  buffer_load_dwordx4 v[148:151], v181, s[4:7], s32 offen
  v_mfma_f32_16x16x32_bf16 a[144:147], v[20:23], v[12:15], a[144:147]
  v_mfma_f32_16x16x32_bf16 a[88:91], v[24:27], v[0:3], a[88:91]
  s_add_u32 s33, s32, 372736
  buffer_load_dwordx4 v[168:171], v184, s[8:11], s33 offen
  v_mfma_f32_16x16x32_bf16 a[108:111], v[24:27], v[4:7], a[108:111]
  v_mfma_f32_16x16x32_bf16 a[128:131], v[24:27], v[8:11], a[128:131]
  buffer_load_dwordx4 v[152:155], v182, s[4:7], s32 offen
  v_mfma_f32_16x16x32_bf16 a[148:151], v[24:27], v[12:15], a[148:151]
  v_mfma_f32_16x16x32_bf16 a[92:95], v[28:31], v[0:3], a[92:95]
  s_add_u32 s33, s32, 559104
  buffer_load_dwordx4 v[172:175], v184, s[8:11], s33 offen
  v_mfma_f32_16x16x32_bf16 a[112:115], v[28:31], v[4:7], a[112:115]
  v_mfma_f32_16x16x32_bf16 a[132:135], v[28:31], v[8:11], a[132:135]
  buffer_load_dwordx4 v[156:159], v183, s[4:7], s32 offen
  v_mfma_f32_16x16x32_bf16 a[152:155], v[28:31], v[12:15], a[152:155]
  v_mfma_f32_16x16x32_bf16 a[96:99], v[32:35], v[0:3], a[96:99]
  s_add_u32 s33, s32, 745472
  buffer_load_dwordx4 v[176:179], v184, s[8:11], s33 offen
  v_mfma_f32_16x16x32_bf16 a[116:119], v[32:35], v[4:7], a[116:119]
  v_mfma_f32_16x16x32_bf16 a[136:139], v[32:35], v[8:11], a[136:139]
  s_add_u32 s32, s32, 1024
  v_mfma_f32_16x16x32_bf16 a[156:159], v[32:35], v[12:15], a[156:159]
  s_waitcnt vmcnt(27)
  v_mfma_f32_16x16x32_bf16 a[80:83], v[52:55], v[36:39], a[80:83]
  buffer_load_dwordx4 v[16:19], v184, s[8:11], s32 offen
  v_mfma_f32_16x16x32_bf16 a[100:103], v[52:55], v[40:43], a[100:103]
  v_mfma_f32_16x16x32_bf16 a[120:123], v[52:55], v[44:47], a[120:123]
  buffer_load_dwordx4 v[0:3], v180, s[4:7], s32 offen
  v_mfma_f32_16x16x32_bf16 a[140:143], v[52:55], v[48:51], a[140:143]
  v_mfma_f32_16x16x32_bf16 a[84:87], v[56:59], v[36:39], a[84:87]
  s_add_u32 s33, s32, 186368
  buffer_load_dwordx4 v[20:23], v184, s[8:11], s33 offen
  v_mfma_f32_16x16x32_bf16 a[104:107], v[56:59], v[40:43], a[104:107]
  v_mfma_f32_16x16x32_bf16 a[124:127], v[56:59], v[44:47], a[124:127]
  buffer_load_dwordx4 v[4:7], v181, s[4:7], s32 offen
  v_mfma_f32_16x16x32_bf16 a[144:147], v[56:59], v[48:51], a[144:147]
  v_mfma_f32_16x16x32_bf16 a[88:91], v[60:63], v[36:39], a[88:91]
  s_add_u32 s33, s32, 372736
  buffer_load_dwordx4 v[24:27], v184, s[8:11], s33 offen
  v_mfma_f32_16x16x32_bf16 a[108:111], v[60:63], v[40:43], a[108:111]
  v_mfma_f32_16x16x32_bf16 a[128:131], v[60:63], v[44:47], a[128:131]
  buffer_load_dwordx4 v[8:11], v182, s[4:7], s32 offen
  v_mfma_f32_16x16x32_bf16 a[148:151], v[60:63], v[48:51], a[148:151]
  v_mfma_f32_16x16x32_bf16 a[92:95], v[64:67], v[36:39], a[92:95]
  s_add_u32 s33, s32, 559104
  buffer_load_dwordx4 v[28:31], v184, s[8:11], s33 offen
  v_mfma_f32_16x16x32_bf16 a[112:115], v[64:67], v[40:43], a[112:115]
  v_mfma_f32_16x16x32_bf16 a[132:135], v[64:67], v[44:47], a[132:135]
  buffer_load_dwordx4 v[12:15], v183, s[4:7], s32 offen
  v_mfma_f32_16x16x32_bf16 a[152:155], v[64:67], v[48:51], a[152:155]
  v_mfma_f32_16x16x32_bf16 a[96:99], v[68:71], v[36:39], a[96:99]
  s_add_u32 s33, s32, 745472
  buffer_load_dwordx4 v[32:35], v184, s[8:11], s33 offen
  v_mfma_f32_16x16x32_bf16 a[116:119], v[68:71], v[40:43], a[116:119]
  v_mfma_f32_16x16x32_bf16 a[136:139], v[68:71], v[44:47], a[136:139]
  s_add_u32 s32, s32, 1024
  v_mfma_f32_16x16x32_bf16 a[156:159], v[68:71], v[48:51], a[156:159]
  s_waitcnt vmcnt(27)
  v_mfma_f32_16x16x32_bf16 a[80:83], v[88:91], v[72:75], a[80:83]
  buffer_load_dwordx4 v[52:55], v184, s[8:11], s32 offen
  v_mfma_f32_16x16x32_bf16 a[100:103], v[88:91], v[76:79], a[100:103]
  v_mfma_f32_16x16x32_bf16 a[120:123], v[88:91], v[80:83], a[120:123]
  buffer_load_dwordx4 v[36:39], v180, s[4:7], s32 offen
  v_mfma_f32_16x16x32_bf16 a[140:143], v[88:91], v[84:87], a[140:143]
  v_mfma_f32_16x16x32_bf16 a[84:87], v[92:95], v[72:75], a[84:87]
  s_add_u32 s33, s32, 186368
  buffer_load_dwordx4 v[56:59], v184, s[8:11], s33 offen
  v_mfma_f32_16x16x32_bf16 a[104:107], v[92:95], v[76:79], a[104:107]
  v_mfma_f32_16x16x32_bf16 a[124:127], v[92:95], v[80:83], a[124:127]
  buffer_load_dwordx4 v[40:43], v181, s[4:7], s32 offen
  v_mfma_f32_16x16x32_bf16 a[144:147], v[92:95], v[84:87], a[144:147]
  v_mfma_f32_16x16x32_bf16 a[88:91], v[96:99], v[72:75], a[88:91]
  s_add_u32 s33, s32, 372736
  buffer_load_dwordx4 v[60:63], v184, s[8:11], s33 offen
  v_mfma_f32_16x16x32_bf16 a[108:111], v[96:99], v[76:79], a[108:111]
  v_mfma_f32_16x16x32_bf16 a[128:131], v[96:99], v[80:83], a[128:131]
  buffer_load_dwordx4 v[44:47], v182, s[4:7], s32 offen
  v_mfma_f32_16x16x32_bf16 a[148:151], v[96:99], v[84:87], a[148:151]
  v_mfma_f32_16x16x32_bf16 a[92:95], v[100:103], v[72:75], a[92:95]
  s_add_u32 s33, s32, 559104
  buffer_load_dwordx4 v[64:67], v184, s[8:11], s33 offen
  v_mfma_f32_16x16x32_bf16 a[112:115], v[100:103], v[76:79], a[112:115]
  v_mfma_f32_16x16x32_bf16 a[132:135], v[100:103], v[80:83], a[132:135]
  buffer_load_dwordx4 v[48:51], v183, s[4:7], s32 offen
  v_mfma_f32_16x16x32_bf16 a[152:155], v[100:103], v[84:87], a[152:155]
  v_mfma_f32_16x16x32_bf16 a[96:99], v[104:107], v[72:75], a[96:99]
  s_add_u32 s33, s32, 745472
  buffer_load_dwordx4 v[68:71], v184, s[8:11], s33 offen
  v_mfma_f32_16x16x32_bf16 a[116:119], v[104:107], v[76:79], a[116:119]
  v_mfma_f32_16x16x32_bf16 a[136:139], v[104:107], v[80:83], a[136:139]
  s_add_u32 s32, s32, 1024
  v_mfma_f32_16x16x32_bf16 a[156:159], v[104:107], v[84:87], a[156:159]
  s_waitcnt vmcnt(27)
  v_mfma_f32_16x16x32_bf16 a[80:83], v[124:127], v[108:111], a[80:83]
  buffer_load_dwordx4 v[88:91], v184, s[8:11], s32 offen
  v_mfma_f32_16x16x32_bf16 a[100:103], v[124:127], v[112:115], a[100:103]
  v_mfma_f32_16x16x32_bf16 a[120:123], v[124:127], v[116:119], a[120:123]
  buffer_load_dwordx4 v[72:75], v180, s[4:7], s32 offen
  v_mfma_f32_16x16x32_bf16 a[140:143], v[124:127], v[120:123], a[140:143]
  v_mfma_f32_16x16x32_bf16 a[84:87], v[128:131], v[108:111], a[84:87]
  s_add_u32 s33, s32, 186368
  buffer_load_dwordx4 v[92:95], v184, s[8:11], s33 offen
  v_mfma_f32_16x16x32_bf16 a[104:107], v[128:131], v[112:115], a[104:107]
  v_mfma_f32_16x16x32_bf16 a[124:127], v[128:131], v[116:119], a[124:127]
  buffer_load_dwordx4 v[76:79], v181, s[4:7], s32 offen
  v_mfma_f32_16x16x32_bf16 a[144:147], v[128:131], v[120:123], a[144:147]
  v_mfma_f32_16x16x32_bf16 a[88:91], v[132:135], v[108:111], a[88:91]
  s_add_u32 s33, s32, 372736
  buffer_load_dwordx4 v[96:99], v184, s[8:11], s33 offen
  v_mfma_f32_16x16x32_bf16 a[108:111], v[132:135], v[112:115], a[108:111]
  v_mfma_f32_16x16x32_bf16 a[128:131], v[132:135], v[116:119], a[128:131]
  buffer_load_dwordx4 v[80:83], v182, s[4:7], s32 offen
  v_mfma_f32_16x16x32_bf16 a[148:151], v[132:135], v[120:123], a[148:151]
  v_mfma_f32_16x16x32_bf16 a[92:95], v[136:139], v[108:111], a[92:95]
  s_add_u32 s33, s32, 559104
  buffer_load_dwordx4 v[100:103], v184, s[8:11], s33 offen
  v_mfma_f32_16x16x32_bf16 a[112:115], v[136:139], v[112:115], a[112:115]
  v_mfma_f32_16x16x32_bf16 a[132:135], v[136:139], v[116:119], a[132:135]
  buffer_load_dwordx4 v[84:87], v183, s[4:7], s32 offen
  v_mfma_f32_16x16x32_bf16 a[152:155], v[136:139], v[120:123], a[152:155]
  v_mfma_f32_16x16x32_bf16 a[96:99], v[140:143], v[108:111], a[96:99]
  s_add_u32 s33, s32, 745472
  buffer_load_dwordx4 v[104:107], v184, s[8:11], s33 offen
  v_mfma_f32_16x16x32_bf16 a[116:119], v[140:143], v[112:115], a[116:119]
  v_mfma_f32_16x16x32_bf16 a[136:139], v[140:143], v[116:119], a[136:139]
  s_add_u32 s32, s32, 1024
  v_mfma_f32_16x16x32_bf16 a[156:159], v[140:143], v[120:123], a[156:159]
  s_waitcnt vmcnt(27)
  v_mfma_f32_16x16x32_bf16 a[0:3], v[160:163], v[144:147], 0
  buffer_load_dwordx4 v[124:127], v184, s[8:11], s32 offen
  v_mfma_f32_16x16x32_bf16 a[20:23], v[160:163], v[148:151], 0
  v_mfma_f32_16x16x32_bf16 a[40:43], v[160:163], v[152:155], 0
  buffer_load_dwordx4 v[108:111], v180, s[4:7], s32 offen
  v_mfma_f32_16x16x32_bf16 a[60:63], v[160:163], v[156:159], 0
  ds_write_b128 v186, a[100:103] offset:15360
  v_mfma_f32_16x16x32_bf16 a[4:7], v[164:167], v[144:147], 0
  s_add_u32 s33, s32, 186368
  buffer_load_dwordx4 v[128:131], v184, s[8:11], s33 offen
  v_mfma_f32_16x16x32_bf16 a[24:27], v[164:167], v[148:151], 0
  v_mfma_f32_16x16x32_bf16 a[44:47], v[164:167], v[152:155], 0
  buffer_load_dwordx4 v[112:115], v181, s[4:7], s32 offen
  ds_write_b128 v186, a[104:107] offset:16384
  v_mfma_f32_16x16x32_bf16 a[64:67], v[164:167], v[156:159], 0
  v_mfma_f32_16x16x32_bf16 a[8:11], v[168:171], v[144:147], 0
  s_add_u32 s33, s32, 372736
  buffer_load_dwordx4 v[132:135], v184, s[8:11], s33 offen
  v_mfma_f32_16x16x32_bf16 a[28:31], v[168:171], v[148:151], 0
  ds_write_b128 v186, a[108:111] offset:17408
  v_mfma_f32_16x16x32_bf16 a[48:51], v[168:171], v[152:155], 0
  buffer_load_dwordx4 v[116:119], v182, s[4:7], s32 offen
  v_mfma_f32_16x16x32_bf16 a[68:71], v[168:171], v[156:159], 0
  v_mfma_f32_16x16x32_bf16 a[12:15], v[172:175], v[144:147], 0
  s_add_u32 s33, s32, 559104
  buffer_load_dwordx4 v[136:139], v184, s[8:11], s33 offen
  ds_write_b128 v186, a[112:115] offset:18432
  v_mfma_f32_16x16x32_bf16 a[32:35], v[172:175], v[148:151], 0
  v_mfma_f32_16x16x32_bf16 a[52:55], v[172:175], v[152:155], 0
  buffer_load_dwordx4 v[120:123], v183, s[4:7], s32 offen
  v_mfma_f32_16x16x32_bf16 a[72:75], v[172:175], v[156:159], 0
  ds_write_b128 v186, a[116:119] offset:19456
  v_mfma_f32_16x16x32_bf16 a[16:19], v[176:179], v[144:147], 0
  s_add_u32 s33, s32, 745472
  buffer_load_dwordx4 v[140:143], v184, s[8:11], s33 offen
  v_mfma_f32_16x16x32_bf16 a[36:39], v[176:179], v[148:151], 0
  v_mfma_f32_16x16x32_bf16 a[56:59], v[176:179], v[152:155], 0
  s_add_u32 s32, s32, 1024
  v_mfma_f32_16x16x32_bf16 a[76:79], v[176:179], v[156:159], 0
  s_waitcnt vmcnt(27)
  v_mfma_f32_16x16x32_bf16 a[0:3], v[16:19], v[0:3], a[0:3]
  buffer_load_dwordx4 v[160:163], v184, s[8:11], s32 offen
  v_mfma_f32_16x16x32_bf16 a[20:23], v[16:19], v[4:7], a[20:23]
  v_mfma_f32_16x16x32_bf16 a[40:43], v[16:19], v[8:11], a[40:43]
  buffer_load_dwordx4 v[144:147], v180, s[4:7], s32 offen
  v_mfma_f32_16x16x32_bf16 a[60:63], v[16:19], v[12:15], a[60:63]
  ds_write_b128 v187, a[120:123] offset:15360
  v_mfma_f32_16x16x32_bf16 a[4:7], v[20:23], v[0:3], a[4:7]
  s_add_u32 s33, s32, 186368
  buffer_load_dwordx4 v[164:167], v184, s[8:11], s33 offen
  v_mfma_f32_16x16x32_bf16 a[24:27], v[20:23], v[4:7], a[24:27]
  v_mfma_f32_16x16x32_bf16 a[44:47], v[20:23], v[8:11], a[44:47]
  buffer_load_dwordx4 v[148:151], v181, s[4:7], s32 offen
  ds_write_b128 v187, a[124:127] offset:16384
  v_mfma_f32_16x16x32_bf16 a[64:67], v[20:23], v[12:15], a[64:67]
  v_mfma_f32_16x16x32_bf16 a[8:11], v[24:27], v[0:3], a[8:11]
  s_add_u32 s33, s32, 372736
  buffer_load_dwordx4 v[168:171], v184, s[8:11], s33 offen
  v_mfma_f32_16x16x32_bf16 a[28:31], v[24:27], v[4:7], a[28:31]
  ds_write_b128 v187, a[128:131] offset:17408
  v_mfma_f32_16x16x32_bf16 a[48:51], v[24:27], v[8:11], a[48:51]
  buffer_load_dwordx4 v[152:155], v182, s[4:7], s32 offen
  v_mfma_f32_16x16x32_bf16 a[68:71], v[24:27], v[12:15], a[68:71]
  v_mfma_f32_16x16x32_bf16 a[12:15], v[28:31], v[0:3], a[12:15]
  s_add_u32 s33, s32, 559104
  buffer_load_dwordx4 v[172:175], v184, s[8:11], s33 offen
  ds_write_b128 v187, a[132:135] offset:18432
  v_mfma_f32_16x16x32_bf16 a[32:35], v[28:31], v[4:7], a[32:35]
  v_mfma_f32_16x16x32_bf16 a[52:55], v[28:31], v[8:11], a[52:55]
  buffer_load_dwordx4 v[156:159], v183, s[4:7], s32 offen
  v_mfma_f32_16x16x32_bf16 a[72:75], v[28:31], v[12:15], a[72:75]
  ds_write_b128 v187, a[136:139] offset:19456
  v_mfma_f32_16x16x32_bf16 a[16:19], v[32:35], v[0:3], a[16:19]
  s_add_u32 s33, s32, 745472
  buffer_load_dwordx4 v[176:179], v184, s[8:11], s33 offen
  v_mfma_f32_16x16x32_bf16 a[36:39], v[32:35], v[4:7], a[36:39]
  v_mfma_f32_16x16x32_bf16 a[56:59], v[32:35], v[8:11], a[56:59]
  s_add_u32 s32, s32, 1024
  v_mfma_f32_16x16x32_bf16 a[76:79], v[32:35], v[12:15], a[76:79]
  s_waitcnt vmcnt(27)
  v_mfma_f32_16x16x32_bf16 a[0:3], v[52:55], v[36:39], a[0:3]
  buffer_load_dwordx4 v[16:19], v184, s[8:11], s32 offen
  v_mfma_f32_16x16x32_bf16 a[20:23], v[52:55], v[40:43], a[20:23]
  v_mfma_f32_16x16x32_bf16 a[40:43], v[52:55], v[44:47], a[40:43]
  buffer_load_dwordx4 v[0:3], v180, s[4:7], s32 offen
  v_mfma_f32_16x16x32_bf16 a[60:63], v[52:55], v[48:51], a[60:63]
  ds_write_b128 v188, a[140:143] offset:15360
  v_mfma_f32_16x16x32_bf16 a[4:7], v[56:59], v[36:39], a[4:7]
  s_add_u32 s33, s32, 186368
  buffer_load_dwordx4 v[20:23], v184, s[8:11], s33 offen
  v_mfma_f32_16x16x32_bf16 a[24:27], v[56:59], v[40:43], a[24:27]
  v_mfma_f32_16x16x32_bf16 a[44:47], v[56:59], v[44:47], a[44:47]
  buffer_load_dwordx4 v[4:7], v181, s[4:7], s32 offen
  ds_write_b128 v188, a[144:147] offset:16384
  v_mfma_f32_16x16x32_bf16 a[64:67], v[56:59], v[48:51], a[64:67]
  v_mfma_f32_16x16x32_bf16 a[8:11], v[60:63], v[36:39], a[8:11]
  s_add_u32 s33, s32, 372736
  buffer_load_dwordx4 v[24:27], v184, s[8:11], s33 offen
  v_mfma_f32_16x16x32_bf16 a[28:31], v[60:63], v[40:43], a[28:31]
  ds_write_b128 v188, a[148:151] offset:17408
  v_mfma_f32_16x16x32_bf16 a[48:51], v[60:63], v[44:47], a[48:51]
  buffer_load_dwordx4 v[8:11], v182, s[4:7], s32 offen
  v_mfma_f32_16x16x32_bf16 a[68:71], v[60:63], v[48:51], a[68:71]
  v_mfma_f32_16x16x32_bf16 a[12:15], v[64:67], v[36:39], a[12:15]
  s_add_u32 s33, s32, 559104
  buffer_load_dwordx4 v[28:31], v184, s[8:11], s33 offen
  ds_write_b128 v188, a[152:155] offset:18432
  v_mfma_f32_16x16x32_bf16 a[32:35], v[64:67], v[40:43], a[32:35]
  v_mfma_f32_16x16x32_bf16 a[52:55], v[64:67], v[44:47], a[52:55]
  buffer_load_dwordx4 v[12:15], v183, s[4:7], s32 offen
  v_mfma_f32_16x16x32_bf16 a[72:75], v[64:67], v[48:51], a[72:75]
  ds_write_b128 v188, a[156:159] offset:19456
  v_mfma_f32_16x16x32_bf16 a[16:19], v[68:71], v[36:39], a[16:19]
  s_add_u32 s33, s32, 745472
  buffer_load_dwordx4 v[32:35], v184, s[8:11], s33 offen
  v_mfma_f32_16x16x32_bf16 a[36:39], v[68:71], v[40:43], a[36:39]
  v_mfma_f32_16x16x32_bf16 a[56:59], v[68:71], v[44:47], a[56:59]
  s_add_u32 s32, s32, 1024
  v_mfma_f32_16x16x32_bf16 a[76:79], v[68:71], v[48:51], a[76:79]
  s_waitcnt vmcnt(27)
  v_mfma_f32_16x16x32_bf16 a[0:3], v[88:91], v[72:75], a[0:3]
  buffer_load_dwordx4 v[52:55], v184, s[8:11], s32 offen
  v_mfma_f32_16x16x32_bf16 a[20:23], v[88:91], v[76:79], a[20:23]
  v_mfma_f32_16x16x32_bf16 a[40:43], v[88:91], v[80:83], a[40:43]
  buffer_load_dwordx4 v[36:39], v180, s[4:7], s32 offen
  v_mfma_f32_16x16x32_bf16 a[60:63], v[88:91], v[84:87], a[60:63]
  v_accvgpr_read_b32 v200, a80
  v_accvgpr_read_b32 v201, a81
  v_accvgpr_read_b32 v202, a82
  v_accvgpr_read_b32 v203, a83
  v_accvgpr_read_b32 v204, a84
  v_mfma_f32_16x16x32_bf16 a[4:7], v[92:95], v[72:75], a[4:7]
  s_add_u32 s33, s32, 186368
  buffer_load_dwordx4 v[56:59], v184, s[8:11], s33 offen
  v_mfma_f32_16x16x32_bf16 a[24:27], v[92:95], v[76:79], a[24:27]
  v_mfma_f32_16x16x32_bf16 a[44:47], v[92:95], v[80:83], a[44:47]
  buffer_load_dwordx4 v[40:43], v181, s[4:7], s32 offen
  v_accvgpr_read_b32 v205, a85
  v_accvgpr_read_b32 v206, a86
  v_accvgpr_read_b32 v207, a87
  v_accvgpr_read_b32 v208, a88
  v_accvgpr_read_b32 v209, a89
  v_mfma_f32_16x16x32_bf16 a[64:67], v[92:95], v[84:87], a[64:67]
  v_mfma_f32_16x16x32_bf16 a[8:11], v[96:99], v[72:75], a[8:11]
  s_add_u32 s33, s32, 372736
  buffer_load_dwordx4 v[60:63], v184, s[8:11], s33 offen
  v_mfma_f32_16x16x32_bf16 a[28:31], v[96:99], v[76:79], a[28:31]
  v_accvgpr_read_b32 v210, a90
  v_accvgpr_read_b32 v211, a91
  v_accvgpr_read_b32 v212, a92
  v_accvgpr_read_b32 v213, a93
  v_accvgpr_read_b32 v214, a94
  v_mfma_f32_16x16x32_bf16 a[48:51], v[96:99], v[80:83], a[48:51]
  buffer_load_dwordx4 v[44:47], v182, s[4:7], s32 offen
  v_mfma_f32_16x16x32_bf16 a[68:71], v[96:99], v[84:87], a[68:71]
  v_mfma_f32_16x16x32_bf16 a[12:15], v[100:103], v[72:75], a[12:15]
  s_add_u32 s33, s32, 559104
  buffer_load_dwordx4 v[64:67], v184, s[8:11], s33 offen
  v_accvgpr_read_b32 v215, a95
  v_accvgpr_read_b32 v216, a96
  v_accvgpr_read_b32 v217, a97
  v_accvgpr_read_b32 v218, a98
  v_accvgpr_read_b32 v219, a99
  v_mfma_f32_16x16x32_bf16 a[32:35], v[100:103], v[76:79], a[32:35]
  v_mfma_f32_16x16x32_bf16 a[52:55], v[100:103], v[80:83], a[52:55]
  buffer_load_dwordx4 v[48:51], v183, s[4:7], s32 offen
  v_mfma_f32_16x16x32_bf16 a[72:75], v[100:103], v[84:87], a[72:75]
  v_mfma_f32_16x16x32_bf16 a[16:19], v[104:107], v[72:75], a[16:19]
  s_add_u32 s33, s32, 745472
  buffer_load_dwordx4 v[68:71], v184, s[8:11], s33 offen
  v_mfma_f32_16x16x32_bf16 a[36:39], v[104:107], v[76:79], a[36:39]
  v_mfma_f32_16x16x32_bf16 a[56:59], v[104:107], v[80:83], a[56:59]
  s_add_u32 s32, s32, 1024
  v_mfma_f32_16x16x32_bf16 a[76:79], v[104:107], v[84:87], a[76:79]
  s_waitcnt vmcnt(27)
  v_mfma_f32_16x16x32_bf16 a[0:3], v[124:127], v[108:111], a[0:3]
  buffer_load_dwordx4 v[88:91], v184, s[8:11], s32 offen
  v_mfma_f32_16x16x32_bf16 a[20:23], v[124:127], v[112:115], a[20:23]
  v_mfma_f32_16x16x32_bf16 a[40:43], v[124:127], v[116:119], a[40:43]
  buffer_load_dwordx4 v[72:75], v180, s[4:7], s32 offen
  v_mfma_f32_16x16x32_bf16 a[60:63], v[124:127], v[120:123], a[60:63]
  s_waitcnt lgkmcnt(0)
  s_barrier
  v_mfma_f32_16x16x32_bf16 a[4:7], v[128:131], v[108:111], a[4:7]
  s_add_u32 s33, s32, 186368
  buffer_load_dwordx4 v[92:95], v184, s[8:11], s33 offen
  v_mfma_f32_16x16x32_bf16 a[24:27], v[128:131], v[112:115], a[24:27]
  v_mfma_f32_16x16x32_bf16 a[44:47], v[128:131], v[116:119], a[44:47]
  buffer_load_dwordx4 v[76:79], v181, s[4:7], s32 offen
  v_mfma_f32_16x16x32_bf16 a[64:67], v[128:131], v[120:123], a[64:67]
  v_mfma_f32_16x16x32_bf16 a[8:11], v[132:135], v[108:111], a[8:11]
  s_add_u32 s33, s32, 372736
  buffer_load_dwordx4 v[96:99], v184, s[8:11], s33 offen
  v_mfma_f32_16x16x32_bf16 a[28:31], v[132:135], v[112:115], a[28:31]
  v_mfma_f32_16x16x32_bf16 a[48:51], v[132:135], v[116:119], a[48:51]
  buffer_load_dwordx4 v[80:83], v182, s[4:7], s32 offen
  v_mfma_f32_16x16x32_bf16 a[68:71], v[132:135], v[120:123], a[68:71]
  v_mfma_f32_16x16x32_bf16 a[12:15], v[136:139], v[108:111], a[12:15]
  s_add_u32 s33, s32, 559104
  buffer_load_dwordx4 v[100:103], v184, s[8:11], s33 offen
  v_mfma_f32_16x16x32_bf16 a[32:35], v[136:139], v[112:115], a[32:35]
  v_mfma_f32_16x16x32_bf16 a[52:55], v[136:139], v[116:119], a[52:55]
  buffer_load_dwordx4 v[84:87], v183, s[4:7], s32 offen
  v_mfma_f32_16x16x32_bf16 a[72:75], v[136:139], v[120:123], a[72:75]
  v_mfma_f32_16x16x32_bf16 a[16:19], v[140:143], v[108:111], a[16:19]
  s_add_u32 s33, s32, 745472
  buffer_load_dwordx4 v[104:107], v184, s[8:11], s33 offen
  v_mfma_f32_16x16x32_bf16 a[36:39], v[140:143], v[112:115], a[36:39]
  v_mfma_f32_16x16x32_bf16 a[56:59], v[140:143], v[116:119], a[56:59]
  s_add_u32 s32, s32, 1024
  v_mfma_f32_16x16x32_bf16 a[76:79], v[140:143], v[120:123], a[76:79]
  s_waitcnt vmcnt(27)
  v_mfma_f32_16x16x32_bf16 a[0:3], v[160:163], v[144:147], a[0:3]
  buffer_load_dwordx4 v[124:127], v184, s[8:11], s32 offen
  v_mfma_f32_16x16x32_bf16 a[20:23], v[160:163], v[148:151], a[20:23]
  v_mfma_f32_16x16x32_bf16 a[40:43], v[160:163], v[152:155], a[40:43]
  buffer_load_dwordx4 v[108:111], v180, s[4:7], s32 offen
  v_mfma_f32_16x16x32_bf16 a[60:63], v[160:163], v[156:159], a[60:63]
  ds_read_b128 v[220:223], v189 offset:15360
  v_mfma_f32_16x16x32_bf16 a[4:7], v[164:167], v[144:147], a[4:7]
  s_add_u32 s33, s32, 186368
  buffer_load_dwordx4 v[128:131], v184, s[8:11], s33 offen
  v_mfma_f32_16x16x32_bf16 a[24:27], v[164:167], v[148:151], a[24:27]
  v_mfma_f32_16x16x32_bf16 a[44:47], v[164:167], v[152:155], a[44:47]
  buffer_load_dwordx4 v[112:115], v181, s[4:7], s32 offen
  ds_read_b128 v[224:227], v189 offset:16384
  v_mfma_f32_16x16x32_bf16 a[64:67], v[164:167], v[156:159], a[64:67]
  v_mfma_f32_16x16x32_bf16 a[8:11], v[168:171], v[144:147], a[8:11]
  s_add_u32 s33, s32, 372736
  buffer_load_dwordx4 v[132:135], v184, s[8:11], s33 offen
  v_mfma_f32_16x16x32_bf16 a[28:31], v[168:171], v[148:151], a[28:31]
  ds_read_b128 v[228:231], v189 offset:17408
  v_mfma_f32_16x16x32_bf16 a[48:51], v[168:171], v[152:155], a[48:51]
  buffer_load_dwordx4 v[116:119], v182, s[4:7], s32 offen
  v_mfma_f32_16x16x32_bf16 a[68:71], v[168:171], v[156:159], a[68:71]
  v_mfma_f32_16x16x32_bf16 a[12:15], v[172:175], v[144:147], a[12:15]
  s_add_u32 s33, s32, 559104
  buffer_load_dwordx4 v[136:139], v184, s[8:11], s33 offen
  ds_read_b128 v[232:235], v189 offset:18432
  v_mfma_f32_16x16x32_bf16 a[32:35], v[172:175], v[148:151], a[32:35]
  v_mfma_f32_16x16x32_bf16 a[52:55], v[172:175], v[152:155], a[52:55]
  buffer_load_dwordx4 v[120:123], v183, s[4:7], s32 offen
  v_mfma_f32_16x16x32_bf16 a[72:75], v[172:175], v[156:159], a[72:75]
  ds_read_b128 v[236:239], v189 offset:19456
  v_mfma_f32_16x16x32_bf16 a[16:19], v[176:179], v[144:147], a[16:19]
  s_add_u32 s33, s32, 745472
  buffer_load_dwordx4 v[140:143], v184, s[8:11], s33 offen
  v_mfma_f32_16x16x32_bf16 a[36:39], v[176:179], v[148:151], a[36:39]
  v_mfma_f32_16x16x32_bf16 a[56:59], v[176:179], v[152:155], a[56:59]
  s_add_u32 s32, s32, 1024
  v_mfma_f32_16x16x32_bf16 a[76:79], v[176:179], v[156:159], a[76:79]
  s_waitcnt vmcnt(27)
  v_mfma_f32_16x16x32_bf16 a[0:3], v[16:19], v[0:3], a[0:3]
  buffer_load_dwordx4 v[160:163], v184, s[8:11], s32 offen
  v_mfma_f32_16x16x32_bf16 a[20:23], v[16:19], v[4:7], a[20:23]
  v_mfma_f32_16x16x32_bf16 a[40:43], v[16:19], v[8:11], a[40:43]
  buffer_load_dwordx4 v[144:147], v180, s[4:7], s32 offen
  v_mfma_f32_16x16x32_bf16 a[60:63], v[16:19], v[12:15], a[60:63]
  s_waitcnt lgkmcnt(4)
  v_add_f32 v200, v200, v220
  v_add_f32 v201, v201, v221
  v_add_f32 v202, v202, v222
  v_add_f32 v203, v203, v223
  v_mfma_f32_16x16x32_bf16 a[4:7], v[20:23], v[0:3], a[4:7]
  s_add_u32 s33, s32, 186368
  buffer_load_dwordx4 v[164:167], v184, s[8:11], s33 offen
  v_mfma_f32_16x16x32_bf16 a[24:27], v[20:23], v[4:7], a[24:27]
  v_mfma_f32_16x16x32_bf16 a[44:47], v[20:23], v[8:11], a[44:47]
  buffer_load_dwordx4 v[148:151], v181, s[4:7], s32 offen
  s_waitcnt lgkmcnt(3)
  v_add_f32 v204, v204, v224
  v_add_f32 v205, v205, v225
  v_add_f32 v206, v206, v226
  v_add_f32 v207, v207, v227
  v_mfma_f32_16x16x32_bf16 a[64:67], v[20:23], v[12:15], a[64:67]
  v_mfma_f32_16x16x32_bf16 a[8:11], v[24:27], v[0:3], a[8:11]
  s_add_u32 s33, s32, 372736
  buffer_load_dwordx4 v[168:171], v184, s[8:11], s33 offen
  v_mfma_f32_16x16x32_bf16 a[28:31], v[24:27], v[4:7], a[28:31]
  s_waitcnt lgkmcnt(2)
  v_add_f32 v208, v208, v228
  v_add_f32 v209, v209, v229
  v_add_f32 v210, v210, v230
  v_add_f32 v211, v211, v231
  v_mfma_f32_16x16x32_bf16 a[48:51], v[24:27], v[8:11], a[48:51]
  buffer_load_dwordx4 v[152:155], v182, s[4:7], s32 offen
  v_mfma_f32_16x16x32_bf16 a[68:71], v[24:27], v[12:15], a[68:71]
  v_mfma_f32_16x16x32_bf16 a[12:15], v[28:31], v[0:3], a[12:15]
  s_add_u32 s33, s32, 559104
  buffer_load_dwordx4 v[172:175], v184, s[8:11], s33 offen
  s_waitcnt lgkmcnt(1)
  v_add_f32 v212, v212, v232
  v_add_f32 v213, v213, v233
  v_add_f32 v214, v214, v234
  v_add_f32 v215, v215, v235
  v_mfma_f32_16x16x32_bf16 a[32:35], v[28:31], v[4:7], a[32:35]
  v_mfma_f32_16x16x32_bf16 a[52:55], v[28:31], v[8:11], a[52:55]
  buffer_load_dwordx4 v[156:159], v183, s[4:7], s32 offen
  v_mfma_f32_16x16x32_bf16 a[72:75], v[28:31], v[12:15], a[72:75]
  s_waitcnt lgkmcnt(0)
  v_add_f32 v216, v216, v236
  v_add_f32 v217, v217, v237
  v_add_f32 v218, v218, v238
  v_add_f32 v219, v219, v239
  v_mfma_f32_16x16x32_bf16 a[16:19], v[32:35], v[0:3], a[16:19]
  s_add_u32 s33, s32, 745472
  buffer_load_dwordx4 v[176:179], v184, s[8:11], s33 offen
  v_mfma_f32_16x16x32_bf16 a[36:39], v[32:35], v[4:7], a[36:39]
  v_mfma_f32_16x16x32_bf16 a[56:59], v[32:35], v[8:11], a[56:59]
  s_add_u32 s32, s32, 1024
  v_mfma_f32_16x16x32_bf16 a[76:79], v[32:35], v[12:15], a[76:79]
  s_waitcnt vmcnt(27)
  v_mfma_f32_16x16x32_bf16 a[0:3], v[52:55], v[36:39], a[0:3]
  buffer_load_dwordx4 v[16:19], v184, s[8:11], s32 offen
  v_mfma_f32_16x16x32_bf16 a[20:23], v[52:55], v[40:43], a[20:23]
  v_mfma_f32_16x16x32_bf16 a[40:43], v[52:55], v[44:47], a[40:43]
  buffer_load_dwordx4 v[0:3], v180, s[4:7], s32 offen
  v_mfma_f32_16x16x32_bf16 a[60:63], v[52:55], v[48:51], a[60:63]
  ds_read_b128 v[220:223], v189 offset:20480
  v_mfma_f32_16x16x32_bf16 a[4:7], v[56:59], v[36:39], a[4:7]
  s_add_u32 s33, s32, 186368
  buffer_load_dwordx4 v[20:23], v184, s[8:11], s33 offen
  v_mfma_f32_16x16x32_bf16 a[24:27], v[56:59], v[40:43], a[24:27]
  v_mfma_f32_16x16x32_bf16 a[44:47], v[56:59], v[44:47], a[44:47]
  buffer_load_dwordx4 v[4:7], v181, s[4:7], s32 offen
  ds_read_b128 v[224:227], v189 offset:21504
  v_mfma_f32_16x16x32_bf16 a[64:67], v[56:59], v[48:51], a[64:67]
  v_mfma_f32_16x16x32_bf16 a[8:11], v[60:63], v[36:39], a[8:11]
  s_add_u32 s33, s32, 372736
  buffer_load_dwordx4 v[24:27], v184, s[8:11], s33 offen
  v_mfma_f32_16x16x32_bf16 a[28:31], v[60:63], v[40:43], a[28:31]
  ds_read_b128 v[228:231], v189 offset:22528
  v_mfma_f32_16x16x32_bf16 a[48:51], v[60:63], v[44:47], a[48:51]
  buffer_load_dwordx4 v[8:11], v182, s[4:7], s32 offen
  v_mfma_f32_16x16x32_bf16 a[68:71], v[60:63], v[48:51], a[68:71]
  v_mfma_f32_16x16x32_bf16 a[12:15], v[64:67], v[36:39], a[12:15]
  s_add_u32 s33, s32, 559104
  buffer_load_dwordx4 v[28:31], v184, s[8:11], s33 offen
  ds_read_b128 v[232:235], v189 offset:23552
  v_mfma_f32_16x16x32_bf16 a[32:35], v[64:67], v[40:43], a[32:35]
  v_mfma_f32_16x16x32_bf16 a[52:55], v[64:67], v[44:47], a[52:55]
  buffer_load_dwordx4 v[12:15], v183, s[4:7], s32 offen
  v_mfma_f32_16x16x32_bf16 a[72:75], v[64:67], v[48:51], a[72:75]
  ds_read_b128 v[236:239], v189 offset:24576
  v_mfma_f32_16x16x32_bf16 a[16:19], v[68:71], v[36:39], a[16:19]
  s_add_u32 s33, s32, 745472
  buffer_load_dwordx4 v[32:35], v184, s[8:11], s33 offen
  v_mfma_f32_16x16x32_bf16 a[36:39], v[68:71], v[40:43], a[36:39]
  v_mfma_f32_16x16x32_bf16 a[56:59], v[68:71], v[44:47], a[56:59]
  s_add_u32 s32, s32, 1024
  v_mfma_f32_16x16x32_bf16 a[76:79], v[68:71], v[48:51], a[76:79]
  s_waitcnt vmcnt(27)
  v_mfma_f32_16x16x32_bf16 a[0:3], v[88:91], v[72:75], a[0:3]
  buffer_load_dwordx4 v[52:55], v184, s[8:11], s32 offen
  v_mfma_f32_16x16x32_bf16 a[20:23], v[88:91], v[76:79], a[20:23]
  v_mfma_f32_16x16x32_bf16 a[40:43], v[88:91], v[80:83], a[40:43]
  buffer_load_dwordx4 v[36:39], v180, s[4:7], s32 offen
  v_mfma_f32_16x16x32_bf16 a[60:63], v[88:91], v[84:87], a[60:63]
  s_waitcnt lgkmcnt(4)
  v_add_f32 v200, v200, v220
  v_add_f32 v201, v201, v221
  v_add_f32 v202, v202, v222
  v_add_f32 v203, v203, v223
  v_mfma_f32_16x16x32_bf16 a[4:7], v[92:95], v[72:75], a[4:7]
  s_add_u32 s33, s32, 186368
  buffer_load_dwordx4 v[56:59], v184, s[8:11], s33 offen
  v_mfma_f32_16x16x32_bf16 a[24:27], v[92:95], v[76:79], a[24:27]
  v_mfma_f32_16x16x32_bf16 a[44:47], v[92:95], v[80:83], a[44:47]
  buffer_load_dwordx4 v[40:43], v181, s[4:7], s32 offen
  s_waitcnt lgkmcnt(3)
  v_add_f32 v204, v204, v224
  v_add_f32 v205, v205, v225
  v_add_f32 v206, v206, v226
  v_add_f32 v207, v207, v227
  v_mfma_f32_16x16x32_bf16 a[64:67], v[92:95], v[84:87], a[64:67]
  v_mfma_f32_16x16x32_bf16 a[8:11], v[96:99], v[72:75], a[8:11]
  s_add_u32 s33, s32, 372736
  buffer_load_dwordx4 v[60:63], v184, s[8:11], s33 offen
  v_mfma_f32_16x16x32_bf16 a[28:31], v[96:99], v[76:79], a[28:31]
  s_waitcnt lgkmcnt(2)
  v_add_f32 v208, v208, v228
  v_add_f32 v209, v209, v229
  v_add_f32 v210, v210, v230
  v_add_f32 v211, v211, v231
  v_mfma_f32_16x16x32_bf16 a[48:51], v[96:99], v[80:83], a[48:51]
  buffer_load_dwordx4 v[44:47], v182, s[4:7], s32 offen
  v_mfma_f32_16x16x32_bf16 a[68:71], v[96:99], v[84:87], a[68:71]
  v_mfma_f32_16x16x32_bf16 a[12:15], v[100:103], v[72:75], a[12:15]
  s_add_u32 s33, s32, 559104
  buffer_load_dwordx4 v[64:67], v184, s[8:11], s33 offen
  s_waitcnt lgkmcnt(1)
  v_add_f32 v212, v212, v232
  v_add_f32 v213, v213, v233
  v_add_f32 v214, v214, v234
  v_add_f32 v215, v215, v235
  v_mfma_f32_16x16x32_bf16 a[32:35], v[100:103], v[76:79], a[32:35]
  v_mfma_f32_16x16x32_bf16 a[52:55], v[100:103], v[80:83], a[52:55]
  buffer_load_dwordx4 v[48:51], v183, s[4:7], s32 offen
  v_mfma_f32_16x16x32_bf16 a[72:75], v[100:103], v[84:87], a[72:75]
  s_waitcnt lgkmcnt(0)
  v_add_f32 v216, v216, v236
  v_add_f32 v217, v217, v237
  v_add_f32 v218, v218, v238
  v_add_f32 v219, v219, v239
  v_mfma_f32_16x16x32_bf16 a[16:19], v[104:107], v[72:75], a[16:19]
  s_add_u32 s33, s32, 745472
  buffer_load_dwordx4 v[68:71], v184, s[8:11], s33 offen
  v_mfma_f32_16x16x32_bf16 a[36:39], v[104:107], v[76:79], a[36:39]
  v_mfma_f32_16x16x32_bf16 a[56:59], v[104:107], v[80:83], a[56:59]
  s_add_u32 s32, s32, 1024
  v_mfma_f32_16x16x32_bf16 a[76:79], v[104:107], v[84:87], a[76:79]
  s_waitcnt vmcnt(27)
  v_mfma_f32_16x16x32_bf16 a[0:3], v[124:127], v[108:111], a[0:3]
  buffer_load_dwordx4 v[88:91], v184, s[8:11], s32 offen
  v_mfma_f32_16x16x32_bf16 a[20:23], v[124:127], v[112:115], a[20:23]
  v_mfma_f32_16x16x32_bf16 a[40:43], v[124:127], v[116:119], a[40:43]
  buffer_load_dwordx4 v[72:75], v180, s[4:7], s32 offen
  v_mfma_f32_16x16x32_bf16 a[60:63], v[124:127], v[120:123], a[60:63]
  ds_read_b128 v[220:223], v189 offset:25600
  v_mfma_f32_16x16x32_bf16 a[4:7], v[128:131], v[108:111], a[4:7]
  s_add_u32 s33, s32, 186368
  buffer_load_dwordx4 v[92:95], v184, s[8:11], s33 offen
  v_mfma_f32_16x16x32_bf16 a[24:27], v[128:131], v[112:115], a[24:27]
  v_mfma_f32_16x16x32_bf16 a[44:47], v[128:131], v[116:119], a[44:47]
  buffer_load_dwordx4 v[76:79], v181, s[4:7], s32 offen
  ds_read_b128 v[224:227], v189 offset:26624
  v_mfma_f32_16x16x32_bf16 a[64:67], v[128:131], v[120:123], a[64:67]
  v_mfma_f32_16x16x32_bf16 a[8:11], v[132:135], v[108:111], a[8:11]
  s_add_u32 s33, s32, 372736
  buffer_load_dwordx4 v[96:99], v184, s[8:11], s33 offen
  v_mfma_f32_16x16x32_bf16 a[28:31], v[132:135], v[112:115], a[28:31]
  ds_read_b128 v[228:231], v189 offset:27648
  v_mfma_f32_16x16x32_bf16 a[48:51], v[132:135], v[116:119], a[48:51]
  buffer_load_dwordx4 v[80:83], v182, s[4:7], s32 offen
  v_mfma_f32_16x16x32_bf16 a[68:71], v[132:135], v[120:123], a[68:71]
  v_mfma_f32_16x16x32_bf16 a[12:15], v[136:139], v[108:111], a[12:15]
  s_add_u32 s33, s32, 559104
  buffer_load_dwordx4 v[100:103], v184, s[8:11], s33 offen
  ds_read_b128 v[232:235], v189 offset:28672
  v_mfma_f32_16x16x32_bf16 a[32:35], v[136:139], v[112:115], a[32:35]
  v_mfma_f32_16x16x32_bf16 a[52:55], v[136:139], v[116:119], a[52:55]
  buffer_load_dwordx4 v[84:87], v183, s[4:7], s32 offen
  v_mfma_f32_16x16x32_bf16 a[72:75], v[136:139], v[120:123], a[72:75]
  ds_read_b128 v[236:239], v189 offset:29696
  v_mfma_f32_16x16x32_bf16 a[16:19], v[140:143], v[108:111], a[16:19]
  s_add_u32 s33, s32, 745472
  buffer_load_dwordx4 v[104:107], v184, s[8:11], s33 offen
  v_mfma_f32_16x16x32_bf16 a[36:39], v[140:143], v[112:115], a[36:39]
  v_mfma_f32_16x16x32_bf16 a[56:59], v[140:143], v[116:119], a[56:59]
  s_add_u32 s32, s32, 1024
  v_mfma_f32_16x16x32_bf16 a[76:79], v[140:143], v[120:123], a[76:79]
  s_waitcnt vmcnt(27)
  v_mfma_f32_16x16x32_bf16 a[0:3], v[160:163], v[144:147], a[0:3]
  buffer_load_dwordx4 v[124:127], v184, s[8:11], s32 offen
  v_mfma_f32_16x16x32_bf16 a[20:23], v[160:163], v[148:151], a[20:23]
  v_mfma_f32_16x16x32_bf16 a[40:43], v[160:163], v[152:155], a[40:43]
  buffer_load_dwordx4 v[108:111], v180, s[4:7], s32 offen
  v_mfma_f32_16x16x32_bf16 a[60:63], v[160:163], v[156:159], a[60:63]
  s_waitcnt lgkmcnt(4)
  v_add_f32 v200, v200, v220
  v_add_f32 v201, v201, v221
  v_add_f32 v202, v202, v222
  v_add_f32 v203, v203, v223
  v_mfma_f32_16x16x32_bf16 a[4:7], v[164:167], v[144:147], a[4:7]
  s_add_u32 s33, s32, 186368
  buffer_load_dwordx4 v[128:131], v184, s[8:11], s33 offen
  v_mfma_f32_16x16x32_bf16 a[24:27], v[164:167], v[148:151], a[24:27]
  v_mfma_f32_16x16x32_bf16 a[44:47], v[164:167], v[152:155], a[44:47]
  buffer_load_dwordx4 v[112:115], v181, s[4:7], s32 offen
  s_waitcnt lgkmcnt(3)
  v_add_f32 v204, v204, v224
  v_add_f32 v205, v205, v225
  v_add_f32 v206, v206, v226
  v_add_f32 v207, v207, v227
  v_mfma_f32_16x16x32_bf16 a[64:67], v[164:167], v[156:159], a[64:67]
  v_mfma_f32_16x16x32_bf16 a[8:11], v[168:171], v[144:147], a[8:11]
  s_add_u32 s33, s32, 372736
  buffer_load_dwordx4 v[132:135], v184, s[8:11], s33 offen
  v_mfma_f32_16x16x32_bf16 a[28:31], v[168:171], v[148:151], a[28:31]
  s_waitcnt lgkmcnt(2)
  v_add_f32 v208, v208, v228
  v_add_f32 v209, v209, v229
  v_add_f32 v210, v210, v230
  v_add_f32 v211, v211, v231
  v_mfma_f32_16x16x32_bf16 a[48:51], v[168:171], v[152:155], a[48:51]
  buffer_load_dwordx4 v[116:119], v182, s[4:7], s32 offen
  v_mfma_f32_16x16x32_bf16 a[68:71], v[168:171], v[156:159], a[68:71]
  v_mfma_f32_16x16x32_bf16 a[12:15], v[172:175], v[144:147], a[12:15]
  s_add_u32 s33, s32, 559104
  buffer_load_dwordx4 v[136:139], v184, s[8:11], s33 offen
  s_waitcnt lgkmcnt(1)
  v_add_f32 v212, v212, v232
  v_add_f32 v213, v213, v233
  v_add_f32 v214, v214, v234
  v_add_f32 v215, v215, v235
  v_mfma_f32_16x16x32_bf16 a[32:35], v[172:175], v[148:151], a[32:35]
  v_mfma_f32_16x16x32_bf16 a[52:55], v[172:175], v[152:155], a[52:55]
  buffer_load_dwordx4 v[120:123], v183, s[4:7], s32 offen
  v_mfma_f32_16x16x32_bf16 a[72:75], v[172:175], v[156:159], a[72:75]
  s_waitcnt lgkmcnt(0)
  v_add_f32 v216, v216, v236
  v_add_f32 v217, v217, v237
  v_add_f32 v218, v218, v238
  v_add_f32 v219, v219, v239
  v_mfma_f32_16x16x32_bf16 a[16:19], v[176:179], v[144:147], a[16:19]
  s_add_u32 s33, s32, 745472
  buffer_load_dwordx4 v[140:143], v184, s[8:11], s33 offen
  v_mfma_f32_16x16x32_bf16 a[36:39], v[176:179], v[148:151], a[36:39]
  v_mfma_f32_16x16x32_bf16 a[56:59], v[176:179], v[152:155], a[56:59]
  s_add_u32 s32, s32, 1024
  v_mfma_f32_16x16x32_bf16 a[76:79], v[176:179], v[156:159], a[76:79]
  s_waitcnt vmcnt(27)
  v_mfma_f32_16x16x32_bf16 a[0:3], v[16:19], v[0:3], a[0:3]
  buffer_load_dwordx4 v[160:163], v184, s[8:11], s32 offen
  v_mfma_f32_16x16x32_bf16 a[20:23], v[16:19], v[4:7], a[20:23]
  v_mfma_f32_16x16x32_bf16 a[40:43], v[16:19], v[8:11], a[40:43]
  buffer_load_dwordx4 v[144:147], v180, s[4:7], s32 offen
  v_mfma_f32_16x16x32_bf16 a[60:63], v[16:19], v[12:15], a[60:63]
  v_mfma_f32_16x16x32_bf16 a[4:7], v[20:23], v[0:3], a[4:7]
  s_add_u32 s33, s32, 186368
  buffer_load_dwordx4 v[164:167], v184, s[8:11], s33 offen
  v_mfma_f32_16x16x32_bf16 a[24:27], v[20:23], v[4:7], a[24:27]
  v_mfma_f32_16x16x32_bf16 a[44:47], v[20:23], v[8:11], a[44:47]
  buffer_load_dwordx4 v[148:151], v181, s[4:7], s32 offen
  v_mfma_f32_16x16x32_bf16 a[64:67], v[20:23], v[12:15], a[64:67]
  v_mfma_f32_16x16x32_bf16 a[8:11], v[24:27], v[0:3], a[8:11]
  s_add_u32 s33, s32, 372736
  buffer_load_dwordx4 v[168:171], v184, s[8:11], s33 offen
  v_mfma_f32_16x16x32_bf16 a[28:31], v[24:27], v[4:7], a[28:31]
  v_mfma_f32_16x16x32_bf16 a[48:51], v[24:27], v[8:11], a[48:51]
  buffer_load_dwordx4 v[152:155], v182, s[4:7], s32 offen
  v_mfma_f32_16x16x32_bf16 a[68:71], v[24:27], v[12:15], a[68:71]
  v_mfma_f32_16x16x32_bf16 a[12:15], v[28:31], v[0:3], a[12:15]
  s_add_u32 s33, s32, 559104
  buffer_load_dwordx4 v[172:175], v184, s[8:11], s33 offen
  v_mfma_f32_16x16x32_bf16 a[32:35], v[28:31], v[4:7], a[32:35]
  v_mfma_f32_16x16x32_bf16 a[52:55], v[28:31], v[8:11], a[52:55]
  buffer_load_dwordx4 v[156:159], v183, s[4:7], s32 offen
  v_mfma_f32_16x16x32_bf16 a[72:75], v[28:31], v[12:15], a[72:75]
  v_mfma_f32_16x16x32_bf16 a[16:19], v[32:35], v[0:3], a[16:19]
  s_add_u32 s33, s32, 745472
  buffer_load_dwordx4 v[176:179], v184, s[8:11], s33 offen
  v_mfma_f32_16x16x32_bf16 a[36:39], v[32:35], v[4:7], a[36:39]
  v_mfma_f32_16x16x32_bf16 a[56:59], v[32:35], v[8:11], a[56:59]
  s_add_u32 s32, s32, 1024
  v_mfma_f32_16x16x32_bf16 a[76:79], v[32:35], v[12:15], a[76:79]
  s_waitcnt vmcnt(27)
  v_mfma_f32_16x16x32_bf16 a[0:3], v[52:55], v[36:39], a[0:3]
  buffer_load_dwordx4 v[16:19], v184, s[8:11], s32 offen
  v_mfma_f32_16x16x32_bf16 a[20:23], v[52:55], v[40:43], a[20:23]
  v_mfma_f32_16x16x32_bf16 a[40:43], v[52:55], v[44:47], a[40:43]
  buffer_load_dwordx4 v[0:3], v180, s[4:7], s32 offen
  v_mfma_f32_16x16x32_bf16 a[60:63], v[52:55], v[48:51], a[60:63]
  v_mul_f32 v220, 0xbfb8aa3b, v200
  v_mul_f32 v221, 0xbfb8aa3b, v201
  v_mul_f32 v222, 0xbfb8aa3b, v202
  v_mul_f32 v223, 0xbfb8aa3b, v203
  v_mfma_f32_16x16x32_bf16 a[4:7], v[56:59], v[36:39], a[4:7]
  s_add_u32 s33, s32, 186368
  buffer_load_dwordx4 v[20:23], v184, s[8:11], s33 offen
  v_mfma_f32_16x16x32_bf16 a[24:27], v[56:59], v[40:43], a[24:27]
  v_mfma_f32_16x16x32_bf16 a[44:47], v[56:59], v[44:47], a[44:47]
  buffer_load_dwordx4 v[4:7], v181, s[4:7], s32 offen
  v_exp_f32 v220, v220
  v_exp_f32 v221, v221
  v_exp_f32 v222, v222
  v_exp_f32 v223, v223
  v_mfma_f32_16x16x32_bf16 a[64:67], v[56:59], v[48:51], a[64:67]
  v_mfma_f32_16x16x32_bf16 a[8:11], v[60:63], v[36:39], a[8:11]
  s_add_u32 s33, s32, 372736
  buffer_load_dwordx4 v[24:27], v184, s[8:11], s33 offen
  v_mfma_f32_16x16x32_bf16 a[28:31], v[60:63], v[40:43], a[28:31]
  v_add_f32 v220, 1.0, v220
  v_add_f32 v221, 1.0, v221
  v_add_f32 v222, 1.0, v222
  v_add_f32 v223, 1.0, v223
  v_mfma_f32_16x16x32_bf16 a[48:51], v[60:63], v[44:47], a[48:51]
  buffer_load_dwordx4 v[8:11], v182, s[4:7], s32 offen
  v_mfma_f32_16x16x32_bf16 a[68:71], v[60:63], v[48:51], a[68:71]
  v_mfma_f32_16x16x32_bf16 a[12:15], v[64:67], v[36:39], a[12:15]
  s_add_u32 s33, s32, 559104
  buffer_load_dwordx4 v[28:31], v184, s[8:11], s33 offen
  v_mfma_f32_16x16x32_bf16 a[32:35], v[64:67], v[40:43], a[32:35]
  v_mfma_f32_16x16x32_bf16 a[52:55], v[64:67], v[44:47], a[52:55]
  buffer_load_dwordx4 v[12:15], v183, s[4:7], s32 offen
  v_mfma_f32_16x16x32_bf16 a[72:75], v[64:67], v[48:51], a[72:75]
  v_mfma_f32_16x16x32_bf16 a[16:19], v[68:71], v[36:39], a[16:19]
  s_add_u32 s33, s32, 745472
  buffer_load_dwordx4 v[32:35], v184, s[8:11], s33 offen
  v_mfma_f32_16x16x32_bf16 a[36:39], v[68:71], v[40:43], a[36:39]
  v_mfma_f32_16x16x32_bf16 a[56:59], v[68:71], v[44:47], a[56:59]
  s_add_u32 s32, s32, 1024
  v_mfma_f32_16x16x32_bf16 a[76:79], v[68:71], v[48:51], a[76:79]
  s_waitcnt vmcnt(27)
  v_mfma_f32_16x16x32_bf16 a[0:3], v[88:91], v[72:75], a[0:3]
  buffer_load_dwordx4 v[52:55], v184, s[8:11], s32 offen
  v_mfma_f32_16x16x32_bf16 a[20:23], v[88:91], v[76:79], a[20:23]
  v_mfma_f32_16x16x32_bf16 a[40:43], v[88:91], v[80:83], a[40:43]
  buffer_load_dwordx4 v[36:39], v180, s[4:7], s32 offen
  v_mfma_f32_16x16x32_bf16 a[60:63], v[88:91], v[84:87], a[60:63]
  v_rcp_f32 v220, v220
  v_rcp_f32 v221, v221
  v_rcp_f32 v222, v222
  v_rcp_f32 v223, v223
  v_mfma_f32_16x16x32_bf16 a[4:7], v[92:95], v[72:75], a[4:7]
  s_add_u32 s33, s32, 186368
  buffer_load_dwordx4 v[56:59], v184, s[8:11], s33 offen
  v_mfma_f32_16x16x32_bf16 a[24:27], v[92:95], v[76:79], a[24:27]
  v_mfma_f32_16x16x32_bf16 a[44:47], v[92:95], v[80:83], a[44:47]
  buffer_load_dwordx4 v[40:43], v181, s[4:7], s32 offen
  v_mul_f32 v200, v200, v220
  v_mul_f32 v201, v201, v221
  v_mul_f32 v202, v202, v222
  v_mul_f32 v203, v203, v223
  v_mfma_f32_16x16x32_bf16 a[64:67], v[92:95], v[84:87], a[64:67]
  v_mfma_f32_16x16x32_bf16 a[8:11], v[96:99], v[72:75], a[8:11]
  s_add_u32 s33, s32, 372736
  buffer_load_dwordx4 v[60:63], v184, s[8:11], s33 offen
  v_mfma_f32_16x16x32_bf16 a[28:31], v[96:99], v[76:79], a[28:31]
  v_mfma_f32_16x16x32_bf16 a[48:51], v[96:99], v[80:83], a[48:51]
  buffer_load_dwordx4 v[44:47], v182, s[4:7], s32 offen
  v_mfma_f32_16x16x32_bf16 a[68:71], v[96:99], v[84:87], a[68:71]
  v_mfma_f32_16x16x32_bf16 a[12:15], v[100:103], v[72:75], a[12:15]
  s_add_u32 s33, s32, 559104
  buffer_load_dwordx4 v[64:67], v184, s[8:11], s33 offen
  v_mfma_f32_16x16x32_bf16 a[32:35], v[100:103], v[76:79], a[32:35]
  v_mfma_f32_16x16x32_bf16 a[52:55], v[100:103], v[80:83], a[52:55]
  buffer_load_dwordx4 v[48:51], v183, s[4:7], s32 offen
  v_mfma_f32_16x16x32_bf16 a[72:75], v[100:103], v[84:87], a[72:75]
  v_mfma_f32_16x16x32_bf16 a[16:19], v[104:107], v[72:75], a[16:19]
  s_add_u32 s33, s32, 745472
  buffer_load_dwordx4 v[68:71], v184, s[8:11], s33 offen
  v_mfma_f32_16x16x32_bf16 a[36:39], v[104:107], v[76:79], a[36:39]
  v_mfma_f32_16x16x32_bf16 a[56:59], v[104:107], v[80:83], a[56:59]
  s_add_u32 s32, s32, 1024
  v_mfma_f32_16x16x32_bf16 a[76:79], v[104:107], v[84:87], a[76:79]
  s_waitcnt vmcnt(27)
  v_mfma_f32_16x16x32_bf16 a[0:3], v[124:127], v[108:111], a[0:3]
  buffer_load_dwordx4 v[88:91], v184, s[8:11], s32 offen
  v_mfma_f32_16x16x32_bf16 a[20:23], v[124:127], v[112:115], a[20:23]
  v_mfma_f32_16x16x32_bf16 a[40:43], v[124:127], v[116:119], a[40:43]
  buffer_load_dwordx4 v[72:75], v180, s[4:7], s32 offen
  v_mfma_f32_16x16x32_bf16 a[60:63], v[124:127], v[120:123], a[60:63]
  v_mul_f32 v224, 0xbfb8aa3b, v204
  v_mul_f32 v225, 0xbfb8aa3b, v205
  v_mul_f32 v226, 0xbfb8aa3b, v206
  v_mul_f32 v227, 0xbfb8aa3b, v207
  v_mfma_f32_16x16x32_bf16 a[4:7], v[128:131], v[108:111], a[4:7]
  s_add_u32 s33, s32, 186368
  buffer_load_dwordx4 v[92:95], v184, s[8:11], s33 offen
  v_mfma_f32_16x16x32_bf16 a[24:27], v[128:131], v[112:115], a[24:27]
  v_mfma_f32_16x16x32_bf16 a[44:47], v[128:131], v[116:119], a[44:47]
  buffer_load_dwordx4 v[76:79], v181, s[4:7], s32 offen
  v_exp_f32 v224, v224
  v_exp_f32 v225, v225
  v_exp_f32 v226, v226
  v_exp_f32 v227, v227
  v_mfma_f32_16x16x32_bf16 a[64:67], v[128:131], v[120:123], a[64:67]
  v_mfma_f32_16x16x32_bf16 a[8:11], v[132:135], v[108:111], a[8:11]
  s_add_u32 s33, s32, 372736
  buffer_load_dwordx4 v[96:99], v184, s[8:11], s33 offen
  v_mfma_f32_16x16x32_bf16 a[28:31], v[132:135], v[112:115], a[28:31]
  v_add_f32 v224, 1.0, v224
  v_add_f32 v225, 1.0, v225
  v_add_f32 v226, 1.0, v226
  v_add_f32 v227, 1.0, v227
  v_mfma_f32_16x16x32_bf16 a[48:51], v[132:135], v[116:119], a[48:51]
  buffer_load_dwordx4 v[80:83], v182, s[4:7], s32 offen
  v_mfma_f32_16x16x32_bf16 a[68:71], v[132:135], v[120:123], a[68:71]
  v_mfma_f32_16x16x32_bf16 a[12:15], v[136:139], v[108:111], a[12:15]
  s_add_u32 s33, s32, 559104
  buffer_load_dwordx4 v[100:103], v184, s[8:11], s33 offen
  v_mfma_f32_16x16x32_bf16 a[32:35], v[136:139], v[112:115], a[32:35]
  v_mfma_f32_16x16x32_bf16 a[52:55], v[136:139], v[116:119], a[52:55]
  buffer_load_dwordx4 v[84:87], v183, s[4:7], s32 offen
  v_mfma_f32_16x16x32_bf16 a[72:75], v[136:139], v[120:123], a[72:75]
  v_mfma_f32_16x16x32_bf16 a[16:19], v[140:143], v[108:111], a[16:19]
  s_add_u32 s33, s32, 745472
  buffer_load_dwordx4 v[104:107], v184, s[8:11], s33 offen
  v_mfma_f32_16x16x32_bf16 a[36:39], v[140:143], v[112:115], a[36:39]
  v_mfma_f32_16x16x32_bf16 a[56:59], v[140:143], v[116:119], a[56:59]
  s_add_u32 s32, s32, 1024
  v_mfma_f32_16x16x32_bf16 a[76:79], v[140:143], v[120:123], a[76:79]
  s_waitcnt vmcnt(27)
  v_mfma_f32_16x16x32_bf16 a[0:3], v[160:163], v[144:147], a[0:3]
  buffer_load_dwordx4 v[124:127], v184, s[8:11], s32 offen
  v_mfma_f32_16x16x32_bf16 a[20:23], v[160:163], v[148:151], a[20:23]
  v_mfma_f32_16x16x32_bf16 a[40:43], v[160:163], v[152:155], a[40:43]
  buffer_load_dwordx4 v[108:111], v180, s[4:7], s32 offen
  v_mfma_f32_16x16x32_bf16 a[60:63], v[160:163], v[156:159], a[60:63]
  v_rcp_f32 v224, v224
  v_rcp_f32 v225, v225
  v_rcp_f32 v226, v226
  v_rcp_f32 v227, v227
  v_mfma_f32_16x16x32_bf16 a[4:7], v[164:167], v[144:147], a[4:7]
  s_add_u32 s33, s32, 186368
  buffer_load_dwordx4 v[128:131], v184, s[8:11], s33 offen
  v_mfma_f32_16x16x32_bf16 a[24:27], v[164:167], v[148:151], a[24:27]
  v_mfma_f32_16x16x32_bf16 a[44:47], v[164:167], v[152:155], a[44:47]
  buffer_load_dwordx4 v[112:115], v181, s[4:7], s32 offen
  v_mul_f32 v204, v204, v224
  v_mul_f32 v205, v205, v225
  v_mul_f32 v206, v206, v226
  v_mul_f32 v207, v207, v227
  v_mfma_f32_16x16x32_bf16 a[64:67], v[164:167], v[156:159], a[64:67]
  v_mfma_f32_16x16x32_bf16 a[8:11], v[168:171], v[144:147], a[8:11]
  s_add_u32 s33, s32, 372736
  buffer_load_dwordx4 v[132:135], v184, s[8:11], s33 offen
  v_mfma_f32_16x16x32_bf16 a[28:31], v[168:171], v[148:151], a[28:31]
  v_mfma_f32_16x16x32_bf16 a[48:51], v[168:171], v[152:155], a[48:51]
  buffer_load_dwordx4 v[116:119], v182, s[4:7], s32 offen
  v_mfma_f32_16x16x32_bf16 a[68:71], v[168:171], v[156:159], a[68:71]
  v_mfma_f32_16x16x32_bf16 a[12:15], v[172:175], v[144:147], a[12:15]
  s_add_u32 s33, s32, 559104
  buffer_load_dwordx4 v[136:139], v184, s[8:11], s33 offen
  v_mfma_f32_16x16x32_bf16 a[32:35], v[172:175], v[148:151], a[32:35]
  v_mfma_f32_16x16x32_bf16 a[52:55], v[172:175], v[152:155], a[52:55]
  buffer_load_dwordx4 v[120:123], v183, s[4:7], s32 offen
  v_mfma_f32_16x16x32_bf16 a[72:75], v[172:175], v[156:159], a[72:75]
  v_mfma_f32_16x16x32_bf16 a[16:19], v[176:179], v[144:147], a[16:19]
  s_add_u32 s33, s32, 745472
  buffer_load_dwordx4 v[140:143], v184, s[8:11], s33 offen
  v_mfma_f32_16x16x32_bf16 a[36:39], v[176:179], v[148:151], a[36:39]
  v_mfma_f32_16x16x32_bf16 a[56:59], v[176:179], v[152:155], a[56:59]
  s_add_u32 s32, s32, 1024
  v_mfma_f32_16x16x32_bf16 a[76:79], v[176:179], v[156:159], a[76:79]
  s_waitcnt vmcnt(27)
  v_mfma_f32_16x16x32_bf16 a[0:3], v[16:19], v[0:3], a[0:3]
  buffer_load_dwordx4 v[160:163], v184, s[8:11], s32 offen
  v_mfma_f32_16x16x32_bf16 a[20:23], v[16:19], v[4:7], a[20:23]
  v_mfma_f32_16x16x32_bf16 a[40:43], v[16:19], v[8:11], a[40:43]
  buffer_load_dwordx4 v[144:147], v180, s[4:7], s32 offen
  v_mfma_f32_16x16x32_bf16 a[60:63], v[16:19], v[12:15], a[60:63]
  v_mul_f32 v228, 0xbfb8aa3b, v208
  v_mul_f32 v229, 0xbfb8aa3b, v209
  v_mul_f32 v230, 0xbfb8aa3b, v210
  v_mul_f32 v231, 0xbfb8aa3b, v211
  v_mfma_f32_16x16x32_bf16 a[4:7], v[20:23], v[0:3], a[4:7]
  s_add_u32 s33, s32, 186368
  buffer_load_dwordx4 v[164:167], v184, s[8:11], s33 offen
  v_mfma_f32_16x16x32_bf16 a[24:27], v[20:23], v[4:7], a[24:27]
  v_mfma_f32_16x16x32_bf16 a[44:47], v[20:23], v[8:11], a[44:47]
  buffer_load_dwordx4 v[148:151], v181, s[4:7], s32 offen
  v_exp_f32 v228, v228
  v_exp_f32 v229, v229
  v_exp_f32 v230, v230
  v_exp_f32 v231, v231
  v_mfma_f32_16x16x32_bf16 a[64:67], v[20:23], v[12:15], a[64:67]
  v_mfma_f32_16x16x32_bf16 a[8:11], v[24:27], v[0:3], a[8:11]
  s_add_u32 s33, s32, 372736
  buffer_load_dwordx4 v[168:171], v184, s[8:11], s33 offen
  v_mfma_f32_16x16x32_bf16 a[28:31], v[24:27], v[4:7], a[28:31]
  v_add_f32 v228, 1.0, v228
  v_add_f32 v229, 1.0, v229
  v_add_f32 v230, 1.0, v230
  v_add_f32 v231, 1.0, v231
  v_mfma_f32_16x16x32_bf16 a[48:51], v[24:27], v[8:11], a[48:51]
  buffer_load_dwordx4 v[152:155], v182, s[4:7], s32 offen
  v_mfma_f32_16x16x32_bf16 a[68:71], v[24:27], v[12:15], a[68:71]
  v_mfma_f32_16x16x32_bf16 a[12:15], v[28:31], v[0:3], a[12:15]
  s_add_u32 s33, s32, 559104
  buffer_load_dwordx4 v[172:175], v184, s[8:11], s33 offen
  v_mfma_f32_16x16x32_bf16 a[32:35], v[28:31], v[4:7], a[32:35]
  v_mfma_f32_16x16x32_bf16 a[52:55], v[28:31], v[8:11], a[52:55]
  buffer_load_dwordx4 v[156:159], v183, s[4:7], s32 offen
  v_mfma_f32_16x16x32_bf16 a[72:75], v[28:31], v[12:15], a[72:75]
  v_mfma_f32_16x16x32_bf16 a[16:19], v[32:35], v[0:3], a[16:19]
  s_add_u32 s33, s32, 745472
  buffer_load_dwordx4 v[176:179], v184, s[8:11], s33 offen
  v_mfma_f32_16x16x32_bf16 a[36:39], v[32:35], v[4:7], a[36:39]
  v_mfma_f32_16x16x32_bf16 a[56:59], v[32:35], v[8:11], a[56:59]
  s_add_u32 s32, s32, 1024
  v_mfma_f32_16x16x32_bf16 a[76:79], v[32:35], v[12:15], a[76:79]
  s_waitcnt vmcnt(27)
  v_mfma_f32_16x16x32_bf16 a[0:3], v[52:55], v[36:39], a[0:3]
  buffer_load_dwordx4 v[16:19], v184, s[8:11], s32 offen
  v_mfma_f32_16x16x32_bf16 a[20:23], v[52:55], v[40:43], a[20:23]
  v_mfma_f32_16x16x32_bf16 a[40:43], v[52:55], v[44:47], a[40:43]
  buffer_load_dwordx4 v[0:3], v180, s[4:7], s32 offen
  v_mfma_f32_16x16x32_bf16 a[60:63], v[52:55], v[48:51], a[60:63]
  v_rcp_f32 v228, v228
  v_rcp_f32 v229, v229
  v_rcp_f32 v230, v230
  v_rcp_f32 v231, v231
  v_mfma_f32_16x16x32_bf16 a[4:7], v[56:59], v[36:39], a[4:7]
  s_add_u32 s33, s32, 186368
  buffer_load_dwordx4 v[20:23], v184, s[8:11], s33 offen
  v_mfma_f32_16x16x32_bf16 a[24:27], v[56:59], v[40:43], a[24:27]
  v_mfma_f32_16x16x32_bf16 a[44:47], v[56:59], v[44:47], a[44:47]
  buffer_load_dwordx4 v[4:7], v181, s[4:7], s32 offen
  v_mul_f32 v208, v208, v228
  v_mul_f32 v209, v209, v229
  v_mul_f32 v210, v210, v230
  v_mul_f32 v211, v211, v231
  v_mfma_f32_16x16x32_bf16 a[64:67], v[56:59], v[48:51], a[64:67]
  v_mfma_f32_16x16x32_bf16 a[8:11], v[60:63], v[36:39], a[8:11]
  s_add_u32 s33, s32, 372736
  buffer_load_dwordx4 v[24:27], v184, s[8:11], s33 offen
  v_mfma_f32_16x16x32_bf16 a[28:31], v[60:63], v[40:43], a[28:31]
  v_mfma_f32_16x16x32_bf16 a[48:51], v[60:63], v[44:47], a[48:51]
  buffer_load_dwordx4 v[8:11], v182, s[4:7], s32 offen
  v_mfma_f32_16x16x32_bf16 a[68:71], v[60:63], v[48:51], a[68:71]
  v_mfma_f32_16x16x32_bf16 a[12:15], v[64:67], v[36:39], a[12:15]
  s_add_u32 s33, s32, 559104
  buffer_load_dwordx4 v[28:31], v184, s[8:11], s33 offen
  v_mfma_f32_16x16x32_bf16 a[32:35], v[64:67], v[40:43], a[32:35]
  v_mfma_f32_16x16x32_bf16 a[52:55], v[64:67], v[44:47], a[52:55]
  buffer_load_dwordx4 v[12:15], v183, s[4:7], s32 offen
  v_mfma_f32_16x16x32_bf16 a[72:75], v[64:67], v[48:51], a[72:75]
  v_mfma_f32_16x16x32_bf16 a[16:19], v[68:71], v[36:39], a[16:19]
  s_add_u32 s33, s32, 745472
  buffer_load_dwordx4 v[32:35], v184, s[8:11], s33 offen
  v_mfma_f32_16x16x32_bf16 a[36:39], v[68:71], v[40:43], a[36:39]
  v_mfma_f32_16x16x32_bf16 a[56:59], v[68:71], v[44:47], a[56:59]
  s_add_u32 s32, s32, 1024
  v_mfma_f32_16x16x32_bf16 a[76:79], v[68:71], v[48:51], a[76:79]
  s_waitcnt vmcnt(27)
  v_mfma_f32_16x16x32_bf16 a[0:3], v[88:91], v[72:75], a[0:3]
  buffer_load_dwordx4 v[52:55], v184, s[8:11], s32 offen
  v_mfma_f32_16x16x32_bf16 a[20:23], v[88:91], v[76:79], a[20:23]
  v_mfma_f32_16x16x32_bf16 a[40:43], v[88:91], v[80:83], a[40:43]
  buffer_load_dwordx4 v[36:39], v180, s[4:7], s32 offen
  v_mfma_f32_16x16x32_bf16 a[60:63], v[88:91], v[84:87], a[60:63]
  v_mul_f32 v232, 0xbfb8aa3b, v212
  v_mul_f32 v233, 0xbfb8aa3b, v213
  v_mul_f32 v234, 0xbfb8aa3b, v214
  v_mul_f32 v235, 0xbfb8aa3b, v215
  v_mfma_f32_16x16x32_bf16 a[4:7], v[92:95], v[72:75], a[4:7]
  s_add_u32 s33, s32, 186368
  buffer_load_dwordx4 v[56:59], v184, s[8:11], s33 offen
  v_mfma_f32_16x16x32_bf16 a[24:27], v[92:95], v[76:79], a[24:27]
  v_mfma_f32_16x16x32_bf16 a[44:47], v[92:95], v[80:83], a[44:47]
  buffer_load_dwordx4 v[40:43], v181, s[4:7], s32 offen
  v_exp_f32 v232, v232
  v_exp_f32 v233, v233
  v_exp_f32 v234, v234
  v_exp_f32 v235, v235
  v_mfma_f32_16x16x32_bf16 a[64:67], v[92:95], v[84:87], a[64:67]
  v_mfma_f32_16x16x32_bf16 a[8:11], v[96:99], v[72:75], a[8:11]
  s_add_u32 s33, s32, 372736
  buffer_load_dwordx4 v[60:63], v184, s[8:11], s33 offen
  v_mfma_f32_16x16x32_bf16 a[28:31], v[96:99], v[76:79], a[28:31]
  v_add_f32 v232, 1.0, v232
  v_add_f32 v233, 1.0, v233
  v_add_f32 v234, 1.0, v234
  v_add_f32 v235, 1.0, v235
  v_mfma_f32_16x16x32_bf16 a[48:51], v[96:99], v[80:83], a[48:51]
  buffer_load_dwordx4 v[44:47], v182, s[4:7], s32 offen
  v_mfma_f32_16x16x32_bf16 a[68:71], v[96:99], v[84:87], a[68:71]
  v_mfma_f32_16x16x32_bf16 a[12:15], v[100:103], v[72:75], a[12:15]
  s_add_u32 s33, s32, 559104
  buffer_load_dwordx4 v[64:67], v184, s[8:11], s33 offen
  v_mfma_f32_16x16x32_bf16 a[32:35], v[100:103], v[76:79], a[32:35]
  v_mfma_f32_16x16x32_bf16 a[52:55], v[100:103], v[80:83], a[52:55]
  buffer_load_dwordx4 v[48:51], v183, s[4:7], s32 offen
  v_mfma_f32_16x16x32_bf16 a[72:75], v[100:103], v[84:87], a[72:75]
  v_mfma_f32_16x16x32_bf16 a[16:19], v[104:107], v[72:75], a[16:19]
  s_add_u32 s33, s32, 745472
  buffer_load_dwordx4 v[68:71], v184, s[8:11], s33 offen
  v_mfma_f32_16x16x32_bf16 a[36:39], v[104:107], v[76:79], a[36:39]
  v_mfma_f32_16x16x32_bf16 a[56:59], v[104:107], v[80:83], a[56:59]
  s_add_u32 s32, s32, 1024
  v_mfma_f32_16x16x32_bf16 a[76:79], v[104:107], v[84:87], a[76:79]
  s_waitcnt vmcnt(27)
  v_mfma_f32_16x16x32_bf16 a[0:3], v[124:127], v[108:111], a[0:3]
  buffer_load_dwordx4 v[88:91], v184, s[8:11], s32 offen
  v_mfma_f32_16x16x32_bf16 a[20:23], v[124:127], v[112:115], a[20:23]
  v_mfma_f32_16x16x32_bf16 a[40:43], v[124:127], v[116:119], a[40:43]
  buffer_load_dwordx4 v[72:75], v180, s[4:7], s32 offen
  v_mfma_f32_16x16x32_bf16 a[60:63], v[124:127], v[120:123], a[60:63]
  v_rcp_f32 v232, v232
  v_rcp_f32 v233, v233
  v_rcp_f32 v234, v234
  v_rcp_f32 v235, v235
  v_mfma_f32_16x16x32_bf16 a[4:7], v[128:131], v[108:111], a[4:7]
  s_add_u32 s33, s32, 186368
  buffer_load_dwordx4 v[92:95], v184, s[8:11], s33 offen
  v_mfma_f32_16x16x32_bf16 a[24:27], v[128:131], v[112:115], a[24:27]
  v_mfma_f32_16x16x32_bf16 a[44:47], v[128:131], v[116:119], a[44:47]
  buffer_load_dwordx4 v[76:79], v181, s[4:7], s32 offen
  v_mul_f32 v212, v212, v232
  v_mul_f32 v213, v213, v233
  v_mul_f32 v214, v214, v234
  v_mul_f32 v215, v215, v235
  v_mfma_f32_16x16x32_bf16 a[64:67], v[128:131], v[120:123], a[64:67]
  v_mfma_f32_16x16x32_bf16 a[8:11], v[132:135], v[108:111], a[8:11]
  s_add_u32 s33, s32, 372736
  buffer_load_dwordx4 v[96:99], v184, s[8:11], s33 offen
  v_mfma_f32_16x16x32_bf16 a[28:31], v[132:135], v[112:115], a[28:31]
  v_mfma_f32_16x16x32_bf16 a[48:51], v[132:135], v[116:119], a[48:51]
  buffer_load_dwordx4 v[80:83], v182, s[4:7], s32 offen
  v_mfma_f32_16x16x32_bf16 a[68:71], v[132:135], v[120:123], a[68:71]
  v_mfma_f32_16x16x32_bf16 a[12:15], v[136:139], v[108:111], a[12:15]
  s_add_u32 s33, s32, 559104
  buffer_load_dwordx4 v[100:103], v184, s[8:11], s33 offen
  v_mfma_f32_16x16x32_bf16 a[32:35], v[136:139], v[112:115], a[32:35]
  v_mfma_f32_16x16x32_bf16 a[52:55], v[136:139], v[116:119], a[52:55]
  buffer_load_dwordx4 v[84:87], v183, s[4:7], s32 offen
  v_mfma_f32_16x16x32_bf16 a[72:75], v[136:139], v[120:123], a[72:75]
  v_mfma_f32_16x16x32_bf16 a[16:19], v[140:143], v[108:111], a[16:19]
  s_add_u32 s33, s32, 745472
  buffer_load_dwordx4 v[104:107], v184, s[8:11], s33 offen
  v_mfma_f32_16x16x32_bf16 a[36:39], v[140:143], v[112:115], a[36:39]
  v_mfma_f32_16x16x32_bf16 a[56:59], v[140:143], v[116:119], a[56:59]
  s_add_u32 s32, s32, 1024
  v_mfma_f32_16x16x32_bf16 a[76:79], v[140:143], v[120:123], a[76:79]
  s_waitcnt vmcnt(27)
  v_mfma_f32_16x16x32_bf16 a[0:3], v[160:163], v[144:147], a[0:3]
  buffer_load_dwordx4 v[124:127], v184, s[8:11], s32 offen
  v_mfma_f32_16x16x32_bf16 a[20:23], v[160:163], v[148:151], a[20:23]
  v_mfma_f32_16x16x32_bf16 a[40:43], v[160:163], v[152:155], a[40:43]
  buffer_load_dwordx4 v[108:111], v180, s[4:7], s32 offen
  v_mfma_f32_16x16x32_bf16 a[60:63], v[160:163], v[156:159], a[60:63]
  v_mul_f32 v236, 0xbfb8aa3b, v216
  v_mul_f32 v237, 0xbfb8aa3b, v217
  v_mul_f32 v238, 0xbfb8aa3b, v218
  v_mul_f32 v239, 0xbfb8aa3b, v219
  v_mfma_f32_16x16x32_bf16 a[4:7], v[164:167], v[144:147], a[4:7]
  s_add_u32 s33, s32, 186368
  buffer_load_dwordx4 v[128:131], v184, s[8:11], s33 offen
  v_mfma_f32_16x16x32_bf16 a[24:27], v[164:167], v[148:151], a[24:27]
  v_mfma_f32_16x16x32_bf16 a[44:47], v[164:167], v[152:155], a[44:47]
  buffer_load_dwordx4 v[112:115], v181, s[4:7], s32 offen
  v_exp_f32 v236, v236
  v_exp_f32 v237, v237
  v_exp_f32 v238, v238
  v_exp_f32 v239, v239
  v_mfma_f32_16x16x32_bf16 a[64:67], v[164:167], v[156:159], a[64:67]
  v_mfma_f32_16x16x32_bf16 a[8:11], v[168:171], v[144:147], a[8:11]
  s_add_u32 s33, s32, 372736
  buffer_load_dwordx4 v[132:135], v184, s[8:11], s33 offen
  v_mfma_f32_16x16x32_bf16 a[28:31], v[168:171], v[148:151], a[28:31]
  v_add_f32 v236, 1.0, v236
  v_add_f32 v237, 1.0, v237
  v_add_f32 v238, 1.0, v238
  v_add_f32 v239, 1.0, v239
  v_mfma_f32_16x16x32_bf16 a[48:51], v[168:171], v[152:155], a[48:51]
  buffer_load_dwordx4 v[116:119], v182, s[4:7], s32 offen
  v_mfma_f32_16x16x32_bf16 a[68:71], v[168:171], v[156:159], a[68:71]
  v_mfma_f32_16x16x32_bf16 a[12:15], v[172:175], v[144:147], a[12:15]
  s_add_u32 s33, s32, 559104
  buffer_load_dwordx4 v[136:139], v184, s[8:11], s33 offen
  v_mfma_f32_16x16x32_bf16 a[32:35], v[172:175], v[148:151], a[32:35]
  v_mfma_f32_16x16x32_bf16 a[52:55], v[172:175], v[152:155], a[52:55]
  buffer_load_dwordx4 v[120:123], v183, s[4:7], s32 offen
  v_mfma_f32_16x16x32_bf16 a[72:75], v[172:175], v[156:159], a[72:75]
  v_mfma_f32_16x16x32_bf16 a[16:19], v[176:179], v[144:147], a[16:19]
  s_add_u32 s33, s32, 745472
  buffer_load_dwordx4 v[140:143], v184, s[8:11], s33 offen
  v_mfma_f32_16x16x32_bf16 a[36:39], v[176:179], v[148:151], a[36:39]
  v_mfma_f32_16x16x32_bf16 a[56:59], v[176:179], v[152:155], a[56:59]
  s_add_u32 s32, s32, 1024
  v_mfma_f32_16x16x32_bf16 a[76:79], v[176:179], v[156:159], a[76:79]
  s_waitcnt vmcnt(27)
  v_mfma_f32_16x16x32_bf16 a[0:3], v[16:19], v[0:3], a[0:3]
  buffer_load_dwordx4 v[160:163], v184, s[8:11], s32 offen
  v_mfma_f32_16x16x32_bf16 a[20:23], v[16:19], v[4:7], a[20:23]
  v_mfma_f32_16x16x32_bf16 a[40:43], v[16:19], v[8:11], a[40:43]
  buffer_load_dwordx4 v[144:147], v180, s[4:7], s32 offen
  v_mfma_f32_16x16x32_bf16 a[60:63], v[16:19], v[12:15], a[60:63]
  v_rcp_f32 v236, v236
  v_rcp_f32 v237, v237
  v_rcp_f32 v238, v238
  v_rcp_f32 v239, v239
  v_mfma_f32_16x16x32_bf16 a[4:7], v[20:23], v[0:3], a[4:7]
  s_add_u32 s33, s32, 186368
  buffer_load_dwordx4 v[164:167], v184, s[8:11], s33 offen
  v_mfma_f32_16x16x32_bf16 a[24:27], v[20:23], v[4:7], a[24:27]
  v_mfma_f32_16x16x32_bf16 a[44:47], v[20:23], v[8:11], a[44:47]
  buffer_load_dwordx4 v[148:151], v181, s[4:7], s32 offen
  v_mul_f32 v216, v216, v236
  v_mul_f32 v217, v217, v237
  v_mul_f32 v218, v218, v238
  v_mul_f32 v219, v219, v239
  v_mfma_f32_16x16x32_bf16 a[64:67], v[20:23], v[12:15], a[64:67]
  v_mfma_f32_16x16x32_bf16 a[8:11], v[24:27], v[0:3], a[8:11]
  s_add_u32 s33, s32, 372736
  buffer_load_dwordx4 v[168:171], v184, s[8:11], s33 offen
  v_mfma_f32_16x16x32_bf16 a[28:31], v[24:27], v[4:7], a[28:31]
  v_mfma_f32_16x16x32_bf16 a[48:51], v[24:27], v[8:11], a[48:51]
  buffer_load_dwordx4 v[152:155], v182, s[4:7], s32 offen
  v_mfma_f32_16x16x32_bf16 a[68:71], v[24:27], v[12:15], a[68:71]
  v_mfma_f32_16x16x32_bf16 a[12:15], v[28:31], v[0:3], a[12:15]
  s_add_u32 s33, s32, 559104
  buffer_load_dwordx4 v[172:175], v184, s[8:11], s33 offen
  v_mfma_f32_16x16x32_bf16 a[32:35], v[28:31], v[4:7], a[32:35]
  v_mfma_f32_16x16x32_bf16 a[52:55], v[28:31], v[8:11], a[52:55]
  buffer_load_dwordx4 v[156:159], v183, s[4:7], s32 offen
  v_mfma_f32_16x16x32_bf16 a[72:75], v[28:31], v[12:15], a[72:75]
  v_mfma_f32_16x16x32_bf16 a[16:19], v[32:35], v[0:3], a[16:19]
  s_add_u32 s33, s32, 745472
  buffer_load_dwordx4 v[176:179], v184, s[8:11], s33 offen
  v_mfma_f32_16x16x32_bf16 a[36:39], v[32:35], v[4:7], a[36:39]
  v_mfma_f32_16x16x32_bf16 a[56:59], v[32:35], v[8:11], a[56:59]
  s_add_u32 s32, s32, 1024
  v_mfma_f32_16x16x32_bf16 a[76:79], v[32:35], v[12:15], a[76:79]
  s_waitcnt vmcnt(27)
  v_mfma_f32_16x16x32_bf16 a[0:3], v[52:55], v[36:39], a[0:3]
  buffer_load_dwordx4 v[16:19], v184, s[8:11], s32 offen
  v_mfma_f32_16x16x32_bf16 a[20:23], v[52:55], v[40:43], a[20:23]
  v_mfma_f32_16x16x32_bf16 a[40:43], v[52:55], v[44:47], a[40:43]
  buffer_load_dwordx4 v[0:3], v180, s[4:7], s32 offen
  v_mfma_f32_16x16x32_bf16 a[60:63], v[52:55], v[48:51], a[60:63]
  v_mfma_f32_16x16x32_bf16 a[4:7], v[56:59], v[36:39], a[4:7]
  s_add_u32 s33, s32, 186368
  buffer_load_dwordx4 v[20:23], v184, s[8:11], s33 offen
  v_mfma_f32_16x16x32_bf16 a[24:27], v[56:59], v[40:43], a[24:27]
  v_mfma_f32_16x16x32_bf16 a[44:47], v[56:59], v[44:47], a[44:47]
  buffer_load_dwordx4 v[4:7], v181, s[4:7], s32 offen
  v_mfma_f32_16x16x32_bf16 a[64:67], v[56:59], v[48:51], a[64:67]
  v_mfma_f32_16x16x32_bf16 a[8:11], v[60:63], v[36:39], a[8:11]
  s_add_u32 s33, s32, 372736
  buffer_load_dwordx4 v[24:27], v184, s[8:11], s33 offen
  v_mfma_f32_16x16x32_bf16 a[28:31], v[60:63], v[40:43], a[28:31]
  v_mfma_f32_16x16x32_bf16 a[48:51], v[60:63], v[44:47], a[48:51]
  buffer_load_dwordx4 v[8:11], v182, s[4:7], s32 offen
  v_mfma_f32_16x16x32_bf16 a[68:71], v[60:63], v[48:51], a[68:71]
  v_mfma_f32_16x16x32_bf16 a[12:15], v[64:67], v[36:39], a[12:15]
  s_add_u32 s33, s32, 559104
  buffer_load_dwordx4 v[28:31], v184, s[8:11], s33 offen
  v_mfma_f32_16x16x32_bf16 a[32:35], v[64:67], v[40:43], a[32:35]
  v_mfma_f32_16x16x32_bf16 a[52:55], v[64:67], v[44:47], a[52:55]
  buffer_load_dwordx4 v[12:15], v183, s[4:7], s32 offen
  v_mfma_f32_16x16x32_bf16 a[72:75], v[64:67], v[48:51], a[72:75]
  v_mfma_f32_16x16x32_bf16 a[16:19], v[68:71], v[36:39], a[16:19]
  s_add_u32 s33, s32, 745472
  buffer_load_dwordx4 v[32:35], v184, s[8:11], s33 offen
  v_mfma_f32_16x16x32_bf16 a[36:39], v[68:71], v[40:43], a[36:39]
  v_mfma_f32_16x16x32_bf16 a[56:59], v[68:71], v[44:47], a[56:59]
  s_add_u32 s32, s32, 1024
  v_mfma_f32_16x16x32_bf16 a[76:79], v[68:71], v[48:51], a[76:79]
  s_waitcnt vmcnt(27)
  v_mfma_f32_16x16x32_bf16 a[0:3], v[88:91], v[72:75], a[0:3]
  buffer_load_dwordx4 v[52:55], v184, s[8:11], s32 offen
  v_mfma_f32_16x16x32_bf16 a[20:23], v[88:91], v[76:79], a[20:23]
  v_mfma_f32_16x16x32_bf16 a[40:43], v[88:91], v[80:83], a[40:43]
  buffer_load_dwordx4 v[36:39], v180, s[4:7], s32 offen
  v_mfma_f32_16x16x32_bf16 a[60:63], v[88:91], v[84:87], a[60:63]
  v_mfma_f32_16x16x32_bf16 a[4:7], v[92:95], v[72:75], a[4:7]
  s_add_u32 s33, s32, 186368
  buffer_load_dwordx4 v[56:59], v184, s[8:11], s33 offen
  v_mfma_f32_16x16x32_bf16 a[24:27], v[92:95], v[76:79], a[24:27]
  v_mfma_f32_16x16x32_bf16 a[44:47], v[92:95], v[80:83], a[44:47]
  buffer_load_dwordx4 v[40:43], v181, s[4:7], s32 offen
  v_mfma_f32_16x16x32_bf16 a[64:67], v[92:95], v[84:87], a[64:67]
  v_mfma_f32_16x16x32_bf16 a[8:11], v[96:99], v[72:75], a[8:11]
  s_add_u32 s33, s32, 372736
  buffer_load_dwordx4 v[60:63], v184, s[8:11], s33 offen
  v_mfma_f32_16x16x32_bf16 a[28:31], v[96:99], v[76:79], a[28:31]
  v_mfma_f32_16x16x32_bf16 a[48:51], v[96:99], v[80:83], a[48:51]
  buffer_load_dwordx4 v[44:47], v182, s[4:7], s32 offen
  v_mfma_f32_16x16x32_bf16 a[68:71], v[96:99], v[84:87], a[68:71]
  v_mfma_f32_16x16x32_bf16 a[12:15], v[100:103], v[72:75], a[12:15]
  s_add_u32 s33, s32, 559104
  buffer_load_dwordx4 v[64:67], v184, s[8:11], s33 offen
  v_mfma_f32_16x16x32_bf16 a[32:35], v[100:103], v[76:79], a[32:35]
  v_mfma_f32_16x16x32_bf16 a[52:55], v[100:103], v[80:83], a[52:55]
  buffer_load_dwordx4 v[48:51], v183, s[4:7], s32 offen
  v_mfma_f32_16x16x32_bf16 a[72:75], v[100:103], v[84:87], a[72:75]
  v_mfma_f32_16x16x32_bf16 a[16:19], v[104:107], v[72:75], a[16:19]
  s_add_u32 s33, s32, 745472
  buffer_load_dwordx4 v[68:71], v184, s[8:11], s33 offen
  v_mfma_f32_16x16x32_bf16 a[36:39], v[104:107], v[76:79], a[36:39]
  v_mfma_f32_16x16x32_bf16 a[56:59], v[104:107], v[80:83], a[56:59]
  s_add_u32 s32, s32, 1024
  v_mfma_f32_16x16x32_bf16 a[76:79], v[104:107], v[84:87], a[76:79]
  s_waitcnt vmcnt(27)
  v_mfma_f32_16x16x32_bf16 a[0:3], v[124:127], v[108:111], a[0:3]
  buffer_load_dwordx4 v[88:91], v184, s[8:11], s32 offen
  v_mfma_f32_16x16x32_bf16 a[20:23], v[124:127], v[112:115], a[20:23]
  v_mfma_f32_16x16x32_bf16 a[40:43], v[124:127], v[116:119], a[40:43]
  buffer_load_dwordx4 v[72:75], v180, s[4:7], s32 offen
  v_mfma_f32_16x16x32_bf16 a[60:63], v[124:127], v[120:123], a[60:63]
  v_mfma_f32_16x16x32_bf16 a[4:7], v[128:131], v[108:111], a[4:7]
  s_add_u32 s33, s32, 186368
  buffer_load_dwordx4 v[92:95], v184, s[8:11], s33 offen
  v_mfma_f32_16x16x32_bf16 a[24:27], v[128:131], v[112:115], a[24:27]
  v_mfma_f32_16x16x32_bf16 a[44:47], v[128:131], v[116:119], a[44:47]
  buffer_load_dwordx4 v[76:79], v181, s[4:7], s32 offen
  v_mfma_f32_16x16x32_bf16 a[64:67], v[128:131], v[120:123], a[64:67]
  v_mfma_f32_16x16x32_bf16 a[8:11], v[132:135], v[108:111], a[8:11]
  s_add_u32 s33, s32, 372736
  buffer_load_dwordx4 v[96:99], v184, s[8:11], s33 offen
  v_mfma_f32_16x16x32_bf16 a[28:31], v[132:135], v[112:115], a[28:31]
  v_mfma_f32_16x16x32_bf16 a[48:51], v[132:135], v[116:119], a[48:51]
  buffer_load_dwordx4 v[80:83], v182, s[4:7], s32 offen
  v_mfma_f32_16x16x32_bf16 a[68:71], v[132:135], v[120:123], a[68:71]
  v_mfma_f32_16x16x32_bf16 a[12:15], v[136:139], v[108:111], a[12:15]
  s_add_u32 s33, s32, 559104
  buffer_load_dwordx4 v[100:103], v184, s[8:11], s33 offen
  v_mfma_f32_16x16x32_bf16 a[32:35], v[136:139], v[112:115], a[32:35]
  v_mfma_f32_16x16x32_bf16 a[52:55], v[136:139], v[116:119], a[52:55]
  buffer_load_dwordx4 v[84:87], v183, s[4:7], s32 offen
  v_mfma_f32_16x16x32_bf16 a[72:75], v[136:139], v[120:123], a[72:75]
  v_mfma_f32_16x16x32_bf16 a[16:19], v[140:143], v[108:111], a[16:19]
  s_add_u32 s33, s32, 745472
  buffer_load_dwordx4 v[104:107], v184, s[8:11], s33 offen
  v_mfma_f32_16x16x32_bf16 a[36:39], v[140:143], v[112:115], a[36:39]
  v_mfma_f32_16x16x32_bf16 a[56:59], v[140:143], v[116:119], a[56:59]
  s_add_u32 s32, s32, 1024
  v_mfma_f32_16x16x32_bf16 a[76:79], v[140:143], v[120:123], a[76:79]
  s_waitcnt vmcnt(27)
  v_mfma_f32_16x16x32_bf16 a[0:3], v[160:163], v[144:147], a[0:3]
  buffer_load_dwordx4 v[124:127], v184, s[8:11], s32 offen
  v_mfma_f32_16x16x32_bf16 a[20:23], v[160:163], v[148:151], a[20:23]
  v_mfma_f32_16x16x32_bf16 a[40:43], v[160:163], v[152:155], a[40:43]
  buffer_load_dwordx4 v[108:111], v180, s[4:7], s32 offen
  v_mfma_f32_16x16x32_bf16 a[60:63], v[160:163], v[156:159], a[60:63]
  v_mfma_f32_16x16x32_bf16 a[4:7], v[164:167], v[144:147], a[4:7]
  s_add_u32 s33, s32, 186368
  buffer_load_dwordx4 v[128:131], v184, s[8:11], s33 offen
  v_mfma_f32_16x16x32_bf16 a[24:27], v[164:167], v[148:151], a[24:27]
  v_mfma_f32_16x16x32_bf16 a[44:47], v[164:167], v[152:155], a[44:47]
  buffer_load_dwordx4 v[112:115], v181, s[4:7], s32 offen
  v_mfma_f32_16x16x32_bf16 a[64:67], v[164:167], v[156:159], a[64:67]
  v_mfma_f32_16x16x32_bf16 a[8:11], v[168:171], v[144:147], a[8:11]
  s_add_u32 s33, s32, 372736
  buffer_load_dwordx4 v[132:135], v184, s[8:11], s33 offen
  v_mfma_f32_16x16x32_bf16 a[28:31], v[168:171], v[148:151], a[28:31]
  v_mfma_f32_16x16x32_bf16 a[48:51], v[168:171], v[152:155], a[48:51]
  buffer_load_dwordx4 v[116:119], v182, s[4:7], s32 offen
  v_mfma_f32_16x16x32_bf16 a[68:71], v[168:171], v[156:159], a[68:71]
  v_mfma_f32_16x16x32_bf16 a[12:15], v[172:175], v[144:147], a[12:15]
  s_add_u32 s33, s32, 559104
  buffer_load_dwordx4 v[136:139], v184, s[8:11], s33 offen
  v_mfma_f32_16x16x32_bf16 a[32:35], v[172:175], v[148:151], a[32:35]
  v_mfma_f32_16x16x32_bf16 a[52:55], v[172:175], v[152:155], a[52:55]
  buffer_load_dwordx4 v[120:123], v183, s[4:7], s32 offen
  v_mfma_f32_16x16x32_bf16 a[72:75], v[172:175], v[156:159], a[72:75]
  v_mfma_f32_16x16x32_bf16 a[16:19], v[176:179], v[144:147], a[16:19]
  s_add_u32 s33, s32, 745472
  buffer_load_dwordx4 v[140:143], v184, s[8:11], s33 offen
  v_mfma_f32_16x16x32_bf16 a[36:39], v[176:179], v[148:151], a[36:39]
  v_mfma_f32_16x16x32_bf16 a[56:59], v[176:179], v[152:155], a[56:59]
  s_add_u32 s32, s32, 1024
  v_mfma_f32_16x16x32_bf16 a[76:79], v[176:179], v[156:159], a[76:79]
  s_waitcnt vmcnt(27)
  v_mfma_f32_16x16x32_bf16 a[0:3], v[16:19], v[0:3], a[0:3]
  buffer_load_dwordx4 v[160:163], v184, s[8:11], s32 offen
  v_mfma_f32_16x16x32_bf16 a[20:23], v[16:19], v[4:7], a[20:23]
  v_mfma_f32_16x16x32_bf16 a[40:43], v[16:19], v[8:11], a[40:43]
  buffer_load_dwordx4 v[144:147], v180, s[4:7], s32 offen
  v_mfma_f32_16x16x32_bf16 a[60:63], v[16:19], v[12:15], a[60:63]
  v_mfma_f32_16x16x32_bf16 a[4:7], v[20:23], v[0:3], a[4:7]
  s_add_u32 s33, s32, 186368
  buffer_load_dwordx4 v[164:167], v184, s[8:11], s33 offen
  v_mfma_f32_16x16x32_bf16 a[24:27], v[20:23], v[4:7], a[24:27]
  v_mfma_f32_16x16x32_bf16 a[44:47], v[20:23], v[8:11], a[44:47]
  buffer_load_dwordx4 v[148:151], v181, s[4:7], s32 offen
  v_mfma_f32_16x16x32_bf16 a[64:67], v[20:23], v[12:15], a[64:67]
  v_mfma_f32_16x16x32_bf16 a[8:11], v[24:27], v[0:3], a[8:11]
  s_add_u32 s33, s32, 372736
  buffer_load_dwordx4 v[168:171], v184, s[8:11], s33 offen
  v_mfma_f32_16x16x32_bf16 a[28:31], v[24:27], v[4:7], a[28:31]
  v_mfma_f32_16x16x32_bf16 a[48:51], v[24:27], v[8:11], a[48:51]
  buffer_load_dwordx4 v[152:155], v182, s[4:7], s32 offen
  v_mfma_f32_16x16x32_bf16 a[68:71], v[24:27], v[12:15], a[68:71]
  v_mfma_f32_16x16x32_bf16 a[12:15], v[28:31], v[0:3], a[12:15]
  s_add_u32 s33, s32, 559104
  buffer_load_dwordx4 v[172:175], v184, s[8:11], s33 offen
  v_mfma_f32_16x16x32_bf16 a[32:35], v[28:31], v[4:7], a[32:35]
  v_mfma_f32_16x16x32_bf16 a[52:55], v[28:31], v[8:11], a[52:55]
  buffer_load_dwordx4 v[156:159], v183, s[4:7], s32 offen
  v_mfma_f32_16x16x32_bf16 a[72:75], v[28:31], v[12:15], a[72:75]
  v_mfma_f32_16x16x32_bf16 a[16:19], v[32:35], v[0:3], a[16:19]
  s_add_u32 s33, s32, 745472
  buffer_load_dwordx4 v[176:179], v184, s[8:11], s33 offen
  v_mfma_f32_16x16x32_bf16 a[36:39], v[32:35], v[4:7], a[36:39]
  v_mfma_f32_16x16x32_bf16 a[56:59], v[32:35], v[8:11], a[56:59]
  s_add_u32 s32, s32, 1024
  v_mfma_f32_16x16x32_bf16 a[76:79], v[32:35], v[12:15], a[76:79]
  s_waitcnt vmcnt(27)
  v_mfma_f32_16x16x32_bf16 a[0:3], v[52:55], v[36:39], a[0:3]
  buffer_load_dwordx4 v[16:19], v184, s[8:11], s32 offen
  v_mfma_f32_16x16x32_bf16 a[20:23], v[52:55], v[40:43], a[20:23]
  v_mfma_f32_16x16x32_bf16 a[40:43], v[52:55], v[44:47], a[40:43]
  buffer_load_dwordx4 v[0:3], v180, s[4:7], s32 offen
  v_mfma_f32_16x16x32_bf16 a[60:63], v[52:55], v[48:51], a[60:63]
  v_mfma_f32_16x16x32_bf16 a[4:7], v[56:59], v[36:39], a[4:7]
  s_add_u32 s33, s32, 186368
  buffer_load_dwordx4 v[20:23], v184, s[8:11], s33 offen
  v_mfma_f32_16x16x32_bf16 a[24:27], v[56:59], v[40:43], a[24:27]
  v_mfma_f32_16x16x32_bf16 a[44:47], v[56:59], v[44:47], a[44:47]
  buffer_load_dwordx4 v[4:7], v181, s[4:7], s32 offen
  v_mfma_f32_16x16x32_bf16 a[64:67], v[56:59], v[48:51], a[64:67]
  v_mfma_f32_16x16x32_bf16 a[8:11], v[60:63], v[36:39], a[8:11]
  s_add_u32 s33, s32, 372736
  buffer_load_dwordx4 v[24:27], v184, s[8:11], s33 offen
  v_mfma_f32_16x16x32_bf16 a[28:31], v[60:63], v[40:43], a[28:31]
  v_mfma_f32_16x16x32_bf16 a[48:51], v[60:63], v[44:47], a[48:51]
  buffer_load_dwordx4 v[8:11], v182, s[4:7], s32 offen
  v_mfma_f32_16x16x32_bf16 a[68:71], v[60:63], v[48:51], a[68:71]
  v_mfma_f32_16x16x32_bf16 a[12:15], v[64:67], v[36:39], a[12:15]
  s_add_u32 s33, s32, 559104
  buffer_load_dwordx4 v[28:31], v184, s[8:11], s33 offen
  v_mfma_f32_16x16x32_bf16 a[32:35], v[64:67], v[40:43], a[32:35]
  v_mfma_f32_16x16x32_bf16 a[52:55], v[64:67], v[44:47], a[52:55]
  buffer_load_dwordx4 v[12:15], v183, s[4:7], s32 offen
  v_mfma_f32_16x16x32_bf16 a[72:75], v[64:67], v[48:51], a[72:75]
  v_mfma_f32_16x16x32_bf16 a[16:19], v[68:71], v[36:39], a[16:19]
  s_add_u32 s33, s32, 745472
  buffer_load_dwordx4 v[32:35], v184, s[8:11], s33 offen
  v_mfma_f32_16x16x32_bf16 a[36:39], v[68:71], v[40:43], a[36:39]
  v_mfma_f32_16x16x32_bf16 a[56:59], v[68:71], v[44:47], a[56:59]
  s_add_u32 s32, s32, 1024
  v_mfma_f32_16x16x32_bf16 a[76:79], v[68:71], v[48:51], a[76:79]
  s_waitcnt vmcnt(27)
  v_mfma_f32_16x16x32_bf16 a[0:3], v[88:91], v[72:75], a[0:3]
  v_mfma_f32_16x16x32_bf16 a[20:23], v[88:91], v[76:79], a[20:23]
  v_mfma_f32_16x16x32_bf16 a[40:43], v[88:91], v[80:83], a[40:43]
  v_mfma_f32_16x16x32_bf16 a[60:63], v[88:91], v[84:87], a[60:63]
  v_mfma_f32_16x16x32_bf16 a[4:7], v[92:95], v[72:75], a[4:7]
  v_mfma_f32_16x16x32_bf16 a[24:27], v[92:95], v[76:79], a[24:27]
  v_mfma_f32_16x16x32_bf16 a[44:47], v[92:95], v[80:83], a[44:47]
  v_mfma_f32_16x16x32_bf16 a[64:67], v[92:95], v[84:87], a[64:67]
  v_mfma_f32_16x16x32_bf16 a[8:11], v[96:99], v[72:75], a[8:11]
  v_mfma_f32_16x16x32_bf16 a[28:31], v[96:99], v[76:79], a[28:31]
  v_mfma_f32_16x16x32_bf16 a[48:51], v[96:99], v[80:83], a[48:51]
  v_mfma_f32_16x16x32_bf16 a[68:71], v[96:99], v[84:87], a[68:71]
  v_mfma_f32_16x16x32_bf16 a[12:15], v[100:103], v[72:75], a[12:15]
  v_mfma_f32_16x16x32_bf16 a[32:35], v[100:103], v[76:79], a[32:35]
  v_mfma_f32_16x16x32_bf16 a[52:55], v[100:103], v[80:83], a[52:55]
  v_mfma_f32_16x16x32_bf16 a[72:75], v[100:103], v[84:87], a[72:75]
  v_mfma_f32_16x16x32_bf16 a[16:19], v[104:107], v[72:75], a[16:19]
  v_mfma_f32_16x16x32_bf16 a[36:39], v[104:107], v[76:79], a[36:39]
  v_mfma_f32_16x16x32_bf16 a[56:59], v[104:107], v[80:83], a[56:59]
  v_mfma_f32_16x16x32_bf16 a[76:79], v[104:107], v[84:87], a[76:79]
  s_waitcnt vmcnt(18)
  v_mfma_f32_16x16x32_bf16 a[0:3], v[124:127], v[108:111], a[0:3]
  v_mfma_f32_16x16x32_bf16 a[20:23], v[124:127], v[112:115], a[20:23]
  v_mfma_f32_16x16x32_bf16 a[40:43], v[124:127], v[116:119], a[40:43]
  v_mfma_f32_16x16x32_bf16 a[60:63], v[124:127], v[120:123], a[60:63]
  v_mfma_f32_16x16x32_bf16 a[4:7], v[128:131], v[108:111], a[4:7]
  v_mfma_f32_16x16x32_bf16 a[24:27], v[128:131], v[112:115], a[24:27]
  v_mfma_f32_16x16x32_bf16 a[44:47], v[128:131], v[116:119], a[44:47]
  v_mfma_f32_16x16x32_bf16 a[64:67], v[128:131], v[120:123], a[64:67]
  v_mfma_f32_16x16x32_bf16 a[8:11], v[132:135], v[108:111], a[8:11]
  v_mfma_f32_16x16x32_bf16 a[28:31], v[132:135], v[112:115], a[28:31]
  v_mfma_f32_16x16x32_bf16 a[48:51], v[132:135], v[116:119], a[48:51]
  v_mfma_f32_16x16x32_bf16 a[68:71], v[132:135], v[120:123], a[68:71]
  v_mfma_f32_16x16x32_bf16 a[12:15], v[136:139], v[108:111], a[12:15]
  v_mfma_f32_16x16x32_bf16 a[32:35], v[136:139], v[112:115], a[32:35]
  v_mfma_f32_16x16x32_bf16 a[52:55], v[136:139], v[116:119], a[52:55]
  v_mfma_f32_16x16x32_bf16 a[72:75], v[136:139], v[120:123], a[72:75]
  v_mfma_f32_16x16x32_bf16 a[16:19], v[140:143], v[108:111], a[16:19]
  v_mfma_f32_16x16x32_bf16 a[36:39], v[140:143], v[112:115], a[36:39]
  v_mfma_f32_16x16x32_bf16 a[56:59], v[140:143], v[116:119], a[56:59]
  v_mfma_f32_16x16x32_bf16 a[76:79], v[140:143], v[120:123], a[76:79]
  s_waitcnt vmcnt(9)
  v_mfma_f32_16x16x32_bf16 a[0:3], v[160:163], v[144:147], a[0:3]
  v_mfma_f32_16x16x32_bf16 a[20:23], v[160:163], v[148:151], a[20:23]
  v_mfma_f32_16x16x32_bf16 a[40:43], v[160:163], v[152:155], a[40:43]
  v_mfma_f32_16x16x32_bf16 a[60:63], v[160:163], v[156:159], a[60:63]
  v_mfma_f32_16x16x32_bf16 a[4:7], v[164:167], v[144:147], a[4:7]
  v_mfma_f32_16x16x32_bf16 a[24:27], v[164:167], v[148:151], a[24:27]
  v_mfma_f32_16x16x32_bf16 a[44:47], v[164:167], v[152:155], a[44:47]
  v_mfma_f32_16x16x32_bf16 a[64:67], v[164:167], v[156:159], a[64:67]
  v_mfma_f32_16x16x32_bf16 a[8:11], v[168:171], v[144:147], a[8:11]
  v_mfma_f32_16x16x32_bf16 a[28:31], v[168:171], v[148:151], a[28:31]
  v_mfma_f32_16x16x32_bf16 a[48:51], v[168:171], v[152:155], a[48:51]
  v_mfma_f32_16x16x32_bf16 a[68:71], v[168:171], v[156:159], a[68:71]
  v_mfma_f32_16x16x32_bf16 a[12:15], v[172:175], v[144:147], a[12:15]
  v_mfma_f32_16x16x32_bf16 a[32:35], v[172:175], v[148:151], a[32:35]
  v_mfma_f32_16x16x32_bf16 a[52:55], v[172:175], v[152:155], a[52:55]
  v_mfma_f32_16x16x32_bf16 a[72:75], v[172:175], v[156:159], a[72:75]
  v_mfma_f32_16x16x32_bf16 a[16:19], v[176:179], v[144:147], a[16:19]
  v_mfma_f32_16x16x32_bf16 a[36:39], v[176:179], v[148:151], a[36:39]
  v_mfma_f32_16x16x32_bf16 a[56:59], v[176:179], v[152:155], a[56:59]
  v_mfma_f32_16x16x32_bf16 a[76:79], v[176:179], v[156:159], a[76:79]
  s_waitcnt vmcnt(0)
  v_mfma_f32_16x16x32_bf16 a[0:3], v[16:19], v[0:3], a[0:3]
  v_mfma_f32_16x16x32_bf16 a[20:23], v[16:19], v[4:7], a[20:23]
  v_mfma_f32_16x16x32_bf16 a[40:43], v[16:19], v[8:11], a[40:43]
  v_mfma_f32_16x16x32_bf16 a[60:63], v[16:19], v[12:15], a[60:63]
  v_mfma_f32_16x16x32_bf16 a[4:7], v[20:23], v[0:3], a[4:7]
  v_mfma_f32_16x16x32_bf16 a[24:27], v[20:23], v[4:7], a[24:27]
  v_mfma_f32_16x16x32_bf16 a[44:47], v[20:23], v[8:11], a[44:47]
  v_mfma_f32_16x16x32_bf16 a[64:67], v[20:23], v[12:15], a[64:67]
  v_mfma_f32_16x16x32_bf16 a[8:11], v[24:27], v[0:3], a[8:11]
  v_mfma_f32_16x16x32_bf16 a[28:31], v[24:27], v[4:7], a[28:31]
  v_mfma_f32_16x16x32_bf16 a[48:51], v[24:27], v[8:11], a[48:51]
  v_mfma_f32_16x16x32_bf16 a[68:71], v[24:27], v[12:15], a[68:71]
  v_mfma_f32_16x16x32_bf16 a[12:15], v[28:31], v[0:3], a[12:15]
  v_mfma_f32_16x16x32_bf16 a[32:35], v[28:31], v[4:7], a[32:35]
  v_mfma_f32_16x16x32_bf16 a[52:55], v[28:31], v[8:11], a[52:55]
  v_mfma_f32_16x16x32_bf16 a[72:75], v[28:31], v[12:15], a[72:75]
  v_mfma_f32_16x16x32_bf16 a[16:19], v[32:35], v[0:3], a[16:19]
  v_mfma_f32_16x16x32_bf16 a[36:39], v[32:35], v[4:7], a[36:39]
  v_mfma_f32_16x16x32_bf16 a[56:59], v[32:35], v[8:11], a[56:59]
  v_mfma_f32_16x16x32_bf16 a[76:79], v[32:35], v[12:15], a[76:79]
  s_nop 7
  ds_write_b128 v186, a[20:23] offset:0
  ds_write_b128 v186, a[24:27] offset:1024
  ds_write_b128 v186, a[28:31] offset:2048
  ds_write_b128 v186, a[32:35] offset:3072
  ds_write_b128 v186, a[36:39] offset:4096
  ds_write_b128 v187, a[40:43] offset:0
  ds_write_b128 v187, a[44:47] offset:1024
  ds_write_b128 v187, a[48:51] offset:2048
  ds_write_b128 v187, a[52:55] offset:3072
  ds_write_b128 v187, a[56:59] offset:4096
  ds_write_b128 v188, a[60:63] offset:0
  ds_write_b128 v188, a[64:67] offset:1024
  ds_write_b128 v188, a[68:71] offset:2048
  ds_write_b128 v188, a[72:75] offset:3072
  ds_write_b128 v188, a[76:79] offset:4096
  v_accvgpr_read_b32 v0, a0
  v_accvgpr_read_b32 v1, a1
  v_accvgpr_read_b32 v2, a2
  v_accvgpr_read_b32 v3, a3
  v_accvgpr_read_b32 v4, a4
  v_accvgpr_read_b32 v5, a5
  v_accvgpr_read_b32 v6, a6
  v_accvgpr_read_b32 v7, a7
  v_accvgpr_read_b32 v8, a8
  v_accvgpr_read_b32 v9, a9
  v_accvgpr_read_b32 v10, a10
  v_accvgpr_read_b32 v11, a11
  v_accvgpr_read_b32 v12, a12
  v_accvgpr_read_b32 v13, a13
  v_accvgpr_read_b32 v14, a14
  v_accvgpr_read_b32 v15, a15
  v_accvgpr_read_b32 v16, a16
  v_accvgpr_read_b32 v17, a17
  v_accvgpr_read_b32 v18, a18
  v_accvgpr_read_b32 v19, a19
  s_mov_b32 s40, 0xffff0000
  s_waitcnt vmcnt(0) lgkmcnt(0)
  v_and_b32 v81, s40, v190
  v_lshlrev_b32 v80, 16, v190
  v_and_b32 v83, s40, v191
  v_lshlrev_b32 v82, 16, v191
  v_and_b32 v85, s40, v192
  v_lshlrev_b32 v84, 16, v192
  v_and_b32 v87, s40, v193
  v_lshlrev_b32 v86, 16, v193
  v_and_b32 v89, s40, v194
  v_lshlrev_b32 v88, 16, v194
  v_and_b32 v91, s40, v195
  v_lshlrev_b32 v90, 16, v195
  v_and_b32 v93, s40, v196
  v_lshlrev_b32 v92, 16, v196
  v_and_b32 v95, s40, v197
  v_lshlrev_b32 v94, 16, v197
  v_and_b32 v97, s40, v198
  v_lshlrev_b32 v96, 16, v198
  v_and_b32 v99, s40, v199
  v_lshlrev_b32 v98, 16, v199
  s_barrier
  ds_read_b128 v[20:23], v189 offset:0
  ds_read_b128 v[24:27], v189 offset:1024
  ds_read_b128 v[28:31], v189 offset:2048
  ds_read_b128 v[32:35], v189 offset:3072
  ds_read_b128 v[36:39], v189 offset:4096
  ds_read_b128 v[40:43], v189 offset:5120
  ds_read_b128 v[44:47], v189 offset:6144
  ds_read_b128 v[48:51], v189 offset:7168
  ds_read_b128 v[52:55], v189 offset:8192
  ds_read_b128 v[56:59], v189 offset:9216
  ds_read_b128 v[60:63], v189 offset:10240
  ds_read_b128 v[64:67], v189 offset:11264
  ds_read_b128 v[68:71], v189 offset:12288
  ds_read_b128 v[72:75], v189 offset:13312
  ds_read_b128 v[76:79], v189 offset:14336
  s_waitcnt lgkmcnt(10)
  v_add_f32 v0, v0, v20
  v_add_f32 v1, v1, v21
  v_add_f32 v2, v2, v22
  v_add_f32 v3, v3, v23
  v_add_f32 v4, v4, v24
  v_add_f32 v5, v5, v25
  v_add_f32 v6, v6, v26
  v_add_f32 v7, v7, v27
  v_add_f32 v8, v8, v28
  v_add_f32 v9, v9, v29
  v_add_f32 v10, v10, v30
  v_add_f32 v11, v11, v31
  v_add_f32 v12, v12, v32
  v_add_f32 v13, v13, v33
  v_add_f32 v14, v14, v34
  v_add_f32 v15, v15, v35
  v_add_f32 v16, v16, v36
  v_add_f32 v17, v17, v37
  v_add_f32 v18, v18, v38
  v_add_f32 v19, v19, v39
  s_waitcnt lgkmcnt(5)
  v_add_f32 v0, v0, v40
  v_add_f32 v1, v1, v41
  v_add_f32 v2, v2, v42
  v_add_f32 v3, v3, v43
  v_add_f32 v4, v4, v44
  v_add_f32 v5, v5, v45
  v_add_f32 v6, v6, v46
  v_add_f32 v7, v7, v47
  v_add_f32 v8, v8, v48
  v_add_f32 v9, v9, v49
  v_add_f32 v10, v10, v50
  v_add_f32 v11, v11, v51
  v_add_f32 v12, v12, v52
  v_add_f32 v13, v13, v53
  v_add_f32 v14, v14, v54
  v_add_f32 v15, v15, v55
  v_add_f32 v16, v16, v56
  v_add_f32 v17, v17, v57
  v_add_f32 v18, v18, v58
  v_add_f32 v19, v19, v59
  s_waitcnt lgkmcnt(0)
  v_add_f32 v0, v0, v60
  v_add_f32 v1, v1, v61
  v_add_f32 v2, v2, v62
  v_add_f32 v3, v3, v63
  v_add_f32 v4, v4, v64
  v_add_f32 v5, v5, v65
  v_add_f32 v6, v6, v66
  v_add_f32 v7, v7, v67
  v_add_f32 v8, v8, v68
  v_add_f32 v9, v9, v69
  v_add_f32 v10, v10, v70
  v_add_f32 v11, v11, v71
  v_add_f32 v12, v12, v72
  v_add_f32 v13, v13, v73
  v_add_f32 v14, v14, v74
  v_add_f32 v15, v15, v75
  v_add_f32 v16, v16, v76
  v_add_f32 v17, v17, v77
  v_add_f32 v18, v18, v78
  v_add_f32 v19, v19, v79
  v_fma_f32 v0, v0, v200, v80
  v_fma_f32 v1, v1, v201, v81
  v_fma_f32 v2, v2, v202, v82
  v_fma_f32 v3, v3, v203, v83
  v_cvt_pk_bf16_f32 v100, v0, v1
  v_cvt_pk_bf16_f32 v101, v2, v3
  buffer_store_dwordx2 v[100:101], v185, s[20:23], 0 offen offset:0
  v_fma_f32 v4, v4, v204, v84
  v_fma_f32 v5, v5, v205, v85
  v_fma_f32 v6, v6, v206, v86
  v_fma_f32 v7, v7, v207, v87
  v_cvt_pk_bf16_f32 v102, v4, v5
  v_cvt_pk_bf16_f32 v103, v6, v7
  buffer_store_dwordx2 v[102:103], v185, s[20:23], 0 offen offset:32
  v_fma_f32 v8, v8, v208, v88
  v_fma_f32 v9, v9, v209, v89
  v_fma_f32 v10, v10, v210, v90
  v_fma_f32 v11, v11, v211, v91
  v_cvt_pk_bf16_f32 v104, v8, v9
  v_cvt_pk_bf16_f32 v105, v10, v11
  buffer_store_dwordx2 v[104:105], v185, s[20:23], 0 offen offset:64
  v_fma_f32 v12, v12, v212, v92
  v_fma_f32 v13, v13, v213, v93
  v_fma_f32 v14, v14, v214, v94
  v_fma_f32 v15, v15, v215, v95
  v_cvt_pk_bf16_f32 v106, v12, v13
  v_cvt_pk_bf16_f32 v107, v14, v15
  buffer_store_dwordx2 v[106:107], v185, s[20:23], 0 offen offset:96
  v_fma_f32 v16, v16, v216, v96
  v_fma_f32 v17, v17, v217, v97
  v_fma_f32 v18, v18, v218, v98
  v_fma_f32 v19, v19, v219, v99
  v_cvt_pk_bf16_f32 v108, v16, v17
  v_cvt_pk_bf16_f32 v109, v18, v19
  buffer_store_dwordx2 v[108:109], v185, s[20:23], 0 offen offset:128
L_k3_done:
  s_endpgm
.section .rodata,"a"
.p2align 6
.amdhsa_kernel ln_kernel
  .amdhsa_next_free_vgpr 88
  .amdhsa_next_free_sgpr 48
  .amdhsa_accum_offset 88
  .amdhsa_group_segment_fixed_size 0
  .amdhsa_kernarg_size 88
  .amdhsa_user_sgpr_count 2
  .amdhsa_user_sgpr_kernarg_segment_ptr 1
  .amdhsa_system_sgpr_workgroup_id_x 1
  .amdhsa_float_denorm_mode_32 3
.end_amdhsa_kernel
.section .rodata,"a"
.p2align 6
.amdhsa_kernel attn_kernel
  .amdhsa_next_free_vgpr 512
  .amdhsa_next_free_sgpr 102
  .amdhsa_accum_offset 256
  .amdhsa_group_segment_fixed_size 0
  .amdhsa_kernarg_size 88
  .amdhsa_user_sgpr_count 2
  .amdhsa_user_sgpr_kernarg_segment_ptr 1
  .amdhsa_system_sgpr_workgroup_id_x 1
  .amdhsa_float_denorm_mode_32 0
.end_amdhsa_kernel
.section .rodata,"a"
.p2align 6
.amdhsa_kernel out_kernel
  .amdhsa_next_free_vgpr 416
  .amdhsa_next_free_sgpr 80
  .amdhsa_accum_offset 256
  .amdhsa_group_segment_fixed_size 0
  .amdhsa_kernarg_size 88
  .amdhsa_user_sgpr_count 2
  .amdhsa_user_sgpr_kernarg_segment_ptr 1
  .amdhsa_system_sgpr_workgroup_id_x 1
  .amdhsa_float_denorm_mode_32 3
.end_amdhsa_kernel
```
